```python
import torch

def _softmax(x, axis=-1):
    return torch.softmax(x, dim=axis)
def _gelu(x):
    return torch.nn.functional.gelu(x, approximate="tanh")
def _silu(x):
    return torch.nn.functional.silu(x)
def _sigmoid(x):
    return torch.sigmoid(x)
def _layernorm(x, axis=-1, eps=1e-5):
    m = x.mean(dim=axis, keepdim=True)
    v = x.var(dim=axis, keepdim=True, unbiased=False)
    return (x - m) / torch.sqrt(v + eps)
def _scatter_add(tgt, idx, src, axis=0):
    return tgt.clone().index_add_(axis, idx, src)
def _segment_sum(src, seg, n):
    out = torch.zeros((n,) + src.shape[1:], dtype=src.dtype)
    return out.index_add_(0, seg, src)
def _pad(x, pw):
    flat = tuple(v for pair in reversed(pw) for v in pair)
    return torch.nn.functional.pad(x, flat)

kernel_name = 'parallel_sum__linear_attn_block__glu_gated_reglu__prompt'

def setup_inputs():

    _w = (lambda a: (lambda t: t.to(torch.bfloat16) if t.is_floating_point() else t)(torch.as_tensor(a)))
    def _A_setup():
        B, S, D = 1, 2048, 576
        return {
            "x": _w((lambda *s: torch.randn(*s, dtype=torch.bfloat16) * 0.05)(B, S, D)),
            "wqkv": _w((lambda *s: torch.randn(*s, dtype=torch.bfloat16) * 0.05)(D, 3 * D)),
            "wo": _w((lambda *s: torch.randn(*s, dtype=torch.bfloat16) * 0.05)(D, D)),
        }
    _A_in = _A_setup()

    def _B_setup():
        B, S, D, F = 1, 2048, 576, 4608
        return {
            "x": _w((lambda *s: torch.randn(*s, dtype=torch.bfloat16) * 0.05)(B, S, D)),
            "W_gate": _w((lambda *s: torch.randn(*s, dtype=torch.bfloat16) * 0.2)(D, F) * (2.0 / D) ** 0.5),
            "W_up": _w((lambda *s: torch.randn(*s, dtype=torch.bfloat16) * 0.2)(D, F) * (2.0 / D) ** 0.5),
            "W_down": _w((lambda *s: torch.randn(*s, dtype=torch.bfloat16) * 0.2)(F, D) * (1.0 / F) ** 0.5),
        }
    _B_in = _B_setup()

    return {
        "A_x": _A_in["x"],
        "A_wqkv": _A_in["wqkv"],
        "A_wo": _A_in["wo"],
        "B_x": _B_in["x"],
        "B_W_gate": _B_in["W_gate"],
        "B_W_up": _B_in["W_up"],
        "B_W_down": _B_in["W_down"],
    }

def reference(A_x, A_wqkv, A_wo, B_x, B_W_gate, B_W_up, B_W_down):
    def _A_ref(x, wqkv, wo):
        B, S, D = x.shape
        H = 32; Dh = D // H
        qkv = (lambda x, *d: x.permute(*d))((x @ wqkv).reshape(B, S, 3, H, Dh), 2, 0, 3, 1, 4)
        q, k, v = qkv[0], qkv[1], qkv[2]
        phi = lambda t: torch.where(t > 0, t + 1, torch.exp(t)) + 1e-6
        pq, pk = phi(q), phi(k)
        kv = torch.einsum("bhsd,bhse->bhde", pk, v)
        z = torch.einsum("bhsd->bhd", pk)
        num = torch.einsum("bhqd,bhde->bhqe", pq, kv)
        den = torch.einsum("bhqd,bhd->bhq", pq, z)[..., None] + 1e-6
        o = num / den
        return (lambda x, *d: x.permute(*d))(o, 0, 2, 1, 3).reshape(B, S, D) @ wo

    def _B_ref(x, W_gate, W_up, W_down):
        gate = torch.einsum("bsd,df->bsf", x, W_gate)
        up = torch.einsum("bsd,df->bsf", x, W_up)
        gate = gate * (lambda x, dt: x.to(dt))(gate > 0, gate.dtype)
        h = gate * up
        return torch.einsum("bsf,fd->bsd", h, W_down)

    x = A_x
    xn = _layernorm(x, axis=-1)
    return x + _A_ref(xn, A_wqkv, A_wo) + _B_ref(xn, B_W_gate, B_W_up, B_W_down)
```

```asm
; @launch grid=(256,1,1) block=(256,1,1) lds=163840
.amdgcn_target "amdgcn-amd-amdhsa--gfx950"
.text
.globl parallel_sum__linear_attn_block__glu_gated_reglu__prompt_kernel
.p2align 8
.type parallel_sum__linear_attn_block__glu_gated_reglu__prompt_kernel,@function
parallel_sum__linear_attn_block__glu_gated_reglu__prompt_kernel:
s_cmp_ge_u32 s2, 256
s_cbranch_scc1 L_done
s_load_dwordx16 s[64:79], s[0:1], 0
s_load_dwordx4 s[80:83], s[0:1], 64
v_lshrrev_b32 v24, 6, v0
v_and_b32 v1, 63, v0
s_nop 0
v_readfirstlane_b32 s3, v24
s_getpc_b64 s[42:43]
L_cp:
s_bfe_u32 s4, s2, 0x50003
s_lshl_b32 s4, s4, 2
v_add_u32 v25, s4, v24
v_mul_u32_u24 v25, 4, v25
v_min_u32 v26, 3, v1
v_add_lshl_u32 v25, v25, v26, 7
v_min_u32 v25, L_end-L_cp-4, v25
global_load_dword v55, v25, s[42:43]
s_and_b32 s4, s2, 7
s_lshl_b32 s4, s4, 1
s_bfe_u32 s5, s2, 0x10003
s_add_u32 s4, s4, s5
s_and_b32 s5, s2, 7
s_lshr_b32 s5, s5, 3
s_lshl_b32 s5, s5, 4
s_lshr_b32 s6, s2, 4
s_add_u32 s5, s5, s6
s_lshl_b32 s6, s5, 7
s_lshl_b32 s7, s3, 5
s_add_u32 s6, s6, s7
v_lshrrev_b32 v26, 3, v1
v_add_u32 v25, s6, v26
v_mul_u32_u24 v25, 1152, v25
v_lshrrev_b32 v26, 4, v1
v_and_b32 v27, 7, v1
v_xor_b32 v26, v26, v27
v_lshl_add_u32 v52, v26, 4, v25
v_xor_b32 v53, 64, v52
v_add_u32 v53, 9216, v53
s_and_b32 s45, s4, 0
s_xor_b32 s46, s45, 1
s_mul_i32 s47, s45, 884736
s_mul_i32 s100, s46, 1105920
s_mul_i32 s46, s46, 640
s_lshl_b32 s45, s45, 9
v_add_u32 v70, s46, v52
v_add_u32 v71, s46, v53
v_add_u32 v52, s45, v52
v_add_u32 v53, s45, v53
v_and_b32 v26, 31, v1
v_lshrrev_b32 v27, 5, v1
s_mov_b32 s101, 18432
s_mov_b32 s10, 2359296
s_mov_b32 s11, 0x20000
s_mov_b32 s14, 1990656
s_mov_b32 s15, 0x20000
v_lshrrev_b32 v28, 4, v1
v_bfe_u32 v29, v1, 2, 2
v_xor_b32 v29, v29, v28
v_and_b32 v30, 3, v1
v_add_u32 v31, 1, v29
v_and_b32 v31, 3, v31
v_mul_u32_u24 v31, 576, v31
v_lshl_add_u32 v31, v30, 3, v31
v_min_u32 v32, 2, v30
v_mul_u32_u24 v32, 576, v32
v_add_u32 v32, 28, v32
v_cmp_eq_u32 vcc, 2, v29
s_lshl_b32 s7, s3, 2
v_add_u32 v28, s7, v28
v_cndmask_b32 v31, v31, v32, vcc
s_mul_i32 s7, s4, 36
v_add_u32 v31, s7, v31
v_mul_u32_u24 v28, 3456, v28
v_lshl_add_u32 v2, v31, 1, v28
s_lshl_b32 s40, s3, 10
v_mul_u32_u24 v33, 57, v1
v_lshrrev_b32 v33, 9, v33
v_mul_u32_u24 v34, 9, v33
v_sub_u32 v34, v1, v34
v_min_u32 v33, 5, v33
s_lshr_b32 s6, s2, 4
s_mul_i32 s6, s6, 36
s_mul_i32 s7, s3, 9
s_add_u32 s6, s6, s7
v_add_u32 v34, s6, v34
v_mul_u32_u24 v34, 3456, v34
v_lshrrev_b32 v35, 1, v33
v_mul_u32_u24 v35, 1152, v35
v_and_b32 v33, 1, v33
v_mul_u32_u24 v33, 68, v33
v_add3_u32 v34, v34, v35, v33
s_mul_i32 s6, s4, 72
s_waitcnt lgkmcnt(0)
s_mov_b32 s8, s64
s_mov_b32 s9, s65
s_mov_b32 s12, s66
s_mov_b32 s13, s67
s_add_u32 m0, s40, 0
s_nop 0
buffer_load_dwordx4 v52, s[8:11], 0 offen offset:0 lds
s_add_u32 m0, s40, 4096
s_nop 0
buffer_load_dwordx4 v53, s[8:11], 0 offen offset:0 lds
s_add_u32 m0, s40, 8192
s_nop 0
buffer_load_dwordx4 v52, s[8:11], s101 offen offset:0 lds
s_add_u32 m0, s40, 12288
s_nop 0
buffer_load_dwordx4 v53, s[8:11], s101 offen offset:0 lds
s_add_u32 m0, s40, 16256
s_nop 0
buffer_load_dwordx4 v52, s[8:11], 0 offen offset:128 lds
s_add_u32 m0, s40, 20352
s_nop 0
buffer_load_dwordx4 v53, s[8:11], 0 offen offset:128 lds
s_add_u32 m0, s40, 24448
s_nop 0
buffer_load_dwordx4 v52, s[8:11], s101 offen offset:128 lds
s_add_u32 m0, s40, 28544
s_nop 0
buffer_load_dwordx4 v53, s[8:11], s101 offen offset:128 lds
s_add_u32 m0, s40, 32512
s_nop 0
buffer_load_dwordx4 v52, s[8:11], 0 offen offset:256 lds
s_add_u32 m0, s40, 36608
s_nop 0
buffer_load_dwordx4 v53, s[8:11], 0 offen offset:256 lds
s_add_u32 m0, s40, 40704
s_nop 0
buffer_load_dwordx4 v52, s[8:11], s101 offen offset:256 lds
s_add_u32 m0, s40, 44800
s_nop 0
buffer_load_dwordx4 v53, s[8:11], s101 offen offset:256 lds
s_add_u32 m0, s40, 48768
s_nop 0
buffer_load_dwordx4 v52, s[8:11], 0 offen offset:384 lds
s_add_u32 m0, s40, 52864
s_nop 0
buffer_load_dwordx4 v53, s[8:11], 0 offen offset:384 lds
s_add_u32 m0, s40, 56960
s_nop 0
buffer_load_dwordx4 v52, s[8:11], s101 offen offset:384 lds
s_add_u32 m0, s40, 61056
s_nop 0
buffer_load_dwordx4 v53, s[8:11], s101 offen offset:384 lds
buffer_load_dword v54, v34, s[12:15], s6 offen
s_add_u32 s6, s6, 1990656
s_cmp_ge_u32 s3, 2
s_cselect_b32 s20, s74, s72
s_cselect_b32 s21, s75, s73
s_mov_b32 s22, 5308416
s_mov_b32 s23, 0x20000
s_mov_b32 s16, s68
s_mov_b32 s17, s69
s_mov_b32 s18, 663552
s_mov_b32 s19, 0x20000
s_mov_b32 s24, s76
s_mov_b32 s25, s77
s_mov_b32 s26, 5308416
s_mov_b32 s27, 0x20000
s_mov_b32 s28, s78
s_mov_b32 s29, s79
s_mov_b32 s30, 2359296
s_mov_b32 s31, 0x20000
s_mov_b32 s32, s80
s_mov_b32 s33, s81
s_mov_b32 s34, 256
s_mov_b32 s35, 0x20000
s_mov_b32 s36, s82
s_mov_b32 s37, s83
s_mov_b32 s38, 268435456
s_mov_b32 s39, 0x20000
s_and_b32 s6, s4, 1
s_mul_i32 s7, s4, 288
s_lshl_b32 s42, s6, 5
s_add_u32 s42, s42, s7
s_xor_b32 s6, s6, 1
s_lshl_b32 s43, s6, 8
s_add_u32 s43, s43, s7
s_lshr_b32 s6, s2, 4
s_lshl_b32 s6, s6, 1
s_and_b32 s7, s3, 1
s_add_u32 s6, s6, s7
s_mul_i32 s6, s6, 18
v_min_u32 v10, 17, v1
v_add_u32 v10, s6, v10
v_mul_u32_u24 v10, 9216, v10
s_lshl_b32 s6, s42, 1
v_add_u32 v10, s6, v10
s_lshr_b32 s6, s2, 4
s_lshl_b32 s6, s6, 2
s_add_u32 s6, s6, s3
s_mul_i32 s7, s6, 5184
s_mul_i32 s44, s4, 331776
s_add_u32 s7, s7, s44
v_min_u32 v13, 13, v1
v_lshl_add_u32 v13, v13, 7, s7
s_mul_i32 s7, s6, 648
s_mul_i32 s44, s4, 41472
s_add_u32 s7, s7, s44
v_min_u32 v16, 6, v1
v_lshl_add_u32 v16, v16, 7, s7
s_sub_u32 s0, s43, s42
s_lshl_b32 s0, s0, 1
v_lshrrev_b32 v28, 3, v1
v_and_b32 v29, 7, v1
v_and_b32 v30, 2, v28
v_xor_b32 v29, v29, v30
v_lshlrev_b32 v29, 4, v29
s_and_b32 s6, s3, 1
s_lshr_b32 s7, s3, 1
s_lshl_b32 s44, s6, 3
v_add_u32 v30, s44, v28
v_mul_u32_u24 v30, 9216, v30
s_lshl_b32 s44, s42, 1
v_add3_u32 v3, v30, v29, s44
s_lshl_b32 s44, s6, 5
s_lshl_b32 s45, s7, 3
s_add_u32 s44, s44, s45
s_add_u32 s44, s44, s42
v_add_u32 v30, s44, v28
v_mul_u32_u24 v30, 1152, v30
v_add_u32 v5, v30, v29
s_lshl_b32 s44, s6, 4
s_add_u32 s44, s44, s45
s_add_u32 s45, s44, s43
v_add_u32 v30, s45, v28
v_mul_u32_u24 v30, 1152, v30
v_add_u32 v6, v30, v29
s_mul_i32 s46, s4, 36
s_add_u32 s45, s44, s46
v_add_u32 v30, s45, v28
v_mul_u32_u24 v30, 1152, v30
v_add_u32 v7, v30, v29
s_add_u32 s45, s46, 28
v_add_u32 v30, s45, v28
v_mul_u32_u24 v30, 1152, v30
s_mov_b32 s45, 0
v_add3_u32 v30, v30, v29, s45
v_accvgpr_write_b32 a183, v30
v_lshrrev_b32 v28, 2, v1
s_lshl_b32 s44, s6, 4
v_add_u32 v28, s44, v28
v_mul_u32_u24 v28, 9216, v28
v_and_b32 v29, 3, v1
v_lshlrev_b32 v29, 4, v29
s_lshl_b32 s44, s43, 1
v_add3_u32 v4, v28, v29, s44
v_bfe_u32 v28, v1, 2, 2
v_and_b32 v29, 1, v1
v_bfe_u32 v30, v1, 1, 1
v_and_b32 v31, 16, v1
v_lshl_add_u32 v30, v30, 3, v31
v_lshl_add_u32 v31, v29, 5, v30
v_lshl_add_u32 v32, v28, 6, v31
v_lshl_add_u32 v14, v27, 9, v32
v_lshl_add_u32 v32, v29, 6, v30
v_lshl_add_u32 v32, v28, 7, v32
v_and_b32 v33, 8, v1
v_lshl_add_u32 v32, v33, 2, v32
v_add_u32 v17, 131072, v32
v_xor_b32 v18, 32, v17
v_lshl_add_u32 v8, v27, 10, v32
v_xor_b32 v11, 32, v8
v_add_u32 v9, 0x10000, v8
v_add_u32 v12, 0x10000, v11
v_add_u32 v15, 0x10000, v14
v_lshl_add_u32 v32, v28, 8, v31
v_lshl_add_u32 v32, v27, 11, v32
v_lshl_add_u32 v40, v28, 6, v32
v_xor_b32 v43, 64, v40
v_xor_b32 v46, 128, v40
v_xor_b32 v49, 192, v40
v_add_u32 v41, 0x10000, v40
v_add_u32 v42, 0x20000, v40
v_add_u32 v44, 0x10000, v43
v_add_u32 v45, 0x20000, v43
v_add_u32 v47, 0x10000, v46
v_add_u32 v48, 0x20000, v46
v_add_u32 v50, 0x10000, v49
v_add_u32 v51, 0x20000, v49
s_lshl_b32 s44, s5, 4
s_add_u32 s44, s44, s4
s_mul_i32 s44, s44, 44
s_add_u32 s44, s44, s3
s_lshl_b32 s44, s44, 12
s_add_u32 s44, s44, 0
v_lshl_add_u32 v21, v1, 4, s44
s_lshl_b32 s44, s5, 4
s_add_u32 s44, s44, s4
v_mov_b32 v28, s44
v_cmp_eq_u32 vcc, 0, v0
v_mov_b32 v29, 0x7fffff00
s_nop 0
v_cndmask_b32 v0, v29, v28, vcc
s_mul_i32 s1, s5, 240
s_add_u32 s1, s1, 83886080
v_mov_b32 v28, 0
buffer_store_byte v28, v0, s[36:39], s1 offen sc0 sc1
s_nop 1
v_lshrrev_b32 v28, 3, v26
v_lshlrev_b32 v28, 12, v28
v_and_b32 v29, 7, v26
v_lshl_add_u32 v28, v29, 7, v28
v_bfe_u32 v29, v26, 1, 3
v_xor_b32 v29, v29, v27
v_lshl_add_u32 v28, v29, 4, v28
v_add_u32 v56, s40, v28
v_xor_b32 v57, 32, v56
v_xor_b32 v58, 64, v56
v_xor_b32 v59, 96, v56
v_add_u32 v62, 0x10000, v56
v_add_u32 v66, 0x20000, v56
v_add_u32 v63, 0x10000, v57
v_add_u32 v67, 0x20000, v57
v_add_u32 v64, 0x10000, v58
v_add_u32 v68, 0x20000, v58
v_add_u32 v65, 0x10000, v59
v_add_u32 v69, 0x20000, v59
v_lshlrev_b32 v34, 2, v27
v_sub_u32 v34, v26, v34
v_mov_b32 v35, 0x3f80
v_mov_b32 v36, 0x3f800000
v_cmp_eq_u32 vcc, 0, v34
v_cmp_eq_u32 s[94:95], 1, v34
s_nop 0
v_cndmask_b32 v37, 0, v35, vcc
v_cndmask_b32 v37, v37, v36, s[94:95]
v_accvgpr_write_b32 a184, v37
v_cmp_eq_u32 vcc, 2, v34
v_cmp_eq_u32 s[94:95], 3, v34
s_nop 0
v_cndmask_b32 v37, 0, v35, vcc
v_cndmask_b32 v37, v37, v36, s[94:95]
v_accvgpr_write_b32 a185, v37
v_cmp_eq_u32 vcc, 8, v34
v_cmp_eq_u32 s[94:95], 9, v34
s_nop 0
v_cndmask_b32 v37, 0, v35, vcc
v_cndmask_b32 v37, v37, v36, s[94:95]
v_accvgpr_write_b32 a186, v37
v_cmp_eq_u32 vcc, 10, v34
v_cmp_eq_u32 s[94:95], 11, v34
s_nop 0
v_cndmask_b32 v37, 0, v35, vcc
v_cndmask_b32 v37, v37, v36, s[94:95]
v_accvgpr_write_b32 a187, v37
v_cmp_eq_u32 vcc, 16, v34
v_cmp_eq_u32 s[94:95], 17, v34
s_nop 0
v_cndmask_b32 v37, 0, v35, vcc
v_cndmask_b32 v37, v37, v36, s[94:95]
v_accvgpr_write_b32 a188, v37
v_cmp_eq_u32 vcc, 18, v34
v_cmp_eq_u32 s[94:95], 19, v34
s_nop 0
v_cndmask_b32 v37, 0, v35, vcc
v_cndmask_b32 v37, v37, v36, s[94:95]
v_accvgpr_write_b32 a189, v37
v_cmp_eq_u32 vcc, 24, v34
v_cmp_eq_u32 s[94:95], 25, v34
s_nop 0
v_cndmask_b32 v37, 0, v35, vcc
v_cndmask_b32 v37, v37, v36, s[94:95]
v_accvgpr_write_b32 a190, v37
v_cmp_eq_u32 vcc, 26, v34
v_cmp_eq_u32 s[94:95], 27, v34
s_nop 0
v_cndmask_b32 v37, 0, v35, vcc
v_cndmask_b32 v37, v37, v36, s[94:95]
v_accvgpr_write_b32 a191, v37
s_mov_b32 s92, 0xf0f0f0f0
s_mov_b32 s93, 0xf0f0f0f0
v_mov_b32 v28, 0x358637bd
v_cndmask_b32 v29, v28, 0, s[92:93]
v_accvgpr_write_b32 a192, v28
v_accvgpr_write_b32 a224, v29
v_accvgpr_write_b32 a240, v28
v_accvgpr_write_b32 a193, v28
v_accvgpr_write_b32 a225, v29
v_accvgpr_write_b32 a241, v28
v_accvgpr_write_b32 a194, v28
v_accvgpr_write_b32 a226, v29
v_accvgpr_write_b32 a242, v28
v_accvgpr_write_b32 a195, v28
v_accvgpr_write_b32 a227, v29
v_accvgpr_write_b32 a243, v28
v_accvgpr_write_b32 a196, v28
v_accvgpr_write_b32 a228, v29
v_accvgpr_write_b32 a244, v28
v_accvgpr_write_b32 a197, v28
v_accvgpr_write_b32 a229, v29
v_accvgpr_write_b32 a245, v28
v_accvgpr_write_b32 a198, v28
v_accvgpr_write_b32 a230, v29
v_accvgpr_write_b32 a246, v28
v_accvgpr_write_b32 a199, v28
v_accvgpr_write_b32 a231, v29
v_accvgpr_write_b32 a247, v28
v_accvgpr_write_b32 a200, v28
v_accvgpr_write_b32 a232, v29
v_accvgpr_write_b32 a248, v28
v_accvgpr_write_b32 a201, v28
v_accvgpr_write_b32 a233, v29
v_accvgpr_write_b32 a249, v28
v_accvgpr_write_b32 a202, v28
v_accvgpr_write_b32 a234, v29
v_accvgpr_write_b32 a250, v28
v_accvgpr_write_b32 a203, v28
v_accvgpr_write_b32 a235, v29
v_accvgpr_write_b32 a251, v28
v_accvgpr_write_b32 a204, v28
v_accvgpr_write_b32 a236, v29
v_accvgpr_write_b32 a252, v28
v_accvgpr_write_b32 a205, v28
v_accvgpr_write_b32 a237, v29
v_accvgpr_write_b32 a253, v28
v_accvgpr_write_b32 a206, v28
v_accvgpr_write_b32 a238, v29
v_accvgpr_write_b32 a254, v28
v_accvgpr_write_b32 a207, v28
v_accvgpr_write_b32 a239, v29
v_accvgpr_write_b32 a255, v28
v_accvgpr_write_b32 a176, -1
v_accvgpr_write_b32 a177, -1
v_accvgpr_write_b32 a178, -1
v_accvgpr_write_b32 a179, -1
s_and_b32 s44, s4, 0
s_xor_b32 s45, s44, 1
s_mul_i32 s44, s44, 2359296
s_mul_i32 s45, s45, 2949120
s_add_u32 s48, s44, 0
s_add_u32 s49, s44, 147456
s_add_u32 s50, s44, 294912
s_add_u32 s51, s44, 442368
s_add_u32 s52, s44, 589824
s_add_u32 s53, s44, 737280
s_add_u32 s54, s44, 884736
s_add_u32 s55, s44, 1032192
s_add_u32 s56, s44, 1179648
s_add_u32 s57, s44, 1327104
s_add_u32 s58, s44, 1474560
s_add_u32 s59, s44, 1622016
s_add_u32 s60, s44, 1769472
s_add_u32 s61, s44, 1916928
s_add_u32 s62, s44, 2064384
s_add_u32 s63, s44, 2211840
s_add_u32 s64, s44, 2359296
s_add_u32 s65, s44, 2506752
s_add_u32 s66, s44, 2654208
s_add_u32 s67, s44, 2801664
s_add_u32 s68, s45, 0
s_add_u32 s69, s45, 147456
s_add_u32 s70, s45, 294912
s_add_u32 s71, s45, 442368
s_add_u32 s72, s45, 589824
s_add_u32 s73, s45, 737280
s_add_u32 s74, s45, 884736
s_add_u32 s75, s45, 1032192
s_add_u32 s76, s45, 1179648
s_add_u32 s77, s45, 1327104
s_add_u32 s78, s45, 1474560
s_add_u32 s79, s45, 1622016
s_add_u32 s80, s45, 1769472
s_add_u32 s81, s45, 1916928
s_add_u32 s82, s45, 2064384
s_add_u32 s83, s45, 2211840
s_mov_b32 s84, 0
s_mov_b32 s85, 18432
s_mov_b32 s86, 73728
s_mov_b32 s87, 92160
s_mov_b32 s88, 147456
s_mov_b32 s89, 165888
s_mov_b32 s90, 221184
s_mov_b32 s91, 239616
s_mov_b32 s42, 0x3f803f80
s_mov_b32 s43, 0x3fb8aa3b
s_mov_b32 s46, 0x358637bd
v_mov_b32 v19, 0xb5c1a2a0
s_add_u32 m0, s40, 65024
s_nop 0
buffer_load_dwordx4 v52, s[8:11], 0 offen offset:512 lds
s_add_u32 m0, s40, 69120
s_nop 0
buffer_load_dwordx4 v53, s[8:11], 0 offen offset:512 lds
s_add_u32 m0, s40, 73216
s_nop 0
buffer_load_dwordx4 v52, s[8:11], s101 offen offset:512 lds
s_add_u32 m0, s40, 77312
s_nop 0
buffer_load_dwordx4 v53, s[8:11], s101 offen offset:512 lds
s_add_u32 m0, s40, 81920
s_nop 0
buffer_load_dwordx4 v70, s[8:11], 0 offen offset:0 lds
s_add_u32 m0, s40, 86016
s_nop 0
buffer_load_dwordx4 v71, s[8:11], 0 offen offset:0 lds
s_add_u32 m0, s40, 90112
s_nop 0
buffer_load_dwordx4 v70, s[8:11], s101 offen offset:0 lds
s_add_u32 m0, s40, 94208
s_nop 0
buffer_load_dwordx4 v71, s[8:11], s101 offen offset:0 lds
s_add_u32 m0, s40, 98176
s_nop 0
buffer_load_dwordx4 v70, s[8:11], 0 offen offset:128 lds
s_add_u32 m0, s40, 102272
s_nop 0
buffer_load_dwordx4 v71, s[8:11], 0 offen offset:128 lds
s_add_u32 m0, s40, 106368
s_nop 0
buffer_load_dwordx4 v70, s[8:11], s101 offen offset:128 lds
s_add_u32 m0, s40, 110464
s_nop 0
buffer_load_dwordx4 v71, s[8:11], s101 offen offset:128 lds
s_add_u32 m0, s40, 114432
s_nop 0
buffer_load_dwordx4 v70, s[8:11], 0 offen offset:256 lds
s_add_u32 m0, s40, 118528
s_nop 0
buffer_load_dwordx4 v71, s[8:11], 0 offen offset:256 lds
s_add_u32 m0, s40, 122624
s_nop 0
buffer_load_dwordx4 v70, s[8:11], s101 offen offset:256 lds
s_add_u32 m0, s40, 126720
s_nop 0
buffer_load_dwordx4 v71, s[8:11], s101 offen offset:256 lds
s_add_u32 m0, s40, 130688
s_nop 0
buffer_load_dwordx4 v70, s[8:11], 0 offen offset:384 lds
s_add_u32 m0, s40, 134784
s_nop 0
buffer_load_dwordx4 v71, s[8:11], 0 offen offset:384 lds
s_add_u32 m0, s40, 138880
s_nop 0
buffer_load_dwordx4 v70, s[8:11], s101 offen offset:384 lds
s_add_u32 m0, s40, 142976
s_nop 0
buffer_load_dwordx4 v71, s[8:11], s101 offen offset:384 lds
buffer_load_dword a182, v10, s[20:23], 0 offen
s_waitcnt vmcnt(35)
ds_read_b128 v[112:115], v56 offset:0
ds_read_b128 v[116:119], v57 offset:0
ds_read_b128 v[120:123], v58 offset:0
ds_read_b128 v[124:127], v59 offset:0
s_waitcnt vmcnt(31)
ds_read_b128 v[128:131], v56 offset:16384
ds_read_b128 v[132:135], v57 offset:16384
ds_read_b128 v[136:139], v58 offset:16384
ds_read_b128 v[140:143], v59 offset:16384
s_waitcnt lgkmcnt(4)
v_dot2_f32_bf16 v28, v112, s42, 0
v_dot2_f32_bf16 v32, v112, v112, 0
s_add_u32 m0, s40, 147456
s_add_u32 s41, s47, 0
buffer_load_dwordx4 v2, s[12:15], s41 offen offset:0 lds
v_dot2_f32_bf16 v29, v113, s42, 0
v_dot2_f32_bf16 v33, v113, v113, 0
v_dot2_f32_bf16 v30, v114, s42, 0
v_dot2_f32_bf16 v34, v114, v114, 0
v_dot2_f32_bf16 v31, v115, s42, 0
v_dot2_f32_bf16 v35, v115, v115, 0
v_dot2_f32_bf16 v28, v116, s42, v28
v_dot2_f32_bf16 v32, v116, v116, v32
s_add_u32 m0, s40, 151552
s_add_u32 s41, s47, 55296
buffer_load_dwordx4 v2, s[12:15], s41 offen offset:0 lds
v_dot2_f32_bf16 v29, v117, s42, v29
v_dot2_f32_bf16 v33, v117, v117, v33
v_dot2_f32_bf16 v30, v118, s42, v30
v_dot2_f32_bf16 v34, v118, v118, v34
v_dot2_f32_bf16 v31, v119, s42, v31
v_dot2_f32_bf16 v35, v119, v119, v35
v_dot2_f32_bf16 v28, v120, s42, v28
v_dot2_f32_bf16 v32, v120, v120, v32
s_add_u32 m0, s40, 155648
s_add_u32 s41, s47, 110592
buffer_load_dwordx4 v2, s[12:15], s41 offen offset:0 lds
v_dot2_f32_bf16 v29, v121, s42, v29
v_dot2_f32_bf16 v33, v121, v121, v33
v_dot2_f32_bf16 v30, v122, s42, v30
v_dot2_f32_bf16 v34, v122, v122, v34
v_dot2_f32_bf16 v31, v123, s42, v31
v_dot2_f32_bf16 v35, v123, v123, v35
v_dot2_f32_bf16 v28, v124, s42, v28
v_dot2_f32_bf16 v32, v124, v124, v32
s_add_u32 m0, s40, 159744
s_add_u32 s41, s47, 165888
buffer_load_dwordx4 v2, s[12:15], s41 offen offset:0 lds
v_dot2_f32_bf16 v29, v125, s42, v29
v_dot2_f32_bf16 v33, v125, v125, v33
v_dot2_f32_bf16 v30, v126, s42, v30
v_dot2_f32_bf16 v34, v126, v126, v34
v_dot2_f32_bf16 v31, v127, s42, v31
v_dot2_f32_bf16 v35, v127, v127, v35
s_waitcnt vmcnt(31)
ds_read_b128 v[144:147], v56 offset:32768
ds_read_b128 v[148:151], v57 offset:32768
ds_read_b128 v[152:155], v58 offset:32768
ds_read_b128 v[156:159], v59 offset:32768
s_waitcnt lgkmcnt(4)
v_dot2_f32_bf16 v28, v128, s42, v28
v_dot2_f32_bf16 v32, v128, v128, v32
v_dot2_f32_bf16 v29, v129, s42, v29
v_dot2_f32_bf16 v33, v129, v129, v33
v_dot2_f32_bf16 v30, v130, s42, v30
v_dot2_f32_bf16 v34, v130, v130, v34
v_dot2_f32_bf16 v31, v131, s42, v31
v_dot2_f32_bf16 v35, v131, v131, v35
v_dot2_f32_bf16 v28, v132, s42, v28
v_dot2_f32_bf16 v32, v132, v132, v32
v_dot2_f32_bf16 v29, v133, s42, v29
v_dot2_f32_bf16 v33, v133, v133, v33
v_dot2_f32_bf16 v30, v134, s42, v30
v_dot2_f32_bf16 v34, v134, v134, v34
v_dot2_f32_bf16 v31, v135, s42, v31
v_dot2_f32_bf16 v35, v135, v135, v35
v_dot2_f32_bf16 v28, v136, s42, v28
v_dot2_f32_bf16 v32, v136, v136, v32
v_dot2_f32_bf16 v29, v137, s42, v29
v_dot2_f32_bf16 v33, v137, v137, v33
v_dot2_f32_bf16 v30, v138, s42, v30
v_dot2_f32_bf16 v34, v138, v138, v34
v_dot2_f32_bf16 v31, v139, s42, v31
v_dot2_f32_bf16 v35, v139, v139, v35
v_dot2_f32_bf16 v28, v140, s42, v28
v_dot2_f32_bf16 v32, v140, v140, v32
v_dot2_f32_bf16 v29, v141, s42, v29
v_dot2_f32_bf16 v33, v141, v141, v33
v_dot2_f32_bf16 v30, v142, s42, v30
v_dot2_f32_bf16 v34, v142, v142, v34
v_dot2_f32_bf16 v31, v143, s42, v31
v_dot2_f32_bf16 v35, v143, v143, v35
s_waitcnt vmcnt(27)
ds_read_b128 v[160:163], v56 offset:49152
ds_read_b128 v[164:167], v57 offset:49152
ds_read_b128 v[168:171], v58 offset:49152
ds_read_b128 v[172:175], v59 offset:49152
s_waitcnt lgkmcnt(4)
v_dot2_f32_bf16 v28, v144, s42, v28
v_dot2_f32_bf16 v32, v144, v144, v32
v_dot2_f32_bf16 v29, v145, s42, v29
v_dot2_f32_bf16 v33, v145, v145, v33
v_dot2_f32_bf16 v30, v146, s42, v30
v_dot2_f32_bf16 v34, v146, v146, v34
v_dot2_f32_bf16 v31, v147, s42, v31
v_dot2_f32_bf16 v35, v147, v147, v35
v_dot2_f32_bf16 v28, v148, s42, v28
v_dot2_f32_bf16 v32, v148, v148, v32
v_dot2_f32_bf16 v29, v149, s42, v29
v_dot2_f32_bf16 v33, v149, v149, v33
v_dot2_f32_bf16 v30, v150, s42, v30
v_dot2_f32_bf16 v34, v150, v150, v34
v_dot2_f32_bf16 v31, v151, s42, v31
v_dot2_f32_bf16 v35, v151, v151, v35
v_dot2_f32_bf16 v28, v152, s42, v28
v_dot2_f32_bf16 v32, v152, v152, v32
v_dot2_f32_bf16 v29, v153, s42, v29
v_dot2_f32_bf16 v33, v153, v153, v33
v_dot2_f32_bf16 v30, v154, s42, v30
v_dot2_f32_bf16 v34, v154, v154, v34
v_dot2_f32_bf16 v31, v155, s42, v31
v_dot2_f32_bf16 v35, v155, v155, v35
v_dot2_f32_bf16 v28, v156, s42, v28
v_dot2_f32_bf16 v32, v156, v156, v32
v_dot2_f32_bf16 v29, v157, s42, v29
v_dot2_f32_bf16 v33, v157, v157, v33
v_dot2_f32_bf16 v30, v158, s42, v30
v_dot2_f32_bf16 v34, v158, v158, v34
v_dot2_f32_bf16 v31, v159, s42, v31
v_dot2_f32_bf16 v35, v159, v159, v35
s_waitcnt vmcnt(21)
ds_read_b128 v[176:179], v62 offset:0
ds_read_b128 v[180:183], v63 offset:0
ds_read_b128 v[184:187], v64 offset:0
ds_read_b128 v[188:191], v65 offset:0
s_waitcnt lgkmcnt(4)
v_dot2_f32_bf16 v28, v160, s42, v28
v_dot2_f32_bf16 v32, v160, v160, v32
v_dot2_f32_bf16 v29, v161, s42, v29
v_dot2_f32_bf16 v33, v161, v161, v33
v_dot2_f32_bf16 v30, v162, s42, v30
v_dot2_f32_bf16 v34, v162, v162, v34
v_dot2_f32_bf16 v31, v163, s42, v31
v_dot2_f32_bf16 v35, v163, v163, v35
v_dot2_f32_bf16 v28, v164, s42, v28
v_dot2_f32_bf16 v32, v164, v164, v32
v_dot2_f32_bf16 v29, v165, s42, v29
v_dot2_f32_bf16 v33, v165, v165, v33
v_dot2_f32_bf16 v30, v166, s42, v30
v_dot2_f32_bf16 v34, v166, v166, v34
v_dot2_f32_bf16 v31, v167, s42, v31
v_dot2_f32_bf16 v35, v167, v167, v35
v_dot2_f32_bf16 v28, v168, s42, v28
v_dot2_f32_bf16 v32, v168, v168, v32
v_dot2_f32_bf16 v29, v169, s42, v29
v_dot2_f32_bf16 v33, v169, v169, v33
v_dot2_f32_bf16 v30, v170, s42, v30
v_dot2_f32_bf16 v34, v170, v170, v34
v_dot2_f32_bf16 v31, v171, s42, v31
v_dot2_f32_bf16 v35, v171, v171, v35
v_dot2_f32_bf16 v28, v172, s42, v28
v_dot2_f32_bf16 v32, v172, v172, v32
v_dot2_f32_bf16 v29, v173, s42, v29
v_dot2_f32_bf16 v33, v173, v173, v33
v_dot2_f32_bf16 v30, v174, s42, v30
v_dot2_f32_bf16 v34, v174, v174, v34
v_dot2_f32_bf16 v31, v175, s42, v31
v_dot2_f32_bf16 v35, v175, v175, v35
s_waitcnt vmcnt(17)
ds_read_b128 v[192:195], v62 offset:16384
ds_read_b128 v[196:199], v63 offset:16384
ds_read_b128 v[200:203], v64 offset:16384
ds_read_b128 v[204:207], v65 offset:16384
s_waitcnt lgkmcnt(4)
v_dot2_f32_bf16 v28, v176, s42, v28
v_dot2_f32_bf16 v32, v176, v176, v32
v_dot2_f32_bf16 v29, v177, s42, v29
v_dot2_f32_bf16 v33, v177, v177, v33
v_dot2_f32_bf16 v30, v178, s42, v30
v_dot2_f32_bf16 v34, v178, v178, v34
v_dot2_f32_bf16 v31, v179, s42, v31
v_dot2_f32_bf16 v35, v179, v179, v35
v_dot2_f32_bf16 v28, v180, s42, v28
v_dot2_f32_bf16 v32, v180, v180, v32
v_dot2_f32_bf16 v29, v181, s42, v29
v_dot2_f32_bf16 v33, v181, v181, v33
v_dot2_f32_bf16 v30, v182, s42, v30
v_dot2_f32_bf16 v34, v182, v182, v34
v_dot2_f32_bf16 v31, v183, s42, v31
v_dot2_f32_bf16 v35, v183, v183, v35
v_dot2_f32_bf16 v28, v184, s42, v28
v_dot2_f32_bf16 v32, v184, v184, v32
v_dot2_f32_bf16 v29, v185, s42, v29
v_dot2_f32_bf16 v33, v185, v185, v33
v_dot2_f32_bf16 v30, v186, s42, v30
v_dot2_f32_bf16 v34, v186, v186, v34
v_dot2_f32_bf16 v31, v187, s42, v31
v_dot2_f32_bf16 v35, v187, v187, v35
v_dot2_f32_bf16 v28, v188, s42, v28
v_dot2_f32_bf16 v32, v188, v188, v32
v_dot2_f32_bf16 v29, v189, s42, v29
v_dot2_f32_bf16 v33, v189, v189, v33
v_dot2_f32_bf16 v30, v190, s42, v30
v_dot2_f32_bf16 v34, v190, v190, v34
v_dot2_f32_bf16 v31, v191, s42, v31
v_dot2_f32_bf16 v35, v191, v191, v35
s_waitcnt vmcnt(13)
ds_read_b128 v[208:211], v62 offset:32768
ds_read_b128 v[212:215], v63 offset:32768
ds_read_b128 v[216:219], v64 offset:32768
ds_read_b128 v[220:223], v65 offset:32768
s_waitcnt lgkmcnt(4)
v_dot2_f32_bf16 v28, v192, s42, v28
v_dot2_f32_bf16 v32, v192, v192, v32
v_dot2_f32_bf16 v29, v193, s42, v29
v_dot2_f32_bf16 v33, v193, v193, v33
v_dot2_f32_bf16 v30, v194, s42, v30
v_dot2_f32_bf16 v34, v194, v194, v34
v_dot2_f32_bf16 v31, v195, s42, v31
v_dot2_f32_bf16 v35, v195, v195, v35
v_dot2_f32_bf16 v28, v196, s42, v28
v_dot2_f32_bf16 v32, v196, v196, v32
v_dot2_f32_bf16 v29, v197, s42, v29
v_dot2_f32_bf16 v33, v197, v197, v33
v_dot2_f32_bf16 v30, v198, s42, v30
v_dot2_f32_bf16 v34, v198, v198, v34
v_dot2_f32_bf16 v31, v199, s42, v31
v_dot2_f32_bf16 v35, v199, v199, v35
v_dot2_f32_bf16 v28, v200, s42, v28
v_dot2_f32_bf16 v32, v200, v200, v32
v_dot2_f32_bf16 v29, v201, s42, v29
v_dot2_f32_bf16 v33, v201, v201, v33
v_dot2_f32_bf16 v30, v202, s42, v30
v_dot2_f32_bf16 v34, v202, v202, v34
v_dot2_f32_bf16 v31, v203, s42, v31
v_dot2_f32_bf16 v35, v203, v203, v35
v_dot2_f32_bf16 v28, v204, s42, v28
v_dot2_f32_bf16 v32, v204, v204, v32
v_dot2_f32_bf16 v29, v205, s42, v29
v_dot2_f32_bf16 v33, v205, v205, v33
v_dot2_f32_bf16 v30, v206, s42, v30
v_dot2_f32_bf16 v34, v206, v206, v34
v_dot2_f32_bf16 v31, v207, s42, v31
v_dot2_f32_bf16 v35, v207, v207, v35
s_waitcnt vmcnt(9)
ds_read_b128 v[224:227], v62 offset:49152
ds_read_b128 v[228:231], v63 offset:49152
ds_read_b128 v[232:235], v64 offset:49152
ds_read_b128 v[236:239], v65 offset:49152
s_waitcnt lgkmcnt(4)
v_dot2_f32_bf16 v28, v208, s42, v28
v_dot2_f32_bf16 v32, v208, v208, v32
v_dot2_f32_bf16 v29, v209, s42, v29
v_dot2_f32_bf16 v33, v209, v209, v33
v_dot2_f32_bf16 v30, v210, s42, v30
v_dot2_f32_bf16 v34, v210, v210, v34
v_dot2_f32_bf16 v31, v211, s42, v31
v_dot2_f32_bf16 v35, v211, v211, v35
v_dot2_f32_bf16 v28, v212, s42, v28
v_dot2_f32_bf16 v32, v212, v212, v32
v_dot2_f32_bf16 v29, v213, s42, v29
v_dot2_f32_bf16 v33, v213, v213, v33
v_dot2_f32_bf16 v30, v214, s42, v30
v_dot2_f32_bf16 v34, v214, v214, v34
v_dot2_f32_bf16 v31, v215, s42, v31
v_dot2_f32_bf16 v35, v215, v215, v35
v_dot2_f32_bf16 v28, v216, s42, v28
v_dot2_f32_bf16 v32, v216, v216, v32
v_dot2_f32_bf16 v29, v217, s42, v29
v_dot2_f32_bf16 v33, v217, v217, v33
v_dot2_f32_bf16 v30, v218, s42, v30
v_dot2_f32_bf16 v34, v218, v218, v34
v_dot2_f32_bf16 v31, v219, s42, v31
v_dot2_f32_bf16 v35, v219, v219, v35
v_dot2_f32_bf16 v28, v220, s42, v28
v_dot2_f32_bf16 v32, v220, v220, v32
v_dot2_f32_bf16 v29, v221, s42, v29
v_dot2_f32_bf16 v33, v221, v221, v33
v_dot2_f32_bf16 v30, v222, s42, v30
v_dot2_f32_bf16 v34, v222, v222, v34
v_dot2_f32_bf16 v31, v223, s42, v31
v_dot2_f32_bf16 v35, v223, v223, v35
s_waitcnt vmcnt(5)
ds_read_b128 v[240:243], v66 offset:0
ds_read_b128 v[244:247], v67 offset:0
ds_read_b128 v[248:251], v68 offset:0
ds_read_b128 v[252:255], v69 offset:0
s_waitcnt lgkmcnt(4)
v_dot2_f32_bf16 v28, v224, s42, v28
v_dot2_f32_bf16 v32, v224, v224, v32
v_dot2_f32_bf16 v29, v225, s42, v29
v_dot2_f32_bf16 v33, v225, v225, v33
v_dot2_f32_bf16 v30, v226, s42, v30
v_dot2_f32_bf16 v34, v226, v226, v34
v_dot2_f32_bf16 v31, v227, s42, v31
v_dot2_f32_bf16 v35, v227, v227, v35
v_dot2_f32_bf16 v28, v228, s42, v28
v_dot2_f32_bf16 v32, v228, v228, v32
v_dot2_f32_bf16 v29, v229, s42, v29
v_dot2_f32_bf16 v33, v229, v229, v33
v_dot2_f32_bf16 v30, v230, s42, v30
v_dot2_f32_bf16 v34, v230, v230, v34
v_dot2_f32_bf16 v31, v231, s42, v31
v_dot2_f32_bf16 v35, v231, v231, v35
v_dot2_f32_bf16 v28, v232, s42, v28
v_dot2_f32_bf16 v32, v232, v232, v32
v_dot2_f32_bf16 v29, v233, s42, v29
v_dot2_f32_bf16 v33, v233, v233, v33
v_dot2_f32_bf16 v30, v234, s42, v30
v_dot2_f32_bf16 v34, v234, v234, v34
v_dot2_f32_bf16 v31, v235, s42, v31
v_dot2_f32_bf16 v35, v235, v235, v35
v_dot2_f32_bf16 v28, v236, s42, v28
v_dot2_f32_bf16 v32, v236, v236, v32
v_dot2_f32_bf16 v29, v237, s42, v29
v_dot2_f32_bf16 v33, v237, v237, v33
v_dot2_f32_bf16 v30, v238, s42, v30
v_dot2_f32_bf16 v34, v238, v238, v34
v_dot2_f32_bf16 v31, v239, s42, v31
v_dot2_f32_bf16 v35, v239, v239, v35
s_waitcnt lgkmcnt(0)
v_dot2_f32_bf16 v28, v240, s42, v28
v_dot2_f32_bf16 v32, v240, v240, v32
v_dot2_f32_bf16 v29, v241, s42, v29
v_dot2_f32_bf16 v33, v241, v241, v33
v_dot2_f32_bf16 v30, v242, s42, v30
v_dot2_f32_bf16 v34, v242, v242, v34
v_dot2_f32_bf16 v31, v243, s42, v31
v_dot2_f32_bf16 v35, v243, v243, v35
v_dot2_f32_bf16 v28, v244, s42, v28
v_dot2_f32_bf16 v32, v244, v244, v32
v_dot2_f32_bf16 v29, v245, s42, v29
v_dot2_f32_bf16 v33, v245, v245, v33
v_dot2_f32_bf16 v30, v246, s42, v30
v_dot2_f32_bf16 v34, v246, v246, v34
v_dot2_f32_bf16 v31, v247, s42, v31
v_dot2_f32_bf16 v35, v247, v247, v35
v_dot2_f32_bf16 v28, v248, s42, v28
v_dot2_f32_bf16 v32, v248, v248, v32
v_dot2_f32_bf16 v29, v249, s42, v29
v_dot2_f32_bf16 v33, v249, v249, v33
v_dot2_f32_bf16 v30, v250, s42, v30
v_dot2_f32_bf16 v34, v250, v250, v34
v_dot2_f32_bf16 v31, v251, s42, v31
v_dot2_f32_bf16 v35, v251, v251, v35
v_dot2_f32_bf16 v28, v252, s42, v28
v_dot2_f32_bf16 v32, v252, v252, v32
v_dot2_f32_bf16 v29, v253, s42, v29
v_dot2_f32_bf16 v33, v253, v253, v33
v_dot2_f32_bf16 v30, v254, s42, v30
v_dot2_f32_bf16 v34, v254, v254, v34
v_dot2_f32_bf16 v31, v255, s42, v31
v_dot2_f32_bf16 v35, v255, v255, v35
s_nop 1
v_pk_add_f32 v[28:29], v[28:29], v[30:31]
v_pk_add_f32 v[32:33], v[32:33], v[34:35]
v_add_f32 v28, v28, v29
v_add_f32 v32, v32, v33
v_mov_b32 v29, v28
v_mov_b32 v33, v32
s_nop 0
v_permlane32_swap_b32 v28, v29
v_permlane32_swap_b32 v32, v33
v_add_f32 v28, v28, v29
v_add_f32 v32, v32, v33
v_mul_f32 v28, 0x3ae38e39, v28
v_mul_f32 v32, 0x3ae38e39, v32
v_fma_f32 v32, -v28, v28, v32
v_max_f32 v32, 0, v32
v_cvt_pk_bf16_f32 v28, v32, v28
v_lshlrev_b32 v32, 16, v28
v_and_b32 v28, 0xffff0000, v28
v_add_f32 v32, 0x3727c5ac, v32
v_cvt_pk_bf16_f32 v32, v32, v32
v_lshlrev_b32 v32, 16, v32
v_sqrt_f32 v32, v32
s_nop 0
v_cvt_pk_bf16_f32 v32, v32, v32
v_lshlrev_b32 v32, 16, v32
v_rcp_f32 v22, v32
s_nop 0
v_mul_f32 v60, -v28, v22
v_mov_b32 v23, v22
v_mov_b32 v61, v60
v_lshlrev_b32 v24, 16, v112
v_and_b32 v25, 0xffff0000, v112
v_lshlrev_b32 v26, 16, v113
v_and_b32 v27, 0xffff0000, v113
v_lshlrev_b32 v28, 16, v114
v_and_b32 v29, 0xffff0000, v114
v_lshlrev_b32 v30, 16, v115
v_and_b32 v31, 0xffff0000, v115
v_pk_fma_f32 v[24:25], v[24:25], v[22:23], v[60:61]
v_pk_fma_f32 v[26:27], v[26:27], v[22:23], v[60:61]
v_pk_fma_f32 v[28:29], v[28:29], v[22:23], v[60:61]
v_pk_fma_f32 v[30:31], v[30:31], v[22:23], v[60:61]
v_cvt_pk_bf16_f32 v112, v24, v25
v_cvt_pk_bf16_f32 v113, v26, v27
v_cvt_pk_bf16_f32 v114, v28, v29
v_cvt_pk_bf16_f32 v115, v30, v31
s_add_u32 m0, s40, 0
s_nop 0
buffer_load_dwordx4 v3, s[20:23], s48 offen offset:0 lds
v_lshlrev_b32 v24, 16, v116
v_and_b32 v25, 0xffff0000, v116
v_lshlrev_b32 v26, 16, v117
v_and_b32 v27, 0xffff0000, v117
v_lshlrev_b32 v28, 16, v118
v_and_b32 v29, 0xffff0000, v118
v_lshlrev_b32 v30, 16, v119
v_and_b32 v31, 0xffff0000, v119
v_pk_fma_f32 v[24:25], v[24:25], v[22:23], v[60:61]
v_pk_fma_f32 v[26:27], v[26:27], v[22:23], v[60:61]
v_pk_fma_f32 v[28:29], v[28:29], v[22:23], v[60:61]
v_pk_fma_f32 v[30:31], v[30:31], v[22:23], v[60:61]
v_cvt_pk_bf16_f32 v116, v24, v25
v_cvt_pk_bf16_f32 v117, v26, v27
v_cvt_pk_bf16_f32 v118, v28, v29
v_cvt_pk_bf16_f32 v119, v30, v31
s_add_u32 m0, s40, 4096
s_add_u32 s41, s47, 221184
buffer_load_dwordx4 v2, s[12:15], s41 offen offset:0 lds
v_lshlrev_b32 v24, 16, v120
v_and_b32 v25, 0xffff0000, v120
v_lshlrev_b32 v26, 16, v121
v_and_b32 v27, 0xffff0000, v121
v_lshlrev_b32 v28, 16, v122
v_and_b32 v29, 0xffff0000, v122
v_lshlrev_b32 v30, 16, v123
v_and_b32 v31, 0xffff0000, v123
v_pk_fma_f32 v[24:25], v[24:25], v[22:23], v[60:61]
v_pk_fma_f32 v[26:27], v[26:27], v[22:23], v[60:61]
v_pk_fma_f32 v[28:29], v[28:29], v[22:23], v[60:61]
v_pk_fma_f32 v[30:31], v[30:31], v[22:23], v[60:61]
v_cvt_pk_bf16_f32 v120, v24, v25
v_cvt_pk_bf16_f32 v121, v26, v27
v_cvt_pk_bf16_f32 v122, v28, v29
v_cvt_pk_bf16_f32 v123, v30, v31
s_add_u32 m0, s40, 8192
s_add_u32 s41, s47, 276480
buffer_load_dwordx4 v2, s[12:15], s41 offen offset:0 lds
v_lshlrev_b32 v24, 16, v124
v_and_b32 v25, 0xffff0000, v124
v_lshlrev_b32 v26, 16, v125
v_and_b32 v27, 0xffff0000, v125
v_lshlrev_b32 v28, 16, v126
v_and_b32 v29, 0xffff0000, v126
v_lshlrev_b32 v30, 16, v127
v_and_b32 v31, 0xffff0000, v127
v_pk_fma_f32 v[24:25], v[24:25], v[22:23], v[60:61]
v_pk_fma_f32 v[26:27], v[26:27], v[22:23], v[60:61]
v_pk_fma_f32 v[28:29], v[28:29], v[22:23], v[60:61]
v_pk_fma_f32 v[30:31], v[30:31], v[22:23], v[60:61]
v_cvt_pk_bf16_f32 v124, v24, v25
v_cvt_pk_bf16_f32 v125, v26, v27
v_cvt_pk_bf16_f32 v126, v28, v29
v_cvt_pk_bf16_f32 v127, v30, v31
s_add_u32 m0, s40, 12288
s_nop 0
buffer_load_dwordx4 v3, s[20:23], s49 offen offset:0 lds
v_lshlrev_b32 v24, 16, v128
v_and_b32 v25, 0xffff0000, v128
v_lshlrev_b32 v26, 16, v129
v_and_b32 v27, 0xffff0000, v129
v_lshlrev_b32 v28, 16, v130
v_and_b32 v29, 0xffff0000, v130
v_lshlrev_b32 v30, 16, v131
v_and_b32 v31, 0xffff0000, v131
v_pk_fma_f32 v[24:25], v[24:25], v[22:23], v[60:61]
v_pk_fma_f32 v[26:27], v[26:27], v[22:23], v[60:61]
v_pk_fma_f32 v[28:29], v[28:29], v[22:23], v[60:61]
v_pk_fma_f32 v[30:31], v[30:31], v[22:23], v[60:61]
v_cvt_pk_bf16_f32 v128, v24, v25
v_cvt_pk_bf16_f32 v129, v26, v27
v_cvt_pk_bf16_f32 v130, v28, v29
v_cvt_pk_bf16_f32 v131, v30, v31
s_add_u32 m0, s40, 16384
s_add_u32 s41, s47, 331776
buffer_load_dwordx4 v2, s[12:15], s41 offen offset:0 lds
v_lshlrev_b32 v24, 16, v132
v_and_b32 v25, 0xffff0000, v132
v_lshlrev_b32 v26, 16, v133
v_and_b32 v27, 0xffff0000, v133
v_lshlrev_b32 v28, 16, v134
v_and_b32 v29, 0xffff0000, v134
v_lshlrev_b32 v30, 16, v135
v_and_b32 v31, 0xffff0000, v135
v_pk_fma_f32 v[24:25], v[24:25], v[22:23], v[60:61]
v_pk_fma_f32 v[26:27], v[26:27], v[22:23], v[60:61]
v_pk_fma_f32 v[28:29], v[28:29], v[22:23], v[60:61]
v_pk_fma_f32 v[30:31], v[30:31], v[22:23], v[60:61]
v_cvt_pk_bf16_f32 v132, v24, v25
v_cvt_pk_bf16_f32 v133, v26, v27
v_cvt_pk_bf16_f32 v134, v28, v29
v_cvt_pk_bf16_f32 v135, v30, v31
s_add_u32 m0, s40, 20480
s_add_u32 s41, s47, 387072
buffer_load_dwordx4 v2, s[12:15], s41 offen offset:0 lds
v_lshlrev_b32 v24, 16, v136
v_and_b32 v25, 0xffff0000, v136
v_lshlrev_b32 v26, 16, v137
v_and_b32 v27, 0xffff0000, v137
v_lshlrev_b32 v28, 16, v138
v_and_b32 v29, 0xffff0000, v138
v_lshlrev_b32 v30, 16, v139
v_and_b32 v31, 0xffff0000, v139
v_pk_fma_f32 v[24:25], v[24:25], v[22:23], v[60:61]
v_pk_fma_f32 v[26:27], v[26:27], v[22:23], v[60:61]
v_pk_fma_f32 v[28:29], v[28:29], v[22:23], v[60:61]
v_pk_fma_f32 v[30:31], v[30:31], v[22:23], v[60:61]
v_cvt_pk_bf16_f32 v136, v24, v25
v_cvt_pk_bf16_f32 v137, v26, v27
v_cvt_pk_bf16_f32 v138, v28, v29
v_cvt_pk_bf16_f32 v139, v30, v31
s_add_u32 m0, s40, 24576
s_nop 0
buffer_load_dwordx4 v3, s[20:23], s50 offen offset:0 lds
v_lshlrev_b32 v24, 16, v140
v_and_b32 v25, 0xffff0000, v140
v_lshlrev_b32 v26, 16, v141
v_and_b32 v27, 0xffff0000, v141
v_lshlrev_b32 v28, 16, v142
v_and_b32 v29, 0xffff0000, v142
v_lshlrev_b32 v30, 16, v143
v_and_b32 v31, 0xffff0000, v143
v_pk_fma_f32 v[24:25], v[24:25], v[22:23], v[60:61]
v_pk_fma_f32 v[26:27], v[26:27], v[22:23], v[60:61]
v_pk_fma_f32 v[28:29], v[28:29], v[22:23], v[60:61]
v_pk_fma_f32 v[30:31], v[30:31], v[22:23], v[60:61]
v_cvt_pk_bf16_f32 v140, v24, v25
v_cvt_pk_bf16_f32 v141, v26, v27
v_cvt_pk_bf16_f32 v142, v28, v29
v_cvt_pk_bf16_f32 v143, v30, v31
s_add_u32 m0, s40, 28672
s_add_u32 s41, s47, 442368
buffer_load_dwordx4 v2, s[12:15], s41 offen offset:0 lds
v_lshlrev_b32 v24, 16, v144
v_and_b32 v25, 0xffff0000, v144
v_lshlrev_b32 v26, 16, v145
v_and_b32 v27, 0xffff0000, v145
v_lshlrev_b32 v28, 16, v146
v_and_b32 v29, 0xffff0000, v146
v_lshlrev_b32 v30, 16, v147
v_and_b32 v31, 0xffff0000, v147
v_pk_fma_f32 v[24:25], v[24:25], v[22:23], v[60:61]
v_pk_fma_f32 v[26:27], v[26:27], v[22:23], v[60:61]
v_pk_fma_f32 v[28:29], v[28:29], v[22:23], v[60:61]
v_pk_fma_f32 v[30:31], v[30:31], v[22:23], v[60:61]
v_cvt_pk_bf16_f32 v144, v24, v25
v_cvt_pk_bf16_f32 v145, v26, v27
v_cvt_pk_bf16_f32 v146, v28, v29
v_cvt_pk_bf16_f32 v147, v30, v31
s_add_u32 m0, s40, 32768
s_add_u32 s41, s47, 497664
buffer_load_dwordx4 v2, s[12:15], s41 offen offset:0 lds
v_lshlrev_b32 v24, 16, v148
v_and_b32 v25, 0xffff0000, v148
v_lshlrev_b32 v26, 16, v149
v_and_b32 v27, 0xffff0000, v149
v_lshlrev_b32 v28, 16, v150
v_and_b32 v29, 0xffff0000, v150
v_lshlrev_b32 v30, 16, v151
v_and_b32 v31, 0xffff0000, v151
v_pk_fma_f32 v[24:25], v[24:25], v[22:23], v[60:61]
v_pk_fma_f32 v[26:27], v[26:27], v[22:23], v[60:61]
v_pk_fma_f32 v[28:29], v[28:29], v[22:23], v[60:61]
v_pk_fma_f32 v[30:31], v[30:31], v[22:23], v[60:61]
v_cvt_pk_bf16_f32 v148, v24, v25
v_cvt_pk_bf16_f32 v149, v26, v27
v_cvt_pk_bf16_f32 v150, v28, v29
v_cvt_pk_bf16_f32 v151, v30, v31
s_add_u32 m0, s40, 36864
s_nop 0
buffer_load_dwordx4 v3, s[20:23], s51 offen offset:0 lds
v_lshlrev_b32 v24, 16, v152
v_and_b32 v25, 0xffff0000, v152
v_lshlrev_b32 v26, 16, v153
v_and_b32 v27, 0xffff0000, v153
v_lshlrev_b32 v28, 16, v154
v_and_b32 v29, 0xffff0000, v154
v_lshlrev_b32 v30, 16, v155
v_and_b32 v31, 0xffff0000, v155
v_pk_fma_f32 v[24:25], v[24:25], v[22:23], v[60:61]
v_pk_fma_f32 v[26:27], v[26:27], v[22:23], v[60:61]
v_pk_fma_f32 v[28:29], v[28:29], v[22:23], v[60:61]
v_pk_fma_f32 v[30:31], v[30:31], v[22:23], v[60:61]
v_cvt_pk_bf16_f32 v152, v24, v25
v_cvt_pk_bf16_f32 v153, v26, v27
v_cvt_pk_bf16_f32 v154, v28, v29
v_cvt_pk_bf16_f32 v155, v30, v31
s_add_u32 m0, s40, 40960
s_add_u32 s41, s47, 552960
buffer_load_dwordx4 v2, s[12:15], s41 offen offset:0 lds
v_lshlrev_b32 v24, 16, v156
v_and_b32 v25, 0xffff0000, v156
v_lshlrev_b32 v26, 16, v157
v_and_b32 v27, 0xffff0000, v157
v_lshlrev_b32 v28, 16, v158
v_and_b32 v29, 0xffff0000, v158
v_lshlrev_b32 v30, 16, v159
v_and_b32 v31, 0xffff0000, v159
v_pk_fma_f32 v[24:25], v[24:25], v[22:23], v[60:61]
v_pk_fma_f32 v[26:27], v[26:27], v[22:23], v[60:61]
v_pk_fma_f32 v[28:29], v[28:29], v[22:23], v[60:61]
v_pk_fma_f32 v[30:31], v[30:31], v[22:23], v[60:61]
v_cvt_pk_bf16_f32 v156, v24, v25
v_cvt_pk_bf16_f32 v157, v26, v27
v_cvt_pk_bf16_f32 v158, v28, v29
v_cvt_pk_bf16_f32 v159, v30, v31
s_add_u32 m0, s40, 45056
s_add_u32 s41, s47, 608256
buffer_load_dwordx4 v2, s[12:15], s41 offen offset:0 lds
v_lshlrev_b32 v24, 16, v160
v_and_b32 v25, 0xffff0000, v160
v_lshlrev_b32 v26, 16, v161
v_and_b32 v27, 0xffff0000, v161
v_lshlrev_b32 v28, 16, v162
v_and_b32 v29, 0xffff0000, v162
v_lshlrev_b32 v30, 16, v163
v_and_b32 v31, 0xffff0000, v163
v_pk_fma_f32 v[24:25], v[24:25], v[22:23], v[60:61]
v_pk_fma_f32 v[26:27], v[26:27], v[22:23], v[60:61]
v_pk_fma_f32 v[28:29], v[28:29], v[22:23], v[60:61]
v_pk_fma_f32 v[30:31], v[30:31], v[22:23], v[60:61]
v_cvt_pk_bf16_f32 v160, v24, v25
v_cvt_pk_bf16_f32 v161, v26, v27
v_cvt_pk_bf16_f32 v162, v28, v29
v_cvt_pk_bf16_f32 v163, v30, v31
s_add_u32 m0, s40, 49152
s_nop 0
buffer_load_dwordx4 v3, s[20:23], s52 offen offset:0 lds
v_lshlrev_b32 v24, 16, v164
v_and_b32 v25, 0xffff0000, v164
v_lshlrev_b32 v26, 16, v165
v_and_b32 v27, 0xffff0000, v165
v_lshlrev_b32 v28, 16, v166
v_and_b32 v29, 0xffff0000, v166
v_lshlrev_b32 v30, 16, v167
v_and_b32 v31, 0xffff0000, v167
v_pk_fma_f32 v[24:25], v[24:25], v[22:23], v[60:61]
v_pk_fma_f32 v[26:27], v[26:27], v[22:23], v[60:61]
v_pk_fma_f32 v[28:29], v[28:29], v[22:23], v[60:61]
v_pk_fma_f32 v[30:31], v[30:31], v[22:23], v[60:61]
v_cvt_pk_bf16_f32 v164, v24, v25
v_cvt_pk_bf16_f32 v165, v26, v27
v_cvt_pk_bf16_f32 v166, v28, v29
v_cvt_pk_bf16_f32 v167, v30, v31
s_add_u32 m0, s40, 53248
s_add_u32 s41, s47, 663552
buffer_load_dwordx4 v2, s[12:15], s41 offen offset:0 lds
s_waitcnt vmcnt(16)
s_barrier
ds_read_b64_tr_b16 v[88:89], v42 offset:16384
ds_read_b64_tr_b16 v[90:91], v42 offset:17408
ds_read_b64_tr_b16 v[92:93], v45 offset:16384
ds_read_b64_tr_b16 v[94:95], v45 offset:17408
ds_read_b64_tr_b16 v[96:97], v48 offset:16384
ds_read_b64_tr_b16 v[98:99], v48 offset:17408
ds_read_b64_tr_b16 v[100:101], v51 offset:16384
ds_read_b64_tr_b16 v[102:103], v51 offset:17408
ds_read_b64_tr_b16 v[104:105], v42 offset:20480
ds_read_b64_tr_b16 v[106:107], v42 offset:21504
ds_read_b64_tr_b16 v[108:109], v45 offset:20480
ds_read_b64_tr_b16 v[110:111], v45 offset:21504
s_waitcnt lgkmcnt(8)
v_mfma_f32_32x32x16_bf16 a[192:207], v[112:115], v[88:91], a[192:207]
ds_read_b64_tr_b16 v[88:89], v48 offset:20480
ds_read_b64_tr_b16 v[90:91], v48 offset:21504
v_lshlrev_b32 v24, 16, v168
v_and_b32 v25, 0xffff0000, v168
v_lshlrev_b32 v26, 16, v169
v_and_b32 v27, 0xffff0000, v169
v_mfma_f32_32x32x16_bf16 a[208:223], v[112:115], v[92:95], 0
ds_read_b64_tr_b16 v[92:93], v51 offset:20480
ds_read_b64_tr_b16 v[94:95], v51 offset:21504
v_lshlrev_b32 v28, 16, v170
s_add_u32 m0, s40, 57344
s_add_u32 s41, s47, 718848
s_waitcnt lgkmcnt(8)
v_mfma_f32_32x32x16_bf16 a[224:239], v[112:115], v[96:99], a[224:239]
s_waitcnt vmcnt(14)
s_barrier
ds_read_b64_tr_b16 v[96:97], v42 offset:24576
ds_read_b64_tr_b16 v[98:99], v42 offset:25600
buffer_load_dwordx4 v2, s[12:15], s41 offen offset:0 lds
v_and_b32 v29, 0xffff0000, v170
v_mfma_f32_32x32x16_bf16 a[240:255], v[100:103], v[112:115], a[240:255]
ds_read_b64_tr_b16 v[100:101], v45 offset:24576
ds_read_b64_tr_b16 v[102:103], v45 offset:25600
v_lshlrev_b32 v30, 16, v171
v_and_b32 v31, 0xffff0000, v171
s_add_u32 m0, s40, 61440
s_waitcnt lgkmcnt(8)
v_mfma_f32_32x32x16_bf16 a[192:207], v[116:119], v[104:107], a[192:207]
ds_read_b64_tr_b16 v[104:105], v48 offset:24576
ds_read_b64_tr_b16 v[106:107], v48 offset:25600
buffer_load_dwordx4 v3, s[20:23], s53 offen offset:0 lds
v_fma_f32 v24, v24, v22, v60
v_fma_f32 v25, v25, v22, v60
v_fma_f32 v26, v26, v22, v60
v_mfma_f32_32x32x16_bf16 a[208:223], v[116:119], v[108:111], a[208:223]
ds_read_b64_tr_b16 v[108:109], v51 offset:24576
ds_read_b64_tr_b16 v[110:111], v51 offset:25600
v_fma_f32 v27, v27, v22, v60
s_add_u32 m0, s40, 65536
s_add_u32 s41, s47, 774144
s_waitcnt lgkmcnt(8)
v_mfma_f32_32x32x16_bf16 a[224:239], v[116:119], v[88:91], a[224:239]
ds_read_b64_tr_b16 v[88:89], v42 offset:28672
ds_read_b64_tr_b16 v[90:91], v42 offset:29696
buffer_load_dwordx4 v2, s[12:15], s41 offen offset:0 lds
v_fma_f32 v28, v28, v22, v60
v_fma_f32 v29, v29, v22, v60
v_fma_f32 v30, v30, v22, v60
v_mfma_f32_32x32x16_bf16 a[240:255], v[92:95], v[116:119], a[240:255]
ds_read_b64_tr_b16 v[92:93], v45 offset:28672
ds_read_b64_tr_b16 v[94:95], v45 offset:29696
v_fma_f32 v31, v31, v22, v60
s_add_u32 m0, s40, 69632
s_add_u32 s41, s47, 829440
s_waitcnt lgkmcnt(8)
v_mfma_f32_32x32x16_bf16 a[192:207], v[120:123], v[96:99], a[192:207]
ds_read_b64_tr_b16 v[96:97], v48 offset:28672
ds_read_b64_tr_b16 v[98:99], v48 offset:29696
buffer_load_dwordx4 v2, s[12:15], s41 offen offset:0 lds
v_cvt_pk_bf16_f32 v168, v24, v25
v_cvt_pk_bf16_f32 v169, v26, v27
v_cvt_pk_bf16_f32 v170, v28, v29
v_mfma_f32_32x32x16_bf16 a[208:223], v[120:123], v[100:103], a[208:223]
ds_read_b64_tr_b16 v[100:101], v51 offset:28672
ds_read_b64_tr_b16 v[102:103], v51 offset:29696
v_cvt_pk_bf16_f32 v171, v30, v31
v_lshlrev_b32 v24, 16, v172
s_add_u32 m0, s40, 73728
s_waitcnt lgkmcnt(8)
v_mfma_f32_32x32x16_bf16 a[224:239], v[120:123], v[104:107], a[224:239]
s_waitcnt vmcnt(16)
s_barrier
ds_read_b64_tr_b16 v[104:105], v8 offset:0
ds_read_b64_tr_b16 v[106:107], v8 offset:512
buffer_load_dwordx4 v3, s[20:23], s54 offen offset:0 lds
v_and_b32 v25, 0xffff0000, v172
v_mfma_f32_32x32x16_bf16 a[240:255], v[108:111], v[120:123], a[240:255]
ds_read_b64_tr_b16 v[108:109], v11 offset:0
ds_read_b64_tr_b16 v[110:111], v11 offset:512
v_lshlrev_b32 v26, 16, v173
s_add_u32 m0, s40, 77824
s_add_u32 s41, s47, 884736
s_waitcnt lgkmcnt(8)
v_mfma_f32_32x32x16_bf16 a[192:207], v[124:127], v[88:91], a[192:207]
ds_read_b64_tr_b16 v[88:89], v8 offset:2048
ds_read_b64_tr_b16 v[90:91], v8 offset:2560
buffer_load_dwordx4 v2, s[12:15], s41 offen offset:0 lds
v_and_b32 v27, 0xffff0000, v173
v_lshlrev_b32 v28, 16, v174
v_and_b32 v29, 0xffff0000, v174
v_mfma_f32_32x32x16_bf16 a[208:223], v[124:127], v[92:95], a[208:223]
ds_read_b64_tr_b16 v[92:93], v11 offset:2048
ds_read_b64_tr_b16 v[94:95], v11 offset:2560
v_lshlrev_b32 v30, 16, v175
s_add_u32 m0, s40, 81920
s_add_u32 s41, s47, 940032
s_waitcnt lgkmcnt(8)
v_mfma_f32_32x32x16_bf16 a[224:239], v[124:127], v[96:99], a[224:239]
ds_read_b64_tr_b16 v[96:97], v40 offset:4096
ds_read_b64_tr_b16 v[98:99], v40 offset:5120
buffer_load_dwordx4 v2, s[12:15], s41 offen offset:0 lds
v_and_b32 v31, 0xffff0000, v175
v_fma_f32 v24, v24, v22, v60
v_fma_f32 v25, v25, v22, v60
v_mfma_f32_32x32x16_bf16 a[240:255], v[100:103], v[124:127], a[240:255]
ds_read_b64_tr_b16 v[100:101], v43 offset:4096
ds_read_b64_tr_b16 v[102:103], v43 offset:5120
v_fma_f32 v26, v26, v22, v60
v_fma_f32 v27, v27, v22, v60
s_add_u32 m0, s40, 86016
s_waitcnt lgkmcnt(8)
v_mfma_f32_32x32x16_bf16 a[0:15], v[104:107], v[112:115], 0
ds_read_b64_tr_b16 v[104:105], v46 offset:4096
ds_read_b64_tr_b16 v[106:107], v46 offset:5120
buffer_load_dwordx4 v3, s[20:23], s55 offen offset:0 lds
v_fma_f32 v28, v28, v22, v60
v_fma_f32 v29, v29, v22, v60
v_fma_f32 v30, v30, v22, v60
v_mfma_f32_32x32x16_bf16 a[16:31], v[108:111], v[112:115], 0
ds_read_b64_tr_b16 v[108:109], v49 offset:4096
ds_read_b64_tr_b16 v[110:111], v49 offset:5120
v_fma_f32 v31, v31, v22, v60
s_add_u32 m0, s40, 90112
s_add_u32 s41, s47, 995328
s_waitcnt lgkmcnt(8)
v_mfma_f32_32x32x16_bf16 a[32:47], v[88:91], v[112:115], 0
s_waitcnt vmcnt(18)
s_barrier
ds_read_b64_tr_b16 v[88:89], v40 offset:8192
ds_read_b64_tr_b16 v[90:91], v40 offset:9216
buffer_load_dwordx4 v2, s[12:15], s41 offen offset:0 lds
v_cvt_pk_bf16_f32 v172, v24, v25
v_mfma_f32_32x32x16_bf16 a[48:63], v[92:95], v[112:115], 0
ds_read_b64_tr_b16 v[92:93], v43 offset:8192
ds_read_b64_tr_b16 v[94:95], v43 offset:9216
v_cvt_pk_bf16_f32 v173, v26, v27
s_add_u32 m0, s40, 94208
s_add_u32 s41, s47, 1050624
s_waitcnt lgkmcnt(8)
v_mfma_f32_32x32x16_bf16 a[192:207], v[128:131], v[96:99], a[192:207]
ds_read_b64_tr_b16 v[96:97], v46 offset:8192
ds_read_b64_tr_b16 v[98:99], v46 offset:9216
buffer_load_dwordx4 v2, s[12:15], s41 offen offset:0 lds
v_cvt_pk_bf16_f32 v174, v28, v29
v_cvt_pk_bf16_f32 v175, v30, v31
v_lshlrev_b32 v24, 16, v176
v_mfma_f32_32x32x16_bf16 a[208:223], v[128:131], v[100:103], a[208:223]
ds_read_b64_tr_b16 v[100:101], v49 offset:8192
ds_read_b64_tr_b16 v[102:103], v49 offset:9216
v_and_b32 v25, 0xffff0000, v176
v_lshlrev_b32 v26, 16, v177
s_add_u32 m0, s40, 98304
s_waitcnt lgkmcnt(8)
v_mfma_f32_32x32x16_bf16 a[224:239], v[128:131], v[104:107], a[224:239]
ds_read_b64_tr_b16 v[104:105], v8 offset:12288
ds_read_b64_tr_b16 v[106:107], v8 offset:12800
buffer_load_dwordx4 v3, s[20:23], s56 offen offset:0 lds
v_and_b32 v27, 0xffff0000, v177
v_lshlrev_b32 v28, 16, v178
v_and_b32 v29, 0xffff0000, v178
v_mfma_f32_32x32x16_bf16 a[240:255], v[108:111], v[128:131], a[240:255]
ds_read_b64_tr_b16 v[108:109], v11 offset:12288
ds_read_b64_tr_b16 v[110:111], v11 offset:12800
v_lshlrev_b32 v30, 16, v179
s_add_u32 m0, s40, 102400
s_add_u32 s41, s100, 0
s_waitcnt lgkmcnt(8)
v_mfma_f32_32x32x16_bf16 a[192:207], v[132:135], v[88:91], a[192:207]
ds_read_b64_tr_b16 v[88:89], v8 offset:14336
ds_read_b64_tr_b16 v[90:91], v8 offset:14848
buffer_load_dwordx4 v2, s[12:15], s41 offen offset:0 lds
v_and_b32 v31, 0xffff0000, v179
v_fma_f32 v24, v24, v22, v60
v_fma_f32 v25, v25, v22, v60
v_mfma_f32_32x32x16_bf16 a[208:223], v[132:135], v[92:95], a[208:223]
ds_read_b64_tr_b16 v[92:93], v11 offset:14336
ds_read_b64_tr_b16 v[94:95], v11 offset:14848
v_fma_f32 v26, v26, v22, v60
s_add_u32 m0, s40, 106496
s_add_u32 s41, s100, 55296
s_waitcnt lgkmcnt(8)
v_mfma_f32_32x32x16_bf16 a[224:239], v[132:135], v[96:99], a[224:239]
s_waitcnt vmcnt(20)
s_barrier
ds_read_b64_tr_b16 v[96:97], v40 offset:16384
ds_read_b64_tr_b16 v[98:99], v40 offset:17408
buffer_load_dwordx4 v2, s[12:15], s41 offen offset:0 lds
v_fma_f32 v27, v27, v22, v60
v_mfma_f32_32x32x16_bf16 a[240:255], v[100:103], v[132:135], a[240:255]
ds_read_b64_tr_b16 v[100:101], v43 offset:16384
ds_read_b64_tr_b16 v[102:103], v43 offset:17408
v_fma_f32 v28, v28, v22, v60
v_fma_f32 v29, v29, v22, v60
s_add_u32 m0, s40, 110592
s_waitcnt lgkmcnt(8)
v_mfma_f32_32x32x16_bf16 a[0:15], v[104:107], v[116:119], a[0:15]
ds_read_b64_tr_b16 v[104:105], v46 offset:16384
ds_read_b64_tr_b16 v[106:107], v46 offset:17408
buffer_load_dwordx4 v3, s[20:23], s57 offen offset:0 lds
v_fma_f32 v30, v30, v22, v60
v_fma_f32 v31, v31, v22, v60
v_cvt_pk_bf16_f32 v176, v24, v25
v_mfma_f32_32x32x16_bf16 a[16:31], v[108:111], v[116:119], a[16:31]
ds_read_b64_tr_b16 v[108:109], v49 offset:16384
ds_read_b64_tr_b16 v[110:111], v49 offset:17408
v_cvt_pk_bf16_f32 v177, v26, v27
s_add_u32 m0, s40, 114688
s_add_u32 s41, s100, 110592
s_waitcnt lgkmcnt(8)
v_mfma_f32_32x32x16_bf16 a[32:47], v[88:91], v[116:119], a[32:47]
ds_read_b64_tr_b16 v[88:89], v40 offset:20480
ds_read_b64_tr_b16 v[90:91], v40 offset:21504
buffer_load_dwordx4 v2, s[12:15], s41 offen offset:0 lds
v_cvt_pk_bf16_f32 v178, v28, v29
v_cvt_pk_bf16_f32 v179, v30, v31
v_lshlrev_b32 v24, 16, v180
v_mfma_f32_32x32x16_bf16 a[48:63], v[92:95], v[116:119], a[48:63]
ds_read_b64_tr_b16 v[92:93], v43 offset:20480
ds_read_b64_tr_b16 v[94:95], v43 offset:21504
v_and_b32 v25, 0xffff0000, v180
s_add_u32 m0, s40, 118784
s_add_u32 s41, s100, 165888
s_waitcnt lgkmcnt(8)
v_mfma_f32_32x32x16_bf16 a[192:207], v[136:139], v[96:99], a[192:207]
ds_read_b64_tr_b16 v[96:97], v46 offset:20480
ds_read_b64_tr_b16 v[98:99], v46 offset:21504
buffer_load_dwordx4 v2, s[12:15], s41 offen offset:0 lds
v_lshlrev_b32 v26, 16, v181
v_and_b32 v27, 0xffff0000, v181
v_lshlrev_b32 v28, 16, v182
v_mfma_f32_32x32x16_bf16 a[208:223], v[136:139], v[100:103], a[208:223]
ds_read_b64_tr_b16 v[100:101], v49 offset:20480
ds_read_b64_tr_b16 v[102:103], v49 offset:21504
v_and_b32 v29, 0xffff0000, v182
v_lshlrev_b32 v30, 16, v183
s_add_u32 m0, s40, 122880
s_waitcnt lgkmcnt(8)
v_mfma_f32_32x32x16_bf16 a[224:239], v[136:139], v[104:107], a[224:239]
s_waitcnt vmcnt(22)
s_barrier
ds_read_b64_tr_b16 v[104:105], v8 offset:24576
ds_read_b64_tr_b16 v[106:107], v8 offset:25088
buffer_load_dwordx4 v3, s[20:23], s58 offen offset:0 lds
v_and_b32 v31, 0xffff0000, v183
v_mfma_f32_32x32x16_bf16 a[240:255], v[108:111], v[136:139], a[240:255]
ds_read_b64_tr_b16 v[108:109], v11 offset:24576
ds_read_b64_tr_b16 v[110:111], v11 offset:25088
v_fma_f32 v24, v24, v22, v60
s_add_u32 m0, s40, 126976
s_add_u32 s41, s100, 221184
s_waitcnt lgkmcnt(8)
v_mfma_f32_32x32x16_bf16 a[192:207], v[140:143], v[88:91], a[192:207]
ds_read_b64_tr_b16 v[88:89], v8 offset:26624
ds_read_b64_tr_b16 v[90:91], v8 offset:27136
buffer_load_dwordx4 v2, s[12:15], s41 offen offset:0 lds
v_fma_f32 v25, v25, v22, v60
v_fma_f32 v26, v26, v22, v60
v_fma_f32 v27, v27, v22, v60
v_mfma_f32_32x32x16_bf16 a[208:223], v[140:143], v[92:95], a[208:223]
ds_read_b64_tr_b16 v[92:93], v11 offset:26624
ds_read_b64_tr_b16 v[94:95], v11 offset:27136
v_fma_f32 v28, v28, v22, v60
s_add_u32 m0, s40, 0
s_add_u32 s41, s100, 276480
s_waitcnt lgkmcnt(8)
v_mfma_f32_32x32x16_bf16 a[224:239], v[140:143], v[96:99], a[224:239]
ds_read_b64_tr_b16 v[96:97], v40 offset:28672
ds_read_b64_tr_b16 v[98:99], v40 offset:29696
buffer_load_dwordx4 v2, s[12:15], s41 offen offset:0 lds
v_fma_f32 v29, v29, v22, v60
v_fma_f32 v30, v30, v22, v60
v_fma_f32 v31, v31, v22, v60
v_mfma_f32_32x32x16_bf16 a[240:255], v[100:103], v[140:143], a[240:255]
ds_read_b64_tr_b16 v[100:101], v43 offset:28672
ds_read_b64_tr_b16 v[102:103], v43 offset:29696
v_cvt_pk_bf16_f32 v180, v24, v25
v_cvt_pk_bf16_f32 v181, v26, v27
s_add_u32 m0, s40, 4096
s_waitcnt lgkmcnt(8)
v_mfma_f32_32x32x16_bf16 a[0:15], v[104:107], v[120:123], a[0:15]
ds_read_b64_tr_b16 v[104:105], v46 offset:28672
ds_read_b64_tr_b16 v[106:107], v46 offset:29696
buffer_load_dwordx4 v3, s[20:23], s59 offen offset:0 lds
buffer_load_dword a182, v10, s[20:23], 0 offen offset:128
v_cvt_pk_bf16_f32 v182, v28, v29
v_cvt_pk_bf16_f32 v183, v30, v31
v_mfma_f32_32x32x16_bf16 a[16:31], v[108:111], v[120:123], a[16:31]
ds_read_b64_tr_b16 v[108:109], v49 offset:28672
ds_read_b64_tr_b16 v[110:111], v49 offset:29696
v_lshlrev_b32 v24, 16, v184
v_and_b32 v25, 0xffff0000, v184
v_lshlrev_b32 v26, 16, v185
s_waitcnt lgkmcnt(8)
v_mfma_f32_32x32x16_bf16 a[32:47], v[88:91], v[120:123], a[32:47]
s_waitcnt vmcnt(25)
s_barrier
ds_read_b64_tr_b16 v[88:89], v40 offset:32768
ds_read_b64_tr_b16 v[90:91], v40 offset:33792
v_and_b32 v27, 0xffff0000, v185
v_lshlrev_b32 v28, 16, v186
v_mfma_f32_32x32x16_bf16 a[48:63], v[92:95], v[120:123], a[48:63]
ds_read_b64_tr_b16 v[92:93], v43 offset:32768
ds_read_b64_tr_b16 v[94:95], v43 offset:33792
v_and_b32 v29, 0xffff0000, v186
s_add_u32 m0, s40, 8192
s_add_u32 s41, s100, 331776
s_waitcnt lgkmcnt(8)
v_mfma_f32_32x32x16_bf16 a[192:207], v[144:147], v[96:99], a[192:207]
ds_read_b64_tr_b16 v[96:97], v46 offset:32768
ds_read_b64_tr_b16 v[98:99], v46 offset:33792
buffer_load_dwordx4 v2, s[12:15], s41 offen offset:0 lds
v_lshlrev_b32 v30, 16, v187
v_and_b32 v31, 0xffff0000, v187
v_fma_f32 v24, v24, v22, v60
v_mfma_f32_32x32x16_bf16 a[208:223], v[144:147], v[100:103], a[208:223]
ds_read_b64_tr_b16 v[100:101], v49 offset:32768
ds_read_b64_tr_b16 v[102:103], v49 offset:33792
v_fma_f32 v25, v25, v22, v60
v_fma_f32 v26, v26, v22, v60
v_fma_f32 v27, v27, v22, v60
s_waitcnt lgkmcnt(8)
v_mfma_f32_32x32x16_bf16 a[224:239], v[144:147], v[104:107], a[224:239]
ds_read_b64_tr_b16 v[104:105], v8 offset:36864
ds_read_b64_tr_b16 v[106:107], v8 offset:37376
v_fma_f32 v28, v28, v22, v60
v_fma_f32 v29, v29, v22, v60
v_fma_f32 v30, v30, v22, v60
v_fma_f32 v31, v31, v22, v60
v_mfma_f32_32x32x16_bf16 a[240:255], v[108:111], v[144:147], a[240:255]
ds_read_b64_tr_b16 v[108:109], v11 offset:36864
ds_read_b64_tr_b16 v[110:111], v11 offset:37376
v_cvt_pk_bf16_f32 v184, v24, v25
s_add_u32 m0, s40, 12288
s_add_u32 s41, s100, 387072
s_waitcnt lgkmcnt(8)
v_mfma_f32_32x32x16_bf16 a[192:207], v[148:151], v[88:91], a[192:207]
ds_read_b64_tr_b16 v[88:89], v8 offset:38912
ds_read_b64_tr_b16 v[90:91], v8 offset:39424
buffer_load_dwordx4 v2, s[12:15], s41 offen offset:0 lds
v_cvt_pk_bf16_f32 v185, v26, v27
v_cvt_pk_bf16_f32 v186, v28, v29
v_cvt_pk_bf16_f32 v187, v30, v31
v_mfma_f32_32x32x16_bf16 a[208:223], v[148:151], v[92:95], a[208:223]
ds_read_b64_tr_b16 v[92:93], v11 offset:38912
ds_read_b64_tr_b16 v[94:95], v11 offset:39424
v_lshlrev_b32 v24, 16, v188
v_and_b32 v25, 0xffff0000, v188
v_lshlrev_b32 v26, 16, v189
s_waitcnt lgkmcnt(8)
v_mfma_f32_32x32x16_bf16 a[224:239], v[148:151], v[96:99], a[224:239]
s_waitcnt vmcnt(25)
s_barrier
ds_read_b64_tr_b16 v[96:97], v40 offset:40960
ds_read_b64_tr_b16 v[98:99], v40 offset:41984
v_and_b32 v27, 0xffff0000, v189
v_lshlrev_b32 v28, 16, v190
v_mfma_f32_32x32x16_bf16 a[240:255], v[100:103], v[148:151], a[240:255]
ds_read_b64_tr_b16 v[100:101], v43 offset:40960
ds_read_b64_tr_b16 v[102:103], v43 offset:41984
v_and_b32 v29, 0xffff0000, v190
v_lshlrev_b32 v30, 16, v191
s_add_u32 m0, s40, 16384
s_waitcnt lgkmcnt(8)
v_mfma_f32_32x32x16_bf16 a[0:15], v[104:107], v[124:127], a[0:15]
ds_read_b64_tr_b16 v[104:105], v46 offset:40960
ds_read_b64_tr_b16 v[106:107], v46 offset:41984
buffer_load_dwordx4 v3, s[20:23], s60 offen offset:0 lds
v_and_b32 v31, 0xffff0000, v191
v_fma_f32 v24, v24, v22, v60
v_fma_f32 v25, v25, v22, v60
v_mfma_f32_32x32x16_bf16 a[16:31], v[108:111], v[124:127], a[16:31]
ds_read_b64_tr_b16 v[108:109], v49 offset:40960
ds_read_b64_tr_b16 v[110:111], v49 offset:41984
v_fma_f32 v26, v26, v22, v60
v_fma_f32 v27, v27, v22, v60
v_fma_f32 v28, v28, v22, v60
s_waitcnt lgkmcnt(8)
v_mfma_f32_32x32x16_bf16 a[32:47], v[88:91], v[124:127], a[32:47]
ds_read_b64_tr_b16 v[88:89], v40 offset:45056
ds_read_b64_tr_b16 v[90:91], v40 offset:46080
v_fma_f32 v29, v29, v22, v60
v_fma_f32 v30, v30, v22, v60
v_fma_f32 v31, v31, v22, v60
v_cvt_pk_bf16_f32 v188, v24, v25
v_mfma_f32_32x32x16_bf16 a[48:63], v[92:95], v[124:127], a[48:63]
ds_read_b64_tr_b16 v[92:93], v43 offset:45056
ds_read_b64_tr_b16 v[94:95], v43 offset:46080
v_cvt_pk_bf16_f32 v189, v26, v27
s_add_u32 m0, s40, 20480
s_add_u32 s41, s100, 442368
s_waitcnt lgkmcnt(8)
v_mfma_f32_32x32x16_bf16 a[192:207], v[152:155], v[96:99], a[192:207]
ds_read_b64_tr_b16 v[96:97], v46 offset:45056
ds_read_b64_tr_b16 v[98:99], v46 offset:46080
buffer_load_dwordx4 v2, s[12:15], s41 offen offset:0 lds
v_cvt_pk_bf16_f32 v190, v28, v29
v_cvt_pk_bf16_f32 v191, v30, v31
v_lshlrev_b32 v24, 16, v192
v_mfma_f32_32x32x16_bf16 a[208:223], v[152:155], v[100:103], a[208:223]
ds_read_b64_tr_b16 v[100:101], v49 offset:45056
ds_read_b64_tr_b16 v[102:103], v49 offset:46080
v_and_b32 v25, 0xffff0000, v192
v_lshlrev_b32 v26, 16, v193
v_and_b32 v27, 0xffff0000, v193
s_waitcnt lgkmcnt(8)
v_mfma_f32_32x32x16_bf16 a[224:239], v[152:155], v[104:107], a[224:239]
s_waitcnt vmcnt(25)
s_barrier
ds_read_b64_tr_b16 v[104:105], v8 offset:49152
ds_read_b64_tr_b16 v[106:107], v8 offset:49664
v_lshlrev_b32 v28, 16, v194
v_and_b32 v29, 0xffff0000, v194
v_mfma_f32_32x32x16_bf16 a[240:255], v[108:111], v[152:155], a[240:255]
ds_read_b64_tr_b16 v[108:109], v11 offset:49152
ds_read_b64_tr_b16 v[110:111], v11 offset:49664
v_lshlrev_b32 v30, 16, v195
s_add_u32 m0, s40, 24576
s_add_u32 s41, s100, 497664
s_waitcnt lgkmcnt(8)
v_mfma_f32_32x32x16_bf16 a[192:207], v[156:159], v[88:91], a[192:207]
ds_read_b64_tr_b16 v[88:89], v8 offset:51200
ds_read_b64_tr_b16 v[90:91], v8 offset:51712
buffer_load_dwordx4 v2, s[12:15], s41 offen offset:0 lds
v_and_b32 v31, 0xffff0000, v195
v_fma_f32 v24, v24, v22, v60
v_fma_f32 v25, v25, v22, v60
v_mfma_f32_32x32x16_bf16 a[208:223], v[156:159], v[92:95], a[208:223]
ds_read_b64_tr_b16 v[92:93], v11 offset:51200
ds_read_b64_tr_b16 v[94:95], v11 offset:51712
v_fma_f32 v26, v26, v22, v60
v_fma_f32 v27, v27, v22, v60
v_fma_f32 v28, v28, v22, v60
s_waitcnt lgkmcnt(8)
v_mfma_f32_32x32x16_bf16 a[224:239], v[156:159], v[96:99], a[224:239]
ds_read_b64_tr_b16 v[96:97], v40 offset:53248
ds_read_b64_tr_b16 v[98:99], v40 offset:54272
v_fma_f32 v29, v29, v22, v60
v_fma_f32 v30, v30, v22, v60
v_fma_f32 v31, v31, v22, v60
v_cvt_pk_bf16_f32 v192, v24, v25
v_mfma_f32_32x32x16_bf16 a[240:255], v[100:103], v[156:159], a[240:255]
ds_read_b64_tr_b16 v[100:101], v43 offset:53248
ds_read_b64_tr_b16 v[102:103], v43 offset:54272
v_cvt_pk_bf16_f32 v193, v26, v27
v_cvt_pk_bf16_f32 v194, v28, v29
s_add_u32 m0, s40, 28672
s_waitcnt lgkmcnt(8)
v_mfma_f32_32x32x16_bf16 a[0:15], v[104:107], v[128:131], a[0:15]
ds_read_b64_tr_b16 v[104:105], v46 offset:53248
ds_read_b64_tr_b16 v[106:107], v46 offset:54272
buffer_load_dwordx4 v3, s[20:23], s61 offen offset:0 lds
v_cvt_pk_bf16_f32 v195, v30, v31
v_lshlrev_b32 v24, 16, v196
v_and_b32 v25, 0xffff0000, v196
v_mfma_f32_32x32x16_bf16 a[16:31], v[108:111], v[128:131], a[16:31]
ds_read_b64_tr_b16 v[108:109], v49 offset:53248
ds_read_b64_tr_b16 v[110:111], v49 offset:54272
v_lshlrev_b32 v26, 16, v197
v_and_b32 v27, 0xffff0000, v197
v_lshlrev_b32 v28, 16, v198
s_waitcnt lgkmcnt(8)
v_mfma_f32_32x32x16_bf16 a[32:47], v[88:91], v[128:131], a[32:47]
s_waitcnt vmcnt(25)
s_barrier
ds_read_b64_tr_b16 v[88:89], v40 offset:57344
ds_read_b64_tr_b16 v[90:91], v40 offset:58368
v_and_b32 v29, 0xffff0000, v198
v_lshlrev_b32 v30, 16, v199
v_mfma_f32_32x32x16_bf16 a[48:63], v[92:95], v[128:131], a[48:63]
ds_read_b64_tr_b16 v[92:93], v43 offset:57344
ds_read_b64_tr_b16 v[94:95], v43 offset:58368
v_and_b32 v31, 0xffff0000, v199
s_add_u32 m0, s40, 32768
s_add_u32 s41, s100, 552960
s_waitcnt lgkmcnt(8)
v_mfma_f32_32x32x16_bf16 a[192:207], v[160:163], v[96:99], a[192:207]
ds_read_b64_tr_b16 v[96:97], v46 offset:57344
ds_read_b64_tr_b16 v[98:99], v46 offset:58368
buffer_load_dwordx4 v2, s[12:15], s41 offen offset:0 lds
v_fma_f32 v24, v24, v22, v60
v_fma_f32 v25, v25, v22, v60
v_fma_f32 v26, v26, v22, v60
v_mfma_f32_32x32x16_bf16 a[208:223], v[160:163], v[100:103], a[208:223]
ds_read_b64_tr_b16 v[100:101], v49 offset:57344
ds_read_b64_tr_b16 v[102:103], v49 offset:58368
v_fma_f32 v27, v27, v22, v60
v_fma_f32 v28, v28, v22, v60
v_fma_f32 v29, v29, v22, v60
s_waitcnt lgkmcnt(8)
v_mfma_f32_32x32x16_bf16 a[224:239], v[160:163], v[104:107], a[224:239]
ds_read_b64_tr_b16 v[104:105], v8 offset:61440
ds_read_b64_tr_b16 v[106:107], v8 offset:61952
v_fma_f32 v30, v30, v22, v60
v_fma_f32 v31, v31, v22, v60
v_cvt_pk_bf16_f32 v196, v24, v25
v_cvt_pk_bf16_f32 v197, v26, v27
v_mfma_f32_32x32x16_bf16 a[240:255], v[108:111], v[160:163], a[240:255]
ds_read_b64_tr_b16 v[108:109], v11 offset:61440
ds_read_b64_tr_b16 v[110:111], v11 offset:61952
v_cvt_pk_bf16_f32 v198, v28, v29
s_add_u32 m0, s40, 36864
s_add_u32 s41, s100, 608256
s_waitcnt lgkmcnt(8)
v_mfma_f32_32x32x16_bf16 a[192:207], v[164:167], v[88:91], a[192:207]
ds_read_b64_tr_b16 v[88:89], v8 offset:63488
ds_read_b64_tr_b16 v[90:91], v8 offset:64000
buffer_load_dwordx4 v2, s[12:15], s41 offen offset:0 lds
v_cvt_pk_bf16_f32 v199, v30, v31
v_lshlrev_b32 v24, 16, v200
v_and_b32 v25, 0xffff0000, v200
v_mfma_f32_32x32x16_bf16 a[208:223], v[164:167], v[92:95], a[208:223]
ds_read_b64_tr_b16 v[92:93], v11 offset:63488
ds_read_b64_tr_b16 v[94:95], v11 offset:64000
v_lshlrev_b32 v26, 16, v201
v_and_b32 v27, 0xffff0000, v201
v_lshlrev_b32 v28, 16, v202
s_waitcnt lgkmcnt(8)
v_mfma_f32_32x32x16_bf16 a[224:239], v[164:167], v[96:99], a[224:239]
s_waitcnt vmcnt(25)
s_barrier
ds_read_b64_tr_b16 v[96:97], v41 offset:0
ds_read_b64_tr_b16 v[98:99], v41 offset:1024
v_and_b32 v29, 0xffff0000, v202
v_lshlrev_b32 v30, 16, v203
v_mfma_f32_32x32x16_bf16 a[240:255], v[100:103], v[164:167], a[240:255]
ds_read_b64_tr_b16 v[100:101], v44 offset:0
ds_read_b64_tr_b16 v[102:103], v44 offset:1024
v_and_b32 v31, 0xffff0000, v203
v_fma_f32 v24, v24, v22, v60
s_add_u32 m0, s40, 40960
s_waitcnt lgkmcnt(8)
v_mfma_f32_32x32x16_bf16 a[0:15], v[104:107], v[132:135], a[0:15]
ds_read_b64_tr_b16 v[104:105], v47 offset:0
ds_read_b64_tr_b16 v[106:107], v47 offset:1024
buffer_load_dwordx4 v3, s[20:23], s62 offen offset:0 lds
v_fma_f32 v25, v25, v22, v60
v_fma_f32 v26, v26, v22, v60
v_fma_f32 v27, v27, v22, v60
v_mfma_f32_32x32x16_bf16 a[16:31], v[108:111], v[132:135], a[16:31]
ds_read_b64_tr_b16 v[108:109], v50 offset:0
ds_read_b64_tr_b16 v[110:111], v50 offset:1024
v_fma_f32 v28, v28, v22, v60
v_fma_f32 v29, v29, v22, v60
v_fma_f32 v30, v30, v22, v60
s_waitcnt lgkmcnt(8)
v_mfma_f32_32x32x16_bf16 a[32:47], v[88:91], v[132:135], a[32:47]
ds_read_b64_tr_b16 v[88:89], v41 offset:4096
ds_read_b64_tr_b16 v[90:91], v41 offset:5120
v_fma_f32 v31, v31, v22, v60
v_cvt_pk_bf16_f32 v200, v24, v25
v_cvt_pk_bf16_f32 v201, v26, v27
v_cvt_pk_bf16_f32 v202, v28, v29
v_mfma_f32_32x32x16_bf16 a[48:63], v[92:95], v[132:135], a[48:63]
ds_read_b64_tr_b16 v[92:93], v44 offset:4096
ds_read_b64_tr_b16 v[94:95], v44 offset:5120
v_cvt_pk_bf16_f32 v203, v30, v31
s_add_u32 m0, s40, 45056
s_add_u32 s41, s100, 663552
s_waitcnt lgkmcnt(8)
v_mfma_f32_32x32x16_bf16 a[192:207], v[168:171], v[96:99], a[192:207]
ds_read_b64_tr_b16 v[96:97], v47 offset:4096
ds_read_b64_tr_b16 v[98:99], v47 offset:5120
buffer_load_dwordx4 v2, s[12:15], s41 offen offset:0 lds
v_lshlrev_b32 v24, 16, v204
v_and_b32 v25, 0xffff0000, v204
v_lshlrev_b32 v26, 16, v205
v_mfma_f32_32x32x16_bf16 a[208:223], v[168:171], v[100:103], a[208:223]
ds_read_b64_tr_b16 v[100:101], v50 offset:4096
ds_read_b64_tr_b16 v[102:103], v50 offset:5120
v_and_b32 v27, 0xffff0000, v205
v_lshlrev_b32 v28, 16, v206
v_and_b32 v29, 0xffff0000, v206
s_waitcnt lgkmcnt(8)
v_mfma_f32_32x32x16_bf16 a[224:239], v[168:171], v[104:107], a[224:239]
s_waitcnt vmcnt(25)
s_barrier
ds_read_b64_tr_b16 v[104:105], v9 offset:8192
ds_read_b64_tr_b16 v[106:107], v9 offset:8704
v_lshlrev_b32 v30, 16, v207
v_and_b32 v31, 0xffff0000, v207
v_mfma_f32_32x32x16_bf16 a[240:255], v[108:111], v[168:171], a[240:255]
ds_read_b64_tr_b16 v[108:109], v12 offset:8192
ds_read_b64_tr_b16 v[110:111], v12 offset:8704
v_fma_f32 v24, v24, v22, v60
s_add_u32 m0, s40, 49152
s_add_u32 s41, s100, 718848
s_waitcnt lgkmcnt(8)
v_mfma_f32_32x32x16_bf16 a[192:207], v[172:175], v[88:91], a[192:207]
ds_read_b64_tr_b16 v[88:89], v9 offset:10240
ds_read_b64_tr_b16 v[90:91], v9 offset:10752
buffer_load_dwordx4 v2, s[12:15], s41 offen offset:0 lds
v_fma_f32 v25, v25, v22, v60
v_fma_f32 v26, v26, v22, v60
v_fma_f32 v27, v27, v22, v60
v_mfma_f32_32x32x16_bf16 a[208:223], v[172:175], v[92:95], a[208:223]
ds_read_b64_tr_b16 v[92:93], v12 offset:10240
ds_read_b64_tr_b16 v[94:95], v12 offset:10752
v_fma_f32 v28, v28, v22, v60
v_fma_f32 v29, v29, v22, v60
v_fma_f32 v30, v30, v22, v60
s_waitcnt lgkmcnt(8)
v_mfma_f32_32x32x16_bf16 a[224:239], v[172:175], v[96:99], a[224:239]
ds_read_b64_tr_b16 v[96:97], v41 offset:12288
ds_read_b64_tr_b16 v[98:99], v41 offset:13312
v_fma_f32 v31, v31, v22, v60
v_cvt_pk_bf16_f32 v204, v24, v25
v_cvt_pk_bf16_f32 v205, v26, v27
v_cvt_pk_bf16_f32 v206, v28, v29
v_mfma_f32_32x32x16_bf16 a[240:255], v[100:103], v[172:175], a[240:255]
ds_read_b64_tr_b16 v[100:101], v44 offset:12288
ds_read_b64_tr_b16 v[102:103], v44 offset:13312
v_cvt_pk_bf16_f32 v207, v30, v31
v_lshlrev_b32 v24, 16, v208
s_add_u32 m0, s40, 53248
s_waitcnt lgkmcnt(8)
v_mfma_f32_32x32x16_bf16 a[0:15], v[104:107], v[136:139], a[0:15]
ds_read_b64_tr_b16 v[104:105], v47 offset:12288
ds_read_b64_tr_b16 v[106:107], v47 offset:13312
buffer_load_dwordx4 v3, s[20:23], s63 offen offset:0 lds
v_and_b32 v25, 0xffff0000, v208
v_lshlrev_b32 v26, 16, v209
v_and_b32 v27, 0xffff0000, v209
v_mfma_f32_32x32x16_bf16 a[16:31], v[108:111], v[136:139], a[16:31]
ds_read_b64_tr_b16 v[108:109], v50 offset:12288
ds_read_b64_tr_b16 v[110:111], v50 offset:13312
v_lshlrev_b32 v28, 16, v210
v_and_b32 v29, 0xffff0000, v210
v_lshlrev_b32 v30, 16, v211
s_waitcnt lgkmcnt(8)
v_mfma_f32_32x32x16_bf16 a[32:47], v[88:91], v[136:139], a[32:47]
s_waitcnt vmcnt(25)
s_barrier
ds_read_b64_tr_b16 v[88:89], v41 offset:16384
ds_read_b64_tr_b16 v[90:91], v41 offset:17408
v_and_b32 v31, 0xffff0000, v211
v_fma_f32 v24, v24, v22, v60
v_mfma_f32_32x32x16_bf16 a[48:63], v[92:95], v[136:139], a[48:63]
ds_read_b64_tr_b16 v[92:93], v44 offset:16384
ds_read_b64_tr_b16 v[94:95], v44 offset:17408
v_fma_f32 v25, v25, v22, v60
s_add_u32 m0, s40, 57344
s_add_u32 s41, s100, 774144
s_waitcnt lgkmcnt(8)
v_mfma_f32_32x32x16_bf16 a[192:207], v[176:179], v[96:99], a[192:207]
ds_read_b64_tr_b16 v[96:97], v47 offset:16384
ds_read_b64_tr_b16 v[98:99], v47 offset:17408
buffer_load_dwordx4 v2, s[12:15], s41 offen offset:0 lds
v_fma_f32 v26, v26, v22, v60
v_fma_f32 v27, v27, v22, v60
v_fma_f32 v28, v28, v22, v60
v_mfma_f32_32x32x16_bf16 a[208:223], v[176:179], v[100:103], a[208:223]
ds_read_b64_tr_b16 v[100:101], v50 offset:16384
ds_read_b64_tr_b16 v[102:103], v50 offset:17408
v_fma_f32 v29, v29, v22, v60
v_fma_f32 v30, v30, v22, v60
v_fma_f32 v31, v31, v22, v60
s_waitcnt lgkmcnt(8)
v_mfma_f32_32x32x16_bf16 a[224:239], v[176:179], v[104:107], a[224:239]
ds_read_b64_tr_b16 v[104:105], v9 offset:20480
ds_read_b64_tr_b16 v[106:107], v9 offset:20992
v_cvt_pk_bf16_f32 v208, v24, v25
v_cvt_pk_bf16_f32 v209, v26, v27
v_cvt_pk_bf16_f32 v210, v28, v29
v_cvt_pk_bf16_f32 v211, v30, v31
v_mfma_f32_32x32x16_bf16 a[240:255], v[108:111], v[176:179], a[240:255]
ds_read_b64_tr_b16 v[108:109], v12 offset:20480
ds_read_b64_tr_b16 v[110:111], v12 offset:20992
v_lshlrev_b32 v24, 16, v212
s_add_u32 m0, s40, 61440
s_add_u32 s41, s100, 829440
s_waitcnt lgkmcnt(8)
v_mfma_f32_32x32x16_bf16 a[192:207], v[180:183], v[88:91], a[192:207]
ds_read_b64_tr_b16 v[88:89], v9 offset:22528
ds_read_b64_tr_b16 v[90:91], v9 offset:23040
buffer_load_dwordx4 v2, s[12:15], s41 offen offset:0 lds
v_and_b32 v25, 0xffff0000, v212
v_lshlrev_b32 v26, 16, v213
v_and_b32 v27, 0xffff0000, v213
v_mfma_f32_32x32x16_bf16 a[208:223], v[180:183], v[92:95], a[208:223]
ds_read_b64_tr_b16 v[92:93], v12 offset:22528
ds_read_b64_tr_b16 v[94:95], v12 offset:23040
v_lshlrev_b32 v28, 16, v214
v_and_b32 v29, 0xffff0000, v214
v_lshlrev_b32 v30, 16, v215
s_waitcnt lgkmcnt(8)
v_mfma_f32_32x32x16_bf16 a[224:239], v[180:183], v[96:99], a[224:239]
s_waitcnt vmcnt(25)
s_barrier
ds_read_b64_tr_b16 v[96:97], v41 offset:24576
ds_read_b64_tr_b16 v[98:99], v41 offset:25600
v_and_b32 v31, 0xffff0000, v215
v_fma_f32 v24, v24, v22, v60
v_mfma_f32_32x32x16_bf16 a[240:255], v[100:103], v[180:183], a[240:255]
ds_read_b64_tr_b16 v[100:101], v44 offset:24576
ds_read_b64_tr_b16 v[102:103], v44 offset:25600
v_fma_f32 v25, v25, v22, v60
v_fma_f32 v26, v26, v22, v60
s_add_u32 m0, s40, 65536
s_waitcnt lgkmcnt(8)
v_mfma_f32_32x32x16_bf16 a[0:15], v[104:107], v[140:143], a[0:15]
ds_read_b64_tr_b16 v[104:105], v47 offset:24576
ds_read_b64_tr_b16 v[106:107], v47 offset:25600
buffer_load_dwordx4 v3, s[20:23], s64 offen offset:0 lds
v_fma_f32 v27, v27, v22, v60
v_fma_f32 v28, v28, v22, v60
v_fma_f32 v29, v29, v22, v60
v_mfma_f32_32x32x16_bf16 a[16:31], v[108:111], v[140:143], a[16:31]
ds_read_b64_tr_b16 v[108:109], v50 offset:24576
ds_read_b64_tr_b16 v[110:111], v50 offset:25600
v_fma_f32 v30, v30, v22, v60
v_fma_f32 v31, v31, v22, v60
v_cvt_pk_bf16_f32 v212, v24, v25
s_waitcnt lgkmcnt(8)
v_mfma_f32_32x32x16_bf16 a[32:47], v[88:91], v[140:143], a[32:47]
ds_read_b64_tr_b16 v[88:89], v41 offset:28672
ds_read_b64_tr_b16 v[90:91], v41 offset:29696
v_cvt_pk_bf16_f32 v213, v26, v27
v_cvt_pk_bf16_f32 v214, v28, v29
v_cvt_pk_bf16_f32 v215, v30, v31
v_lshlrev_b32 v24, 16, v216
v_mfma_f32_32x32x16_bf16 a[48:63], v[92:95], v[140:143], a[48:63]
ds_read_b64_tr_b16 v[92:93], v44 offset:28672
ds_read_b64_tr_b16 v[94:95], v44 offset:29696
v_and_b32 v25, 0xffff0000, v216
v_lshlrev_b32 v26, 16, v217
s_add_u32 m0, s40, 69632
s_waitcnt lgkmcnt(8)
v_mfma_f32_32x32x16_bf16 a[192:207], v[184:187], v[96:99], a[192:207]
ds_read_b64_tr_b16 v[96:97], v47 offset:28672
ds_read_b64_tr_b16 v[98:99], v47 offset:29696
buffer_load_dwordx4 v3, s[20:23], s65 offen offset:0 lds
v_and_b32 v27, 0xffff0000, v217
v_lshlrev_b32 v28, 16, v218
v_and_b32 v29, 0xffff0000, v218
v_mfma_f32_32x32x16_bf16 a[208:223], v[184:187], v[100:103], a[208:223]
ds_read_b64_tr_b16 v[100:101], v50 offset:28672
ds_read_b64_tr_b16 v[102:103], v50 offset:29696
v_lshlrev_b32 v30, 16, v219
v_and_b32 v31, 0xffff0000, v219
v_fma_f32 v24, v24, v22, v60
s_waitcnt lgkmcnt(8)
v_mfma_f32_32x32x16_bf16 a[224:239], v[184:187], v[104:107], a[224:239]
s_waitcnt vmcnt(25)
s_barrier
ds_read_b64_tr_b16 v[104:105], v9 offset:32768
ds_read_b64_tr_b16 v[106:107], v9 offset:33280
v_fma_f32 v25, v25, v22, v60
v_fma_f32 v26, v26, v22, v60
v_mfma_f32_32x32x16_bf16 a[240:255], v[108:111], v[184:187], a[240:255]
ds_read_b64_tr_b16 v[108:109], v12 offset:32768
ds_read_b64_tr_b16 v[110:111], v12 offset:33280
v_fma_f32 v27, v27, v22, v60
v_fma_f32 v28, v28, v22, v60
s_add_u32 m0, s40, 73728
s_waitcnt lgkmcnt(8)
v_mfma_f32_32x32x16_bf16 a[192:207], v[188:191], v[88:91], a[192:207]
ds_read_b64_tr_b16 v[88:89], v9 offset:34816
ds_read_b64_tr_b16 v[90:91], v9 offset:35328
buffer_load_dwordx4 v3, s[20:23], s66 offen offset:0 lds
v_fma_f32 v29, v29, v22, v60
v_fma_f32 v30, v30, v22, v60
v_fma_f32 v31, v31, v22, v60
v_mfma_f32_32x32x16_bf16 a[208:223], v[188:191], v[92:95], a[208:223]
ds_read_b64_tr_b16 v[92:93], v12 offset:34816
ds_read_b64_tr_b16 v[94:95], v12 offset:35328
v_cvt_pk_bf16_f32 v216, v24, v25
v_cvt_pk_bf16_f32 v217, v26, v27
v_cvt_pk_bf16_f32 v218, v28, v29
s_waitcnt lgkmcnt(8)
v_mfma_f32_32x32x16_bf16 a[224:239], v[188:191], v[96:99], a[224:239]
ds_read_b64_tr_b16 v[96:97], v41 offset:36864
ds_read_b64_tr_b16 v[98:99], v41 offset:37888
v_cvt_pk_bf16_f32 v219, v30, v31
v_lshlrev_b32 v24, 16, v220
v_and_b32 v25, 0xffff0000, v220
v_lshlrev_b32 v26, 16, v221
v_mfma_f32_32x32x16_bf16 a[240:255], v[100:103], v[188:191], a[240:255]
ds_read_b64_tr_b16 v[100:101], v44 offset:36864
ds_read_b64_tr_b16 v[102:103], v44 offset:37888
v_and_b32 v27, 0xffff0000, v221
v_lshlrev_b32 v28, 16, v222
s_add_u32 m0, s40, 77824
s_waitcnt lgkmcnt(8)
v_mfma_f32_32x32x16_bf16 a[0:15], v[104:107], v[144:147], a[0:15]
ds_read_b64_tr_b16 v[104:105], v47 offset:36864
ds_read_b64_tr_b16 v[106:107], v47 offset:37888
buffer_load_dwordx4 v3, s[20:23], s67 offen offset:0 lds
v_and_b32 v29, 0xffff0000, v222
v_lshlrev_b32 v30, 16, v223
v_and_b32 v31, 0xffff0000, v223
v_mfma_f32_32x32x16_bf16 a[16:31], v[108:111], v[144:147], a[16:31]
ds_read_b64_tr_b16 v[108:109], v50 offset:36864
ds_read_b64_tr_b16 v[110:111], v50 offset:37888
v_fma_f32 v24, v24, v22, v60
v_fma_f32 v25, v25, v22, v60
v_fma_f32 v26, v26, v22, v60
s_waitcnt lgkmcnt(8)
v_mfma_f32_32x32x16_bf16 a[32:47], v[88:91], v[144:147], a[32:47]
s_waitcnt vmcnt(25)
s_barrier
ds_read_b64_tr_b16 v[88:89], v41 offset:40960
ds_read_b64_tr_b16 v[90:91], v41 offset:41984
v_fma_f32 v27, v27, v22, v60
v_fma_f32 v28, v28, v22, v60
v_mfma_f32_32x32x16_bf16 a[48:63], v[92:95], v[144:147], a[48:63]
ds_read_b64_tr_b16 v[92:93], v44 offset:40960
ds_read_b64_tr_b16 v[94:95], v44 offset:41984
v_fma_f32 v29, v29, v22, v60
v_fma_f32 v30, v30, v22, v60
s_add_u32 m0, s40, 81920
s_waitcnt lgkmcnt(8)
v_mfma_f32_32x32x16_bf16 a[192:207], v[192:195], v[96:99], a[192:207]
ds_read_b64_tr_b16 v[96:97], v47 offset:40960
ds_read_b64_tr_b16 v[98:99], v47 offset:41984
buffer_load_dwordx4 v3, s[20:23], s68 offen offset:0 lds
v_fma_f32 v31, v31, v22, v60
v_cvt_pk_bf16_f32 v220, v24, v25
v_cvt_pk_bf16_f32 v221, v26, v27
v_mfma_f32_32x32x16_bf16 a[208:223], v[192:195], v[100:103], a[208:223]
ds_read_b64_tr_b16 v[100:101], v50 offset:40960
ds_read_b64_tr_b16 v[102:103], v50 offset:41984
v_cvt_pk_bf16_f32 v222, v28, v29
v_cvt_pk_bf16_f32 v223, v30, v31
v_lshlrev_b32 v24, 16, v224
s_waitcnt lgkmcnt(8)
v_mfma_f32_32x32x16_bf16 a[224:239], v[192:195], v[104:107], a[224:239]
ds_read_b64_tr_b16 v[104:105], v9 offset:45056
ds_read_b64_tr_b16 v[106:107], v9 offset:45568
v_and_b32 v25, 0xffff0000, v224
v_lshlrev_b32 v26, 16, v225
v_and_b32 v27, 0xffff0000, v225
v_lshlrev_b32 v28, 16, v226
v_mfma_f32_32x32x16_bf16 a[240:255], v[108:111], v[192:195], a[240:255]
ds_read_b64_tr_b16 v[108:109], v12 offset:45056
ds_read_b64_tr_b16 v[110:111], v12 offset:45568
v_and_b32 v29, 0xffff0000, v226
v_lshlrev_b32 v30, 16, v227
s_add_u32 m0, s40, 86016
s_waitcnt lgkmcnt(8)
v_mfma_f32_32x32x16_bf16 a[192:207], v[196:199], v[88:91], a[192:207]
ds_read_b64_tr_b16 v[88:89], v9 offset:47104
ds_read_b64_tr_b16 v[90:91], v9 offset:47616
buffer_load_dwordx4 v3, s[20:23], s69 offen offset:0 lds
v_and_b32 v31, 0xffff0000, v227
v_fma_f32 v24, v24, v22, v60
v_fma_f32 v25, v25, v22, v60
v_mfma_f32_32x32x16_bf16 a[208:223], v[196:199], v[92:95], a[208:223]
ds_read_b64_tr_b16 v[92:93], v12 offset:47104
ds_read_b64_tr_b16 v[94:95], v12 offset:47616
v_fma_f32 v26, v26, v22, v60
v_fma_f32 v27, v27, v22, v60
v_fma_f32 v28, v28, v22, v60
s_waitcnt lgkmcnt(8)
v_mfma_f32_32x32x16_bf16 a[224:239], v[196:199], v[96:99], a[224:239]
s_waitcnt vmcnt(25)
s_barrier
ds_read_b64_tr_b16 v[96:97], v41 offset:49152
ds_read_b64_tr_b16 v[98:99], v41 offset:50176
v_fma_f32 v29, v29, v22, v60
v_fma_f32 v30, v30, v22, v60
v_mfma_f32_32x32x16_bf16 a[240:255], v[100:103], v[196:199], a[240:255]
ds_read_b64_tr_b16 v[100:101], v44 offset:49152
ds_read_b64_tr_b16 v[102:103], v44 offset:50176
v_fma_f32 v31, v31, v22, v60
v_cvt_pk_bf16_f32 v224, v24, v25
s_add_u32 m0, s40, 90112
s_waitcnt lgkmcnt(8)
v_mfma_f32_32x32x16_bf16 a[0:15], v[104:107], v[148:151], a[0:15]
ds_read_b64_tr_b16 v[104:105], v47 offset:49152
ds_read_b64_tr_b16 v[106:107], v47 offset:50176
buffer_load_dwordx4 v3, s[20:23], s70 offen offset:0 lds
v_cvt_pk_bf16_f32 v225, v26, v27
v_cvt_pk_bf16_f32 v226, v28, v29
v_cvt_pk_bf16_f32 v227, v30, v31
v_mfma_f32_32x32x16_bf16 a[16:31], v[108:111], v[148:151], a[16:31]
ds_read_b64_tr_b16 v[108:109], v50 offset:49152
ds_read_b64_tr_b16 v[110:111], v50 offset:50176
v_lshlrev_b32 v24, 16, v228
v_and_b32 v25, 0xffff0000, v228
v_lshlrev_b32 v26, 16, v229
s_waitcnt lgkmcnt(8)
v_mfma_f32_32x32x16_bf16 a[32:47], v[88:91], v[148:151], a[32:47]
ds_read_b64_tr_b16 v[88:89], v41 offset:53248
ds_read_b64_tr_b16 v[90:91], v41 offset:54272
v_and_b32 v27, 0xffff0000, v229
v_lshlrev_b32 v28, 16, v230
v_and_b32 v29, 0xffff0000, v230
v_lshlrev_b32 v30, 16, v231
v_mfma_f32_32x32x16_bf16 a[48:63], v[92:95], v[148:151], a[48:63]
ds_read_b64_tr_b16 v[92:93], v44 offset:53248
ds_read_b64_tr_b16 v[94:95], v44 offset:54272
v_and_b32 v31, 0xffff0000, v231
v_fma_f32 v24, v24, v22, v60
s_add_u32 m0, s40, 94208
s_waitcnt lgkmcnt(8)
v_mfma_f32_32x32x16_bf16 a[192:207], v[200:203], v[96:99], a[192:207]
ds_read_b64_tr_b16 v[96:97], v47 offset:53248
ds_read_b64_tr_b16 v[98:99], v47 offset:54272
buffer_load_dwordx4 v3, s[20:23], s71 offen offset:0 lds
v_fma_f32 v25, v25, v22, v60
v_fma_f32 v26, v26, v22, v60
v_fma_f32 v27, v27, v22, v60
v_mfma_f32_32x32x16_bf16 a[208:223], v[200:203], v[100:103], a[208:223]
ds_read_b64_tr_b16 v[100:101], v50 offset:53248
ds_read_b64_tr_b16 v[102:103], v50 offset:54272
v_fma_f32 v28, v28, v22, v60
v_fma_f32 v29, v29, v22, v60
v_fma_f32 v30, v30, v22, v60
s_waitcnt lgkmcnt(8)
v_mfma_f32_32x32x16_bf16 a[224:239], v[200:203], v[104:107], a[224:239]
s_waitcnt vmcnt(25)
s_barrier
ds_read_b64_tr_b16 v[104:105], v9 offset:57344
ds_read_b64_tr_b16 v[106:107], v9 offset:57856
v_fma_f32 v31, v31, v22, v60
v_cvt_pk_bf16_f32 v228, v24, v25
v_mfma_f32_32x32x16_bf16 a[240:255], v[108:111], v[200:203], a[240:255]
ds_read_b64_tr_b16 v[108:109], v12 offset:57344
ds_read_b64_tr_b16 v[110:111], v12 offset:57856
v_cvt_pk_bf16_f32 v229, v26, v27
v_cvt_pk_bf16_f32 v230, v28, v29
s_add_u32 m0, s40, 98304
s_waitcnt lgkmcnt(8)
v_mfma_f32_32x32x16_bf16 a[192:207], v[204:207], v[88:91], a[192:207]
ds_read_b64_tr_b16 v[88:89], v9 offset:59392
ds_read_b64_tr_b16 v[90:91], v9 offset:59904
buffer_load_dwordx4 v3, s[20:23], s72 offen offset:0 lds
v_cvt_pk_bf16_f32 v231, v30, v31
v_lshlrev_b32 v24, 16, v232
v_and_b32 v25, 0xffff0000, v232
v_mfma_f32_32x32x16_bf16 a[208:223], v[204:207], v[92:95], a[208:223]
ds_read_b64_tr_b16 v[92:93], v12 offset:59392
ds_read_b64_tr_b16 v[94:95], v12 offset:59904
v_lshlrev_b32 v26, 16, v233
v_and_b32 v27, 0xffff0000, v233
v_lshlrev_b32 v28, 16, v234
s_waitcnt lgkmcnt(8)
v_mfma_f32_32x32x16_bf16 a[224:239], v[204:207], v[96:99], a[224:239]
ds_read_b64_tr_b16 v[96:97], v41 offset:61440
ds_read_b64_tr_b16 v[98:99], v41 offset:62464
v_and_b32 v29, 0xffff0000, v234
v_lshlrev_b32 v30, 16, v235
v_and_b32 v31, 0xffff0000, v235
v_fma_f32 v24, v24, v22, v60
v_mfma_f32_32x32x16_bf16 a[240:255], v[100:103], v[204:207], a[240:255]
ds_read_b64_tr_b16 v[100:101], v44 offset:61440
ds_read_b64_tr_b16 v[102:103], v44 offset:62464
v_fma_f32 v25, v25, v22, v60
v_fma_f32 v26, v26, v22, v60
s_add_u32 m0, s40, 102400
s_waitcnt lgkmcnt(8)
v_mfma_f32_32x32x16_bf16 a[0:15], v[104:107], v[152:155], a[0:15]
ds_read_b64_tr_b16 v[104:105], v47 offset:61440
ds_read_b64_tr_b16 v[106:107], v47 offset:62464
buffer_load_dwordx4 v3, s[20:23], s73 offen offset:0 lds
v_fma_f32 v27, v27, v22, v60
v_fma_f32 v28, v28, v22, v60
v_fma_f32 v29, v29, v22, v60
v_mfma_f32_32x32x16_bf16 a[16:31], v[108:111], v[152:155], a[16:31]
ds_read_b64_tr_b16 v[108:109], v50 offset:61440
ds_read_b64_tr_b16 v[110:111], v50 offset:62464
v_fma_f32 v30, v30, v22, v60
v_fma_f32 v31, v31, v22, v60
v_cvt_pk_bf16_f32 v232, v24, v25
s_waitcnt lgkmcnt(8)
v_mfma_f32_32x32x16_bf16 a[32:47], v[88:91], v[152:155], a[32:47]
s_waitcnt vmcnt(25)
s_barrier
ds_read_b64_tr_b16 v[88:89], v40 offset:0
ds_read_b64_tr_b16 v[90:91], v40 offset:1024
v_cvt_pk_bf16_f32 v233, v26, v27
v_cvt_pk_bf16_f32 v234, v28, v29
v_mfma_f32_32x32x16_bf16 a[48:63], v[92:95], v[152:155], a[48:63]
ds_read_b64_tr_b16 v[92:93], v43 offset:0
ds_read_b64_tr_b16 v[94:95], v43 offset:1024
v_cvt_pk_bf16_f32 v235, v30, v31
v_lshlrev_b32 v24, 16, v236
s_add_u32 m0, s40, 106496
s_waitcnt lgkmcnt(8)
v_mfma_f32_32x32x16_bf16 a[192:207], v[208:211], v[96:99], a[192:207]
ds_read_b64_tr_b16 v[96:97], v46 offset:0
ds_read_b64_tr_b16 v[98:99], v46 offset:1024
buffer_load_dwordx4 v3, s[20:23], s74 offen offset:0 lds
v_and_b32 v25, 0xffff0000, v236
v_lshlrev_b32 v26, 16, v237
v_and_b32 v27, 0xffff0000, v237
v_mfma_f32_32x32x16_bf16 a[208:223], v[208:211], v[100:103], a[208:223]
ds_read_b64_tr_b16 v[100:101], v49 offset:0
ds_read_b64_tr_b16 v[102:103], v49 offset:1024
v_lshlrev_b32 v28, 16, v238
v_and_b32 v29, 0xffff0000, v238
v_lshlrev_b32 v30, 16, v239
s_waitcnt lgkmcnt(8)
v_mfma_f32_32x32x16_bf16 a[224:239], v[208:211], v[104:107], a[224:239]
ds_read_b64_tr_b16 v[104:105], v8 offset:4096
ds_read_b64_tr_b16 v[106:107], v8 offset:4608
v_and_b32 v31, 0xffff0000, v239
v_fma_f32 v24, v24, v22, v60
v_fma_f32 v25, v25, v22, v60
v_fma_f32 v26, v26, v22, v60
v_mfma_f32_32x32x16_bf16 a[240:255], v[108:111], v[208:211], a[240:255]
ds_read_b64_tr_b16 v[108:109], v11 offset:4096
ds_read_b64_tr_b16 v[110:111], v11 offset:4608
v_fma_f32 v27, v27, v22, v60
v_fma_f32 v28, v28, v22, v60
s_add_u32 m0, s40, 110592
s_waitcnt lgkmcnt(8)
v_mfma_f32_32x32x16_bf16 a[192:207], v[212:215], v[88:91], a[192:207]
ds_read_b64_tr_b16 v[88:89], v8 offset:6144
ds_read_b64_tr_b16 v[90:91], v8 offset:6656
buffer_load_dwordx4 v3, s[20:23], s75 offen offset:0 lds
v_fma_f32 v29, v29, v22, v60
v_fma_f32 v30, v30, v22, v60
v_fma_f32 v31, v31, v22, v60
v_mfma_f32_32x32x16_bf16 a[208:223], v[212:215], v[92:95], a[208:223]
ds_read_b64_tr_b16 v[92:93], v11 offset:6144
ds_read_b64_tr_b16 v[94:95], v11 offset:6656
v_cvt_pk_bf16_f32 v236, v24, v25
v_cvt_pk_bf16_f32 v237, v26, v27
v_cvt_pk_bf16_f32 v238, v28, v29
s_waitcnt lgkmcnt(8)
v_mfma_f32_32x32x16_bf16 a[224:239], v[212:215], v[96:99], a[224:239]
s_waitcnt vmcnt(24)
s_barrier
ds_read_b64_tr_b16 v[96:97], v40 offset:8192
ds_read_b64_tr_b16 v[98:99], v40 offset:9216
v_cvt_pk_bf16_f32 v239, v30, v31
v_lshlrev_b32 v24, 16, v240
v_mfma_f32_32x32x16_bf16 a[240:255], v[100:103], v[212:215], a[240:255]
ds_read_b64_tr_b16 v[100:101], v43 offset:8192
ds_read_b64_tr_b16 v[102:103], v43 offset:9216
v_and_b32 v25, 0xffff0000, v240
v_lshlrev_b32 v26, 16, v241
s_add_u32 m0, s40, 114688
s_waitcnt lgkmcnt(8)
v_mfma_f32_32x32x16_bf16 a[0:15], v[104:107], v[156:159], a[0:15]
ds_read_b64_tr_b16 v[104:105], v46 offset:8192
ds_read_b64_tr_b16 v[106:107], v46 offset:9216
buffer_load_dwordx4 v3, s[20:23], s76 offen offset:0 lds
v_and_b32 v27, 0xffff0000, v241
v_lshlrev_b32 v28, 16, v242
v_and_b32 v29, 0xffff0000, v242
v_mfma_f32_32x32x16_bf16 a[16:31], v[108:111], v[156:159], a[16:31]
ds_read_b64_tr_b16 v[108:109], v49 offset:8192
ds_read_b64_tr_b16 v[110:111], v49 offset:9216
v_lshlrev_b32 v30, 16, v243
v_and_b32 v31, 0xffff0000, v243
v_fma_f32 v24, v24, v22, v60
s_waitcnt lgkmcnt(8)
v_mfma_f32_32x32x16_bf16 a[32:47], v[88:91], v[156:159], a[32:47]
ds_read_b64_tr_b16 v[88:89], v40 offset:12288
ds_read_b64_tr_b16 v[90:91], v40 offset:13312
buffer_load_dword a182, v10, s[20:23], 0 offen offset:256
v_fma_f32 v25, v25, v22, v60
v_fma_f32 v26, v26, v22, v60
v_fma_f32 v27, v27, v22, v60
v_mfma_f32_32x32x16_bf16 a[48:63], v[92:95], v[156:159], a[48:63]
ds_read_b64_tr_b16 v[92:93], v43 offset:12288
ds_read_b64_tr_b16 v[94:95], v43 offset:13312
v_fma_f32 v28, v28, v22, v60
v_fma_f32 v29, v29, v22, v60
s_add_u32 m0, s40, 118784
s_waitcnt lgkmcnt(8)
v_mfma_f32_32x32x16_bf16 a[192:207], v[216:219], v[96:99], a[192:207]
ds_read_b64_tr_b16 v[96:97], v46 offset:12288
ds_read_b64_tr_b16 v[98:99], v46 offset:13312
buffer_load_dwordx4 v3, s[20:23], s77 offen offset:0 lds
v_fma_f32 v30, v30, v22, v60
v_fma_f32 v31, v31, v22, v60
v_cvt_pk_bf16_f32 v240, v24, v25
v_mfma_f32_32x32x16_bf16 a[208:223], v[216:219], v[100:103], a[208:223]
ds_read_b64_tr_b16 v[100:101], v49 offset:12288
ds_read_b64_tr_b16 v[102:103], v49 offset:13312
v_cvt_pk_bf16_f32 v241, v26, v27
v_cvt_pk_bf16_f32 v242, v28, v29
v_cvt_pk_bf16_f32 v243, v30, v31
s_waitcnt lgkmcnt(8)
v_mfma_f32_32x32x16_bf16 a[224:239], v[216:219], v[104:107], a[224:239]
s_waitcnt vmcnt(25)
s_barrier
ds_read_b64_tr_b16 v[104:105], v8 offset:16384
ds_read_b64_tr_b16 v[106:107], v8 offset:16896
v_lshlrev_b32 v24, 16, v244
v_and_b32 v25, 0xffff0000, v244
v_mfma_f32_32x32x16_bf16 a[240:255], v[108:111], v[216:219], a[240:255]
ds_read_b64_tr_b16 v[108:109], v11 offset:16384
ds_read_b64_tr_b16 v[110:111], v11 offset:16896
v_lshlrev_b32 v26, 16, v245
v_and_b32 v27, 0xffff0000, v245
s_add_u32 m0, s40, 122880
s_waitcnt lgkmcnt(8)
v_mfma_f32_32x32x16_bf16 a[192:207], v[220:223], v[88:91], a[192:207]
ds_read_b64_tr_b16 v[88:89], v8 offset:18432
ds_read_b64_tr_b16 v[90:91], v8 offset:18944
buffer_load_dwordx4 v3, s[20:23], s78 offen offset:0 lds
v_lshlrev_b32 v28, 16, v246
v_and_b32 v29, 0xffff0000, v246
v_lshlrev_b32 v30, 16, v247
v_mfma_f32_32x32x16_bf16 a[208:223], v[220:223], v[92:95], a[208:223]
ds_read_b64_tr_b16 v[92:93], v11 offset:18432
ds_read_b64_tr_b16 v[94:95], v11 offset:18944
v_and_b32 v31, 0xffff0000, v247
v_fma_f32 v24, v24, v22, v60
v_fma_f32 v25, v25, v22, v60
s_waitcnt lgkmcnt(8)
v_mfma_f32_32x32x16_bf16 a[224:239], v[220:223], v[96:99], a[224:239]
ds_read_b64_tr_b16 v[96:97], v40 offset:20480
ds_read_b64_tr_b16 v[98:99], v40 offset:21504
v_fma_f32 v26, v26, v22, v60
v_fma_f32 v27, v27, v22, v60
v_fma_f32 v28, v28, v22, v60
v_fma_f32 v29, v29, v22, v60
v_mfma_f32_32x32x16_bf16 a[240:255], v[100:103], v[220:223], a[240:255]
ds_read_b64_tr_b16 v[100:101], v43 offset:20480
ds_read_b64_tr_b16 v[102:103], v43 offset:21504
v_fma_f32 v30, v30, v22, v60
v_fma_f32 v31, v31, v22, v60
s_add_u32 m0, s40, 126976
s_waitcnt lgkmcnt(8)
v_mfma_f32_32x32x16_bf16 a[0:15], v[104:107], v[160:163], a[0:15]
ds_read_b64_tr_b16 v[104:105], v46 offset:20480
ds_read_b64_tr_b16 v[106:107], v46 offset:21504
buffer_load_dwordx4 v3, s[20:23], s79 offen offset:0 lds
v_cvt_pk_bf16_f32 v244, v24, v25
v_cvt_pk_bf16_f32 v245, v26, v27
v_cvt_pk_bf16_f32 v246, v28, v29
v_mfma_f32_32x32x16_bf16 a[16:31], v[108:111], v[160:163], a[16:31]
ds_read_b64_tr_b16 v[108:109], v49 offset:20480
ds_read_b64_tr_b16 v[110:111], v49 offset:21504
v_cvt_pk_bf16_f32 v247, v30, v31
v_lshlrev_b32 v24, 16, v248
v_and_b32 v25, 0xffff0000, v248
s_waitcnt lgkmcnt(8)
v_mfma_f32_32x32x16_bf16 a[32:47], v[88:91], v[160:163], a[32:47]
s_waitcnt vmcnt(25)
s_barrier
ds_read_b64_tr_b16 v[88:89], v40 offset:24576
ds_read_b64_tr_b16 v[90:91], v40 offset:25600
v_lshlrev_b32 v26, 16, v249
v_and_b32 v27, 0xffff0000, v249
v_mfma_f32_32x32x16_bf16 a[48:63], v[92:95], v[160:163], a[48:63]
ds_read_b64_tr_b16 v[92:93], v43 offset:24576
ds_read_b64_tr_b16 v[94:95], v43 offset:25600
v_lshlrev_b32 v28, 16, v250
v_and_b32 v29, 0xffff0000, v250
s_add_u32 m0, s40, 0
s_waitcnt lgkmcnt(8)
v_mfma_f32_32x32x16_bf16 a[192:207], v[224:227], v[96:99], a[192:207]
ds_read_b64_tr_b16 v[96:97], v46 offset:24576
ds_read_b64_tr_b16 v[98:99], v46 offset:25600
buffer_load_dwordx4 v3, s[20:23], s80 offen offset:0 lds
v_lshlrev_b32 v30, 16, v251
v_and_b32 v31, 0xffff0000, v251
v_fma_f32 v24, v24, v22, v60
v_mfma_f32_32x32x16_bf16 a[208:223], v[224:227], v[100:103], a[208:223]
ds_read_b64_tr_b16 v[100:101], v49 offset:24576
ds_read_b64_tr_b16 v[102:103], v49 offset:25600
v_fma_f32 v25, v25, v22, v60
v_fma_f32 v26, v26, v22, v60
v_fma_f32 v27, v27, v22, v60
s_waitcnt lgkmcnt(8)
v_mfma_f32_32x32x16_bf16 a[224:239], v[224:227], v[104:107], a[224:239]
ds_read_b64_tr_b16 v[104:105], v8 offset:28672
ds_read_b64_tr_b16 v[106:107], v8 offset:29184
v_fma_f32 v28, v28, v22, v60
v_fma_f32 v29, v29, v22, v60
v_fma_f32 v30, v30, v22, v60
v_fma_f32 v31, v31, v22, v60
v_mfma_f32_32x32x16_bf16 a[240:255], v[108:111], v[224:227], a[240:255]
ds_read_b64_tr_b16 v[108:109], v11 offset:28672
ds_read_b64_tr_b16 v[110:111], v11 offset:29184
v_cvt_pk_bf16_f32 v248, v24, v25
v_cvt_pk_bf16_f32 v249, v26, v27
s_add_u32 m0, s40, 4096
s_waitcnt lgkmcnt(8)
v_mfma_f32_32x32x16_bf16 a[192:207], v[228:231], v[88:91], a[192:207]
ds_read_b64_tr_b16 v[88:89], v8 offset:30720
ds_read_b64_tr_b16 v[90:91], v8 offset:31232
buffer_load_dwordx4 v3, s[20:23], s81 offen offset:0 lds
v_cvt_pk_bf16_f32 v250, v28, v29
v_cvt_pk_bf16_f32 v251, v30, v31
v_lshlrev_b32 v24, 16, v252
v_mfma_f32_32x32x16_bf16 a[208:223], v[228:231], v[92:95], a[208:223]
ds_read_b64_tr_b16 v[92:93], v11 offset:30720
ds_read_b64_tr_b16 v[94:95], v11 offset:31232
v_and_b32 v25, 0xffff0000, v252
v_lshlrev_b32 v26, 16, v253
v_and_b32 v27, 0xffff0000, v253
s_waitcnt lgkmcnt(8)
v_mfma_f32_32x32x16_bf16 a[224:239], v[228:231], v[96:99], a[224:239]
s_waitcnt vmcnt(25)
s_barrier
ds_read_b64_tr_b16 v[96:97], v40 offset:32768
ds_read_b64_tr_b16 v[98:99], v40 offset:33792
s_mov_b32 s41, 65536
buffer_store_dwordx4 a[176:179], v21, s[36:39], s41 offen offset:0 sc1
v_mfma_f32_32x32x16_bf16 a[240:255], v[100:103], v[228:231], a[240:255]
ds_read_b64_tr_b16 v[100:101], v43 offset:32768
ds_read_b64_tr_b16 v[102:103], v43 offset:33792
v_lshlrev_b32 v28, 16, v254
v_and_b32 v29, 0xffff0000, v254
s_add_u32 m0, s40, 8192
s_waitcnt lgkmcnt(8)
v_mfma_f32_32x32x16_bf16 a[0:15], v[104:107], v[164:167], a[0:15]
ds_read_b64_tr_b16 v[104:105], v46 offset:32768
ds_read_b64_tr_b16 v[106:107], v46 offset:33792
buffer_load_dwordx4 v3, s[20:23], s82 offen offset:0 lds
v_lshlrev_b32 v30, 16, v255
v_and_b32 v31, 0xffff0000, v255
v_fma_f32 v24, v24, v22, v60
v_mfma_f32_32x32x16_bf16 a[16:31], v[108:111], v[164:167], a[16:31]
ds_read_b64_tr_b16 v[108:109], v49 offset:32768
ds_read_b64_tr_b16 v[110:111], v49 offset:33792
v_fma_f32 v25, v25, v22, v60
v_fma_f32 v26, v26, v22, v60
v_fma_f32 v27, v27, v22, v60
s_waitcnt lgkmcnt(8)
v_mfma_f32_32x32x16_bf16 a[32:47], v[88:91], v[164:167], a[32:47]
ds_read_b64_tr_b16 v[88:89], v40 offset:36864
ds_read_b64_tr_b16 v[90:91], v40 offset:37888
v_fma_f32 v28, v28, v22, v60
v_fma_f32 v29, v29, v22, v60
v_fma_f32 v30, v30, v22, v60
v_fma_f32 v31, v31, v22, v60
v_mfma_f32_32x32x16_bf16 a[48:63], v[92:95], v[164:167], a[48:63]
ds_read_b64_tr_b16 v[92:93], v43 offset:36864
ds_read_b64_tr_b16 v[94:95], v43 offset:37888
v_cvt_pk_bf16_f32 v252, v24, v25
v_cvt_pk_bf16_f32 v253, v26, v27
s_add_u32 m0, s40, 12288
s_waitcnt lgkmcnt(8)
v_mfma_f32_32x32x16_bf16 a[192:207], v[232:235], v[96:99], a[192:207]
ds_read_b64_tr_b16 v[96:97], v46 offset:36864
ds_read_b64_tr_b16 v[98:99], v46 offset:37888
buffer_load_dwordx4 v3, s[20:23], s83 offen offset:0 lds
v_cvt_pk_bf16_f32 v254, v28, v29
v_cvt_pk_bf16_f32 v255, v30, v31
v_mfma_f32_32x32x16_bf16 a[208:223], v[232:235], v[100:103], a[208:223]
ds_read_b64_tr_b16 v[100:101], v49 offset:36864
ds_read_b64_tr_b16 v[102:103], v49 offset:37888
s_waitcnt lgkmcnt(8)
v_mfma_f32_32x32x16_bf16 a[224:239], v[232:235], v[104:107], a[224:239]
s_waitcnt vmcnt(26)
s_barrier
ds_read_b64_tr_b16 v[104:105], v8 offset:40960
ds_read_b64_tr_b16 v[106:107], v8 offset:41472
v_mfma_f32_32x32x16_bf16 a[240:255], v[108:111], v[232:235], a[240:255]
ds_read_b64_tr_b16 v[108:109], v11 offset:40960
ds_read_b64_tr_b16 v[110:111], v11 offset:41472
s_add_u32 m0, s40, 16256
s_waitcnt lgkmcnt(8)
v_mfma_f32_32x32x16_bf16 a[192:207], v[236:239], v[88:91], a[192:207]
ds_read_b64_tr_b16 v[88:89], v8 offset:43008
ds_read_b64_tr_b16 v[90:91], v8 offset:43520
buffer_load_dwordx4 v3, s[20:23], s48 offen offset:128 lds
v_mfma_f32_32x32x16_bf16 a[208:223], v[236:239], v[92:95], a[208:223]
ds_read_b64_tr_b16 v[92:93], v11 offset:43008
ds_read_b64_tr_b16 v[94:95], v11 offset:43520
s_waitcnt lgkmcnt(8)
v_mfma_f32_32x32x16_bf16 a[224:239], v[236:239], v[96:99], a[224:239]
ds_read_b64_tr_b16 v[96:97], v40 offset:45056
ds_read_b64_tr_b16 v[98:99], v40 offset:46080
v_mfma_f32_32x32x16_bf16 a[240:255], v[100:103], v[236:239], a[240:255]
ds_read_b64_tr_b16 v[100:101], v43 offset:45056
ds_read_b64_tr_b16 v[102:103], v43 offset:46080
s_add_u32 m0, s40, 20352
s_waitcnt lgkmcnt(8)
v_mfma_f32_32x32x16_bf16 a[0:15], v[104:107], v[168:171], a[0:15]
ds_read_b64_tr_b16 v[104:105], v46 offset:45056
ds_read_b64_tr_b16 v[106:107], v46 offset:46080
buffer_load_dwordx4 v3, s[20:23], s49 offen offset:128 lds
v_mfma_f32_32x32x16_bf16 a[16:31], v[108:111], v[168:171], a[16:31]
ds_read_b64_tr_b16 v[108:109], v49 offset:45056
ds_read_b64_tr_b16 v[110:111], v49 offset:46080
s_waitcnt lgkmcnt(8)
v_mfma_f32_32x32x16_bf16 a[32:47], v[88:91], v[168:171], a[32:47]
s_waitcnt vmcnt(26)
s_barrier
ds_read_b64_tr_b16 v[88:89], v40 offset:49152
ds_read_b64_tr_b16 v[90:91], v40 offset:50176
v_mfma_f32_32x32x16_bf16 a[48:63], v[92:95], v[168:171], a[48:63]
ds_read_b64_tr_b16 v[92:93], v43 offset:49152
ds_read_b64_tr_b16 v[94:95], v43 offset:50176
s_add_u32 m0, s40, 24448
s_waitcnt lgkmcnt(8)
v_mfma_f32_32x32x16_bf16 a[192:207], v[240:243], v[96:99], a[192:207]
ds_read_b64_tr_b16 v[96:97], v46 offset:49152
ds_read_b64_tr_b16 v[98:99], v46 offset:50176
buffer_load_dwordx4 v3, s[20:23], s50 offen offset:128 lds
v_mfma_f32_32x32x16_bf16 a[208:223], v[240:243], v[100:103], a[208:223]
ds_read_b64_tr_b16 v[100:101], v49 offset:49152
ds_read_b64_tr_b16 v[102:103], v49 offset:50176
s_waitcnt lgkmcnt(8)
v_mfma_f32_32x32x16_bf16 a[224:239], v[240:243], v[104:107], a[224:239]
ds_read_b64_tr_b16 v[104:105], v8 offset:53248
ds_read_b64_tr_b16 v[106:107], v8 offset:53760
s_mov_b32 s41, 65536
buffer_store_dwordx4 a[176:179], v21, s[36:39], s41 offen offset:1024 sc1
v_mfma_f32_32x32x16_bf16 a[240:255], v[108:111], v[240:243], a[240:255]
ds_read_b64_tr_b16 v[108:109], v11 offset:53248
ds_read_b64_tr_b16 v[110:111], v11 offset:53760
s_add_u32 m0, s40, 28544
s_waitcnt lgkmcnt(8)
v_mfma_f32_32x32x16_bf16 a[192:207], v[244:247], v[88:91], a[192:207]
ds_read_b64_tr_b16 v[88:89], v8 offset:55296
ds_read_b64_tr_b16 v[90:91], v8 offset:55808
buffer_load_dwordx4 v3, s[20:23], s51 offen offset:128 lds
v_mfma_f32_32x32x16_bf16 a[208:223], v[244:247], v[92:95], a[208:223]
ds_read_b64_tr_b16 v[92:93], v11 offset:55296
ds_read_b64_tr_b16 v[94:95], v11 offset:55808
s_waitcnt lgkmcnt(8)
v_mfma_f32_32x32x16_bf16 a[224:239], v[244:247], v[96:99], a[224:239]
s_waitcnt vmcnt(27)
s_barrier
ds_read_b64_tr_b16 v[96:97], v40 offset:57344
ds_read_b64_tr_b16 v[98:99], v40 offset:58368
v_mfma_f32_32x32x16_bf16 a[240:255], v[100:103], v[244:247], a[240:255]
ds_read_b64_tr_b16 v[100:101], v43 offset:57344
ds_read_b64_tr_b16 v[102:103], v43 offset:58368
s_add_u32 m0, s40, 32640
s_waitcnt lgkmcnt(8)
v_mfma_f32_32x32x16_bf16 a[0:15], v[104:107], v[172:175], a[0:15]
ds_read_b64_tr_b16 v[104:105], v46 offset:57344
ds_read_b64_tr_b16 v[106:107], v46 offset:58368
buffer_load_dwordx4 v3, s[20:23], s52 offen offset:128 lds
v_mfma_f32_32x32x16_bf16 a[16:31], v[108:111], v[172:175], a[16:31]
ds_read_b64_tr_b16 v[108:109], v49 offset:57344
ds_read_b64_tr_b16 v[110:111], v49 offset:58368
s_waitcnt lgkmcnt(8)
v_mfma_f32_32x32x16_bf16 a[32:47], v[88:91], v[172:175], a[32:47]
ds_read_b64_tr_b16 v[88:89], v40 offset:61440
ds_read_b64_tr_b16 v[90:91], v40 offset:62464
v_mfma_f32_32x32x16_bf16 a[48:63], v[92:95], v[172:175], a[48:63]
ds_read_b64_tr_b16 v[92:93], v43 offset:61440
ds_read_b64_tr_b16 v[94:95], v43 offset:62464
s_add_u32 m0, s40, 36736
s_waitcnt lgkmcnt(8)
v_mfma_f32_32x32x16_bf16 a[192:207], v[248:251], v[96:99], a[192:207]
ds_read_b64_tr_b16 v[96:97], v46 offset:61440
ds_read_b64_tr_b16 v[98:99], v46 offset:62464
buffer_load_dwordx4 v3, s[20:23], s53 offen offset:128 lds
v_mfma_f32_32x32x16_bf16 a[208:223], v[248:251], v[100:103], a[208:223]
ds_read_b64_tr_b16 v[100:101], v49 offset:61440
ds_read_b64_tr_b16 v[102:103], v49 offset:62464
s_waitcnt lgkmcnt(8)
v_mfma_f32_32x32x16_bf16 a[224:239], v[248:251], v[104:107], a[224:239]
s_waitcnt vmcnt(27)
s_barrier
ds_read_b64_tr_b16 v[104:105], v9 offset:0
ds_read_b64_tr_b16 v[106:107], v9 offset:512
v_mfma_f32_32x32x16_bf16 a[240:255], v[108:111], v[248:251], a[240:255]
ds_read_b64_tr_b16 v[108:109], v12 offset:0
ds_read_b64_tr_b16 v[110:111], v12 offset:512
s_add_u32 m0, s40, 40832
s_waitcnt lgkmcnt(8)
v_mfma_f32_32x32x16_bf16 a[192:207], v[252:255], v[88:91], a[192:207]
ds_read_b64_tr_b16 v[88:89], v9 offset:2048
ds_read_b64_tr_b16 v[90:91], v9 offset:2560
buffer_load_dwordx4 v3, s[20:23], s54 offen offset:128 lds
v_mfma_f32_32x32x16_bf16 a[208:223], v[252:255], v[92:95], a[208:223]
ds_read_b64_tr_b16 v[92:93], v12 offset:2048
ds_read_b64_tr_b16 v[94:95], v12 offset:2560
s_waitcnt lgkmcnt(8)
v_mfma_f32_32x32x16_bf16 a[224:239], v[252:255], v[96:99], a[224:239]
ds_read_b64_tr_b16 v[96:97], v9 offset:4096
ds_read_b64_tr_b16 v[98:99], v9 offset:4608
v_mfma_f32_32x32x16_bf16 a[240:255], v[100:103], v[252:255], a[240:255]
ds_read_b64_tr_b16 v[100:101], v12 offset:4096
ds_read_b64_tr_b16 v[102:103], v12 offset:4608
s_add_u32 m0, s40, 44928
s_waitcnt lgkmcnt(8)
v_mfma_f32_32x32x16_bf16 a[0:15], v[104:107], v[176:179], a[0:15]
ds_read_b64_tr_b16 v[104:105], v9 offset:6144
ds_read_b64_tr_b16 v[106:107], v9 offset:6656
buffer_load_dwordx4 v3, s[20:23], s55 offen offset:128 lds
v_mfma_f32_32x32x16_bf16 a[16:31], v[108:111], v[176:179], a[16:31]
ds_read_b64_tr_b16 v[108:109], v12 offset:6144
ds_read_b64_tr_b16 v[110:111], v12 offset:6656
s_waitcnt lgkmcnt(8)
v_mfma_f32_32x32x16_bf16 a[32:47], v[88:91], v[176:179], a[32:47]
s_waitcnt vmcnt(27)
s_barrier
ds_read_b64_tr_b16 v[88:89], v9 offset:8192
ds_read_b64_tr_b16 v[90:91], v9 offset:8704
s_mov_b32 s41, 65536
buffer_store_dwordx4 a[176:179], v21, s[36:39], s41 offen offset:2048 sc1
v_mfma_f32_32x32x16_bf16 a[48:63], v[92:95], v[176:179], a[48:63]
ds_read_b64_tr_b16 v[92:93], v12 offset:8192
ds_read_b64_tr_b16 v[94:95], v12 offset:8704
v_mov_b32 v73, s42
s_mul_i32 s7, s3, 6144
s_add_u32 m0, s40, 49024
s_waitcnt lgkmcnt(8)
v_mfma_f32_32x32x16_bf16 a[0:15], v[96:99], v[180:183], a[0:15]
ds_read_b64_tr_b16 v[96:97], v9 offset:10240
ds_read_b64_tr_b16 v[98:99], v9 offset:10752
buffer_load_dwordx4 v3, s[20:23], s56 offen offset:128 lds
s_add_u32 s7, s7, 131072
v_lshl_add_u32 v74, v1, 4, s7
s_mov_b32 s94, 0x30
v_mfma_f32_32x32x16_bf16 a[16:31], v[100:103], v[180:183], a[16:31]
ds_read_b64_tr_b16 v[100:101], v12 offset:10240
ds_read_b64_tr_b16 v[102:103], v12 offset:10752
s_mov_b32 s95, 0x30
v_accvgpr_read_b32 v40, a192
v_accvgpr_read_b32 v41, a193
s_waitcnt lgkmcnt(8)
v_mfma_f32_32x32x16_bf16 a[32:47], v[104:107], v[180:183], a[32:47]
ds_read_b64_tr_b16 v[104:105], v9 offset:12288
ds_read_b64_tr_b16 v[106:107], v9 offset:12800
v_fma_f32 v42, v40, s43, v19
v_fma_f32 v43, v41, s43, v19
v_exp_f32 v42, v42 clamp
v_mfma_f32_32x32x16_bf16 a[48:63], v[108:111], v[180:183], a[48:63]
ds_read_b64_tr_b16 v[108:109], v12 offset:12288
ds_read_b64_tr_b16 v[110:111], v12 offset:12800
v_max_f32 v40, s46, v40
s_add_u32 m0, s40, 53120
s_waitcnt lgkmcnt(8)
v_mfma_f32_32x32x16_bf16 a[0:15], v[88:91], v[184:187], a[0:15]
ds_read_b64_tr_b16 v[88:89], v9 offset:14336
ds_read_b64_tr_b16 v[90:91], v9 offset:14848
buffer_load_dwordx4 v3, s[20:23], s57 offen offset:128 lds
v_exp_f32 v43, v43 clamp
v_max_f32 v41, s46, v41
v_mfma_f32_32x32x16_bf16 a[16:31], v[92:95], v[184:187], a[16:31]
ds_read_b64_tr_b16 v[92:93], v12 offset:14336
ds_read_b64_tr_b16 v[94:95], v12 offset:14848
v_add_f32 v40, v40, v42
v_add_f32 v41, v41, v43
v_cvt_pk_bf16_f32 v48, v40, v41
s_waitcnt lgkmcnt(8)
v_mfma_f32_32x32x16_bf16 a[32:47], v[96:99], v[184:187], a[32:47]
s_waitcnt vmcnt(28)
s_barrier
ds_read_b64_tr_b16 v[96:97], v9 offset:16384
ds_read_b64_tr_b16 v[98:99], v9 offset:16896
v_accvgpr_read_b32 v44, a194
v_accvgpr_read_b32 v45, a195
v_mfma_f32_32x32x16_bf16 a[48:63], v[100:103], v[184:187], a[48:63]
ds_read_b64_tr_b16 v[100:101], v12 offset:16384
ds_read_b64_tr_b16 v[102:103], v12 offset:16896
v_fma_f32 v46, v44, s43, v19
v_fma_f32 v47, v45, s43, v19
s_add_u32 m0, s40, 57216
s_waitcnt lgkmcnt(8)
v_mfma_f32_32x32x16_bf16 a[0:15], v[104:107], v[188:191], a[0:15]
ds_read_b64_tr_b16 v[104:105], v9 offset:18432
ds_read_b64_tr_b16 v[106:107], v9 offset:18944
buffer_load_dwordx4 v3, s[20:23], s58 offen offset:128 lds
v_exp_f32 v46, v46 clamp
v_max_f32 v44, s46, v44
v_mfma_f32_32x32x16_bf16 a[16:31], v[108:111], v[188:191], a[16:31]
ds_read_b64_tr_b16 v[108:109], v12 offset:18432
ds_read_b64_tr_b16 v[110:111], v12 offset:18944
v_exp_f32 v47, v47 clamp
v_max_f32 v45, s46, v45
s_waitcnt lgkmcnt(8)
v_mfma_f32_32x32x16_bf16 a[32:47], v[88:91], v[188:191], a[32:47]
ds_read_b64_tr_b16 v[88:89], v9 offset:20480
ds_read_b64_tr_b16 v[90:91], v9 offset:20992
v_add_f32 v44, v44, v46
v_add_f32 v45, v45, v47
v_cvt_pk_bf16_f32 v49, v44, v45
v_accvgpr_read_b32 v40, a196
v_mfma_f32_32x32x16_bf16 a[48:63], v[92:95], v[188:191], a[48:63]
ds_read_b64_tr_b16 v[92:93], v12 offset:20480
ds_read_b64_tr_b16 v[94:95], v12 offset:20992
v_accvgpr_read_b32 v41, a197
v_fma_f32 v42, v40, s43, v19
s_add_u32 m0, s40, 61312
s_waitcnt lgkmcnt(8)
v_mfma_f32_32x32x16_bf16 a[0:15], v[96:99], v[192:195], a[0:15]
ds_read_b64_tr_b16 v[96:97], v9 offset:22528
ds_read_b64_tr_b16 v[98:99], v9 offset:23040
buffer_load_dwordx4 v3, s[20:23], s59 offen offset:128 lds
v_fma_f32 v43, v41, s43, v19
v_exp_f32 v42, v42 clamp
v_mfma_f32_32x32x16_bf16 a[16:31], v[100:103], v[192:195], a[16:31]
ds_read_b64_tr_b16 v[100:101], v12 offset:22528
ds_read_b64_tr_b16 v[102:103], v12 offset:23040
v_max_f32 v40, s46, v40
v_exp_f32 v43, v43 clamp
s_waitcnt lgkmcnt(8)
v_mfma_f32_32x32x16_bf16 a[32:47], v[104:107], v[192:195], a[32:47]
s_waitcnt vmcnt(28)
s_barrier
ds_read_b64_tr_b16 v[104:105], v9 offset:24576
ds_read_b64_tr_b16 v[106:107], v9 offset:25088
v_max_f32 v41, s46, v41
v_add_f32 v40, v40, v42
v_mfma_f32_32x32x16_bf16 a[48:63], v[108:111], v[192:195], a[48:63]
ds_read_b64_tr_b16 v[108:109], v12 offset:24576
ds_read_b64_tr_b16 v[110:111], v12 offset:25088
v_add_f32 v41, v41, v43
v_cvt_pk_bf16_f32 v50, v40, v41
s_add_u32 m0, s40, 65408
s_waitcnt lgkmcnt(8)
v_mfma_f32_32x32x16_bf16 a[0:15], v[88:91], v[196:199], a[0:15]
ds_read_b64_tr_b16 v[88:89], v9 offset:26624
ds_read_b64_tr_b16 v[90:91], v9 offset:27136
buffer_load_dwordx4 v3, s[20:23], s60 offen offset:128 lds
v_accvgpr_read_b32 v44, a198
v_accvgpr_read_b32 v45, a199
v_fma_f32 v46, v44, s43, v19
v_mfma_f32_32x32x16_bf16 a[16:31], v[92:95], v[196:199], a[16:31]
ds_read_b64_tr_b16 v[92:93], v12 offset:26624
ds_read_b64_tr_b16 v[94:95], v12 offset:27136
v_fma_f32 v47, v45, s43, v19
v_exp_f32 v46, v46 clamp
s_waitcnt lgkmcnt(8)
v_mfma_f32_32x32x16_bf16 a[32:47], v[96:99], v[196:199], a[32:47]
ds_read_b64_tr_b16 v[96:97], v9 offset:28672
ds_read_b64_tr_b16 v[98:99], v9 offset:29184
buffer_load_dword a182, v10, s[20:23], 0 offen offset:384
v_max_f32 v44, s46, v44
v_exp_f32 v47, v47 clamp
v_mfma_f32_32x32x16_bf16 a[48:63], v[100:103], v[196:199], a[48:63]
ds_read_b64_tr_b16 v[100:101], v12 offset:28672
ds_read_b64_tr_b16 v[102:103], v12 offset:29184
s_mov_b32 s41, 65536
buffer_store_dwordx4 a[176:179], v21, s[36:39], s41 offen offset:3072 sc1
s_add_u32 m0, s40, 69504
s_waitcnt lgkmcnt(8)
v_mfma_f32_32x32x16_bf16 a[0:15], v[104:107], v[200:203], a[0:15]
ds_read_b64_tr_b16 v[104:105], v9 offset:30720
ds_read_b64_tr_b16 v[106:107], v9 offset:31232
buffer_load_dwordx4 v3, s[20:23], s61 offen offset:128 lds
v_max_f32 v45, s46, v45
v_add_f32 v44, v44, v46
v_add_f32 v45, v45, v47
v_mfma_f32_32x32x16_bf16 a[16:31], v[108:111], v[200:203], a[16:31]
ds_read_b64_tr_b16 v[108:109], v12 offset:30720
ds_read_b64_tr_b16 v[110:111], v12 offset:31232
v_cvt_pk_bf16_f32 v51, v44, v45
v_accvgpr_read_b32 v40, a200
v_accvgpr_read_b32 v41, a201
s_waitcnt lgkmcnt(8)
v_mfma_f32_32x32x16_bf16 a[32:47], v[88:91], v[200:203], a[32:47]
s_waitcnt vmcnt(30)
s_barrier
ds_read_b64_tr_b16 v[88:89], v9 offset:32768
ds_read_b64_tr_b16 v[90:91], v9 offset:33280
v_fma_f32 v42, v40, s43, v19
v_fma_f32 v43, v41, s43, v19
v_mfma_f32_32x32x16_bf16 a[48:63], v[92:95], v[200:203], a[48:63]
ds_read_b64_tr_b16 v[92:93], v12 offset:32768
ds_read_b64_tr_b16 v[94:95], v12 offset:33280
v_exp_f32 v42, v42 clamp
s_add_u32 m0, s40, 73600
s_waitcnt lgkmcnt(8)
v_mfma_f32_32x32x16_bf16 a[0:15], v[96:99], v[204:207], a[0:15]
ds_read_b64_tr_b16 v[96:97], v9 offset:34816
ds_read_b64_tr_b16 v[98:99], v9 offset:35328
buffer_load_dwordx4 v3, s[20:23], s62 offen offset:128 lds
v_max_f32 v40, s46, v40
v_exp_f32 v43, v43 clamp
v_mfma_f32_32x32x16_bf16 a[16:31], v[100:103], v[204:207], a[16:31]
ds_read_b64_tr_b16 v[100:101], v12 offset:34816
ds_read_b64_tr_b16 v[102:103], v12 offset:35328
v_max_f32 v41, s46, v41
v_add_f32 v40, v40, v42
v_add_f32 v41, v41, v43
s_waitcnt lgkmcnt(8)
v_mfma_f32_32x32x16_bf16 a[32:47], v[104:107], v[204:207], a[32:47]
ds_read_b64_tr_b16 v[104:105], v9 offset:36864
ds_read_b64_tr_b16 v[106:107], v9 offset:37376
v_cvt_pk_bf16_f32 v52, v40, v41
v_accvgpr_read_b32 v44, a202
v_accvgpr_read_b32 v45, a203
v_fma_f32 v46, v44, s43, v19
v_mfma_f32_32x32x16_bf16 a[48:63], v[108:111], v[204:207], a[48:63]
ds_read_b64_tr_b16 v[108:109], v12 offset:36864
ds_read_b64_tr_b16 v[110:111], v12 offset:37376
v_fma_f32 v47, v45, s43, v19
s_add_u32 m0, s40, 77696
s_waitcnt lgkmcnt(8)
v_mfma_f32_32x32x16_bf16 a[0:15], v[88:91], v[208:211], a[0:15]
ds_read_b64_tr_b16 v[88:89], v9 offset:38912
ds_read_b64_tr_b16 v[90:91], v9 offset:39424
buffer_load_dwordx4 v3, s[20:23], s63 offen offset:128 lds
v_exp_f32 v46, v46 clamp
v_max_f32 v44, s46, v44
v_mfma_f32_32x32x16_bf16 a[16:31], v[92:95], v[208:211], a[16:31]
ds_read_b64_tr_b16 v[92:93], v12 offset:38912
ds_read_b64_tr_b16 v[94:95], v12 offset:39424
v_exp_f32 v47, v47 clamp
v_max_f32 v45, s46, v45
s_waitcnt lgkmcnt(8)
v_mfma_f32_32x32x16_bf16 a[32:47], v[96:99], v[208:211], a[32:47]
s_waitcnt vmcnt(30)
s_barrier
ds_read_b64_tr_b16 v[96:97], v9 offset:40960
ds_read_b64_tr_b16 v[98:99], v9 offset:41472
v_add_f32 v44, v44, v46
v_add_f32 v45, v45, v47
v_mfma_f32_32x32x16_bf16 a[48:63], v[100:103], v[208:211], a[48:63]
ds_read_b64_tr_b16 v[100:101], v12 offset:40960
ds_read_b64_tr_b16 v[102:103], v12 offset:41472
v_cvt_pk_bf16_f32 v53, v44, v45
v_accvgpr_read_b32 v40, a204
s_add_u32 m0, s40, 81792
s_waitcnt lgkmcnt(8)
v_mfma_f32_32x32x16_bf16 a[0:15], v[104:107], v[212:215], a[0:15]
ds_read_b64_tr_b16 v[104:105], v9 offset:43008
ds_read_b64_tr_b16 v[106:107], v9 offset:43520
buffer_load_dwordx4 v3, s[20:23], s64 offen offset:128 lds
v_accvgpr_read_b32 v41, a205
v_fma_f32 v42, v40, s43, v19
v_fma_f32 v43, v41, s43, v19
v_mfma_f32_32x32x16_bf16 a[16:31], v[108:111], v[212:215], a[16:31]
ds_read_b64_tr_b16 v[108:109], v12 offset:43008
ds_read_b64_tr_b16 v[110:111], v12 offset:43520
v_exp_f32 v42, v42 clamp
v_max_f32 v40, s46, v40
s_waitcnt lgkmcnt(8)
v_mfma_f32_32x32x16_bf16 a[32:47], v[88:91], v[212:215], a[32:47]
ds_read_b64_tr_b16 v[88:89], v9 offset:45056
ds_read_b64_tr_b16 v[90:91], v9 offset:45568
v_exp_f32 v43, v43 clamp
v_max_f32 v41, s46, v41
v_add_f32 v40, v40, v42
v_mfma_f32_32x32x16_bf16 a[48:63], v[92:95], v[212:215], a[48:63]
ds_read_b64_tr_b16 v[92:93], v12 offset:45056
ds_read_b64_tr_b16 v[94:95], v12 offset:45568
v_add_f32 v41, v41, v43
v_cvt_pk_bf16_f32 v54, v40, v41
s_add_u32 m0, s40, 85888
s_waitcnt lgkmcnt(8)
v_mfma_f32_32x32x16_bf16 a[0:15], v[96:99], v[216:219], a[0:15]
ds_read_b64_tr_b16 v[96:97], v9 offset:47104
ds_read_b64_tr_b16 v[98:99], v9 offset:47616
buffer_load_dwordx4 v3, s[20:23], s65 offen offset:128 lds
v_accvgpr_read_b32 v44, a206
v_accvgpr_read_b32 v45, a207
v_fma_f32 v46, v44, s43, v19
v_mfma_f32_32x32x16_bf16 a[16:31], v[100:103], v[216:219], a[16:31]
ds_read_b64_tr_b16 v[100:101], v12 offset:47104
ds_read_b64_tr_b16 v[102:103], v12 offset:47616
v_fma_f32 v47, v45, s43, v19
v_exp_f32 v46, v46 clamp
s_waitcnt lgkmcnt(8)
v_mfma_f32_32x32x16_bf16 a[32:47], v[104:107], v[216:219], a[32:47]
s_waitcnt vmcnt(29)
s_barrier
ds_read_b64_tr_b16 v[104:105], v9 offset:49152
ds_read_b64_tr_b16 v[106:107], v9 offset:49664
v_max_f32 v44, s46, v44
v_mfma_f32_32x32x16_bf16 a[48:63], v[108:111], v[216:219], a[48:63]
ds_read_b64_tr_b16 v[108:109], v12 offset:49152
ds_read_b64_tr_b16 v[110:111], v12 offset:49664
v_exp_f32 v47, v47 clamp
s_add_u32 m0, s40, 89984
s_waitcnt lgkmcnt(8)
v_mfma_f32_32x32x16_bf16 a[0:15], v[88:91], v[220:223], a[0:15]
ds_read_b64_tr_b16 v[88:89], v9 offset:51200
ds_read_b64_tr_b16 v[90:91], v9 offset:51712
buffer_load_dwordx4 v3, s[20:23], s66 offen offset:128 lds
v_max_f32 v45, s46, v45
v_add_f32 v44, v44, v46
v_add_f32 v45, v45, v47
v_mfma_f32_32x32x16_bf16 a[16:31], v[92:95], v[220:223], a[16:31]
ds_read_b64_tr_b16 v[92:93], v12 offset:51200
ds_read_b64_tr_b16 v[94:95], v12 offset:51712
v_cvt_pk_bf16_f32 v55, v44, v45
ds_write_b128 v74, v[48:51] offset:0
ds_write_b128 v74, v[52:55] offset:1024
s_waitcnt lgkmcnt(10)
v_mfma_f32_32x32x16_bf16 a[32:47], v[96:99], v[220:223], a[32:47]
ds_read_b64_tr_b16 v[96:97], v9 offset:53248
ds_read_b64_tr_b16 v[98:99], v9 offset:53760
v_accvgpr_read_b32 v40, a208
v_accvgpr_read_b32 v41, a209
v_cvt_pk_bf16_f32 v56, v40, v41
v_accvgpr_read_b32 v44, a210
v_mfma_f32_32x32x16_bf16 a[48:63], v[100:103], v[220:223], a[48:63]
ds_read_b64_tr_b16 v[100:101], v12 offset:53248
ds_read_b64_tr_b16 v[102:103], v12 offset:53760
v_accvgpr_read_b32 v45, a211
v_cvt_pk_bf16_f32 v57, v44, v45
s_add_u32 m0, s40, 94080
s_waitcnt lgkmcnt(10)
v_mfma_f32_32x32x16_bf16 a[0:15], v[104:107], v[224:227], a[0:15]
ds_read_b64_tr_b16 v[104:105], v9 offset:55296
ds_read_b64_tr_b16 v[106:107], v9 offset:55808
buffer_load_dwordx4 v3, s[20:23], s67 offen offset:128 lds
v_accvgpr_read_b32 v40, a212
v_accvgpr_read_b32 v41, a213
v_cvt_pk_bf16_f32 v58, v40, v41
v_mfma_f32_32x32x16_bf16 a[16:31], v[108:111], v[224:227], a[16:31]
ds_read_b64_tr_b16 v[108:109], v12 offset:55296
ds_read_b64_tr_b16 v[110:111], v12 offset:55808
v_accvgpr_read_b32 v44, a214
v_accvgpr_read_b32 v45, a215
v_cvt_pk_bf16_f32 v59, v44, v45
s_waitcnt lgkmcnt(10)
v_mfma_f32_32x32x16_bf16 a[32:47], v[88:91], v[224:227], a[32:47]
s_waitcnt vmcnt(29)
s_barrier
ds_read_b64_tr_b16 v[88:89], v9 offset:57344
ds_read_b64_tr_b16 v[90:91], v9 offset:57856
v_accvgpr_read_b32 v40, a216
v_accvgpr_read_b32 v41, a217
v_mfma_f32_32x32x16_bf16 a[48:63], v[92:95], v[224:227], a[48:63]
ds_read_b64_tr_b16 v[92:93], v12 offset:57344
ds_read_b64_tr_b16 v[94:95], v12 offset:57856
v_cvt_pk_bf16_f32 v60, v40, v41
v_accvgpr_read_b32 v44, a218
s_add_u32 m0, s40, 98176
s_waitcnt lgkmcnt(8)
v_mfma_f32_32x32x16_bf16 a[0:15], v[96:99], v[228:231], a[0:15]
ds_read_b64_tr_b16 v[96:97], v9 offset:59392
ds_read_b64_tr_b16 v[98:99], v9 offset:59904
buffer_load_dwordx4 v3, s[20:23], s68 offen offset:128 lds
v_accvgpr_read_b32 v45, a219
v_cvt_pk_bf16_f32 v61, v44, v45
v_accvgpr_read_b32 v40, a220
v_mfma_f32_32x32x16_bf16 a[16:31], v[100:103], v[228:231], a[16:31]
ds_read_b64_tr_b16 v[100:101], v12 offset:59392
ds_read_b64_tr_b16 v[102:103], v12 offset:59904
v_accvgpr_read_b32 v41, a221
v_cvt_pk_bf16_f32 v62, v40, v41
v_accvgpr_read_b32 v44, a222
s_waitcnt lgkmcnt(8)
v_mfma_f32_32x32x16_bf16 a[32:47], v[104:107], v[228:231], a[32:47]
ds_read_b64_tr_b16 v[104:105], v9 offset:61440
ds_read_b64_tr_b16 v[106:107], v9 offset:61952
v_accvgpr_read_b32 v45, a223
v_cvt_pk_bf16_f32 v63, v44, v45
ds_write_b128 v74, v[56:59] offset:2048
ds_write_b128 v74, v[60:63] offset:3072
v_mfma_f32_32x32x16_bf16 a[48:63], v[108:111], v[228:231], a[48:63]
ds_read_b64_tr_b16 v[108:109], v12 offset:61440
ds_read_b64_tr_b16 v[110:111], v12 offset:61952
v_accvgpr_read_b32 v40, a224
v_accvgpr_read_b32 v41, a225
s_add_u32 m0, s40, 102272
s_waitcnt lgkmcnt(10)
v_mfma_f32_32x32x16_bf16 a[0:15], v[88:91], v[232:235], a[0:15]
ds_read_b64_tr_b16 v[88:89], v9 offset:63488
ds_read_b64_tr_b16 v[90:91], v9 offset:64000
buffer_load_dwordx4 v3, s[20:23], s69 offen offset:128 lds
v_fma_f32 v42, v40, s43, v19
v_fma_f32 v43, v41, s43, v19
v_cvt_pk_bf16_f32 v72, v40, v41
v_mfma_f32_32x32x16_bf16 a[16:31], v[92:95], v[232:235], a[16:31]
ds_read_b64_tr_b16 v[92:93], v12 offset:63488
ds_read_b64_tr_b16 v[94:95], v12 offset:64000
v_exp_f32 v42, v42 clamp
v_max_f32 v40, s46, v40
s_waitcnt lgkmcnt(10)
v_mfma_f32_32x32x16_bf16 a[32:47], v[96:99], v[232:235], a[32:47]
s_waitcnt vmcnt(29)
s_barrier
ds_read_b64_tr_b16 v[96:97], v8 offset:0
ds_read_b64_tr_b16 v[98:99], v8 offset:512
v_exp_f32 v43, v43 clamp
v_mfma_f32_32x32x16_bf16 a[48:63], v[100:103], v[232:235], a[48:63]
ds_read_b64_tr_b16 v[100:101], v11 offset:0
ds_read_b64_tr_b16 v[102:103], v11 offset:512
v_max_f32 v41, s46, v41
v_add_f32 v40, v40, v42
s_add_u32 m0, s40, 106368
s_waitcnt lgkmcnt(8)
v_mfma_f32_32x32x16_bf16 a[0:15], v[104:107], v[236:239], a[0:15]
ds_read_b64_tr_b16 v[104:105], v8 offset:2048
ds_read_b64_tr_b16 v[106:107], v8 offset:2560
buffer_load_dwordx4 v3, s[20:23], s70 offen offset:128 lds
v_add_f32 v41, v41, v43
v_cvt_pk_bf16_f32 v64, v40, v41
v_cndmask_b32 v64, v64, v72, s[92:93]
v_mfma_f32_32x32x16_bf16 a[16:31], v[108:111], v[236:239], a[16:31]
ds_read_b64_tr_b16 v[108:109], v11 offset:2048
ds_read_b64_tr_b16 v[110:111], v11 offset:2560
v_cndmask_b32 v64, v64, v73, s[94:95]
v_accvgpr_read_b32 v44, a226
v_accvgpr_read_b32 v45, a227
s_waitcnt lgkmcnt(8)
v_mfma_f32_32x32x16_bf16 a[32:47], v[88:91], v[236:239], a[32:47]
ds_read_b64_tr_b16 v[88:89], v8 offset:4096
ds_read_b64_tr_b16 v[90:91], v8 offset:4608
v_fma_f32 v46, v44, s43, v19
v_fma_f32 v47, v45, s43, v19
v_cvt_pk_bf16_f32 v72, v44, v45
v_mfma_f32_32x32x16_bf16 a[48:63], v[92:95], v[236:239], a[48:63]
ds_read_b64_tr_b16 v[92:93], v11 offset:4096
ds_read_b64_tr_b16 v[94:95], v11 offset:4608
v_exp_f32 v46, v46 clamp
s_add_u32 m0, s40, 110464
s_waitcnt lgkmcnt(8)
v_mfma_f32_32x32x16_bf16 a[0:15], v[96:99], v[240:243], a[0:15]
ds_read_b64_tr_b16 v[96:97], v8 offset:6144
ds_read_b64_tr_b16 v[98:99], v8 offset:6656
buffer_load_dwordx4 v3, s[20:23], s71 offen offset:128 lds
v_max_f32 v44, s46, v44
v_exp_f32 v47, v47 clamp
v_mfma_f32_32x32x16_bf16 a[16:31], v[100:103], v[240:243], a[16:31]
ds_read_b64_tr_b16 v[100:101], v11 offset:6144
ds_read_b64_tr_b16 v[102:103], v11 offset:6656
v_max_f32 v45, s46, v45
v_add_f32 v44, v44, v46
v_add_f32 v45, v45, v47
s_waitcnt lgkmcnt(8)
v_mfma_f32_32x32x16_bf16 a[32:47], v[104:107], v[240:243], a[32:47]
s_waitcnt vmcnt(28)
s_barrier
ds_read_b64_tr_b16 v[104:105], v8 offset:8192
ds_read_b64_tr_b16 v[106:107], v8 offset:8704
v_cvt_pk_bf16_f32 v65, v44, v45
v_cndmask_b32 v65, v65, v72, s[92:93]
v_mfma_f32_32x32x16_bf16 a[48:63], v[108:111], v[240:243], a[48:63]
ds_read_b64_tr_b16 v[108:109], v11 offset:8192
ds_read_b64_tr_b16 v[110:111], v11 offset:8704
v_cndmask_b32 v65, v65, v73, s[94:95]
v_accvgpr_read_b32 v40, a228
s_add_u32 m0, s40, 114560
s_waitcnt lgkmcnt(8)
v_mfma_f32_32x32x16_bf16 a[0:15], v[88:91], v[244:247], a[0:15]
ds_read_b64_tr_b16 v[88:89], v8 offset:10240
ds_read_b64_tr_b16 v[90:91], v8 offset:10752
buffer_load_dwordx4 v3, s[20:23], s72 offen offset:128 lds
v_accvgpr_read_b32 v41, a229
v_fma_f32 v42, v40, s43, v19
v_fma_f32 v43, v41, s43, v19
v_mfma_f32_32x32x16_bf16 a[16:31], v[92:95], v[244:247], a[16:31]
ds_read_b64_tr_b16 v[92:93], v11 offset:10240
ds_read_b64_tr_b16 v[94:95], v11 offset:10752
v_cvt_pk_bf16_f32 v72, v40, v41
v_exp_f32 v42, v42 clamp
s_waitcnt lgkmcnt(8)
v_mfma_f32_32x32x16_bf16 a[32:47], v[96:99], v[244:247], a[32:47]
ds_read_b64_tr_b16 v[96:97], v8 offset:12288
ds_read_b64_tr_b16 v[98:99], v8 offset:12800
v_max_f32 v40, s46, v40
v_exp_f32 v43, v43 clamp
v_max_f32 v41, s46, v41
v_mfma_f32_32x32x16_bf16 a[48:63], v[100:103], v[244:247], a[48:63]
ds_read_b64_tr_b16 v[100:101], v11 offset:12288
ds_read_b64_tr_b16 v[102:103], v11 offset:12800
v_add_f32 v40, v40, v42
v_add_f32 v41, v41, v43
s_add_u32 m0, s40, 118656
s_waitcnt lgkmcnt(8)
v_mfma_f32_32x32x16_bf16 a[0:15], v[104:107], v[248:251], a[0:15]
ds_read_b64_tr_b16 v[104:105], v8 offset:14336
ds_read_b64_tr_b16 v[106:107], v8 offset:14848
buffer_load_dwordx4 v3, s[20:23], s73 offen offset:128 lds
v_add_u32 v10, s0, v10
buffer_load_dword a182, v10, s[20:23], 0 offen
v_cvt_pk_bf16_f32 v66, v40, v41
v_mfma_f32_32x32x16_bf16 a[16:31], v[108:111], v[248:251], a[16:31]
ds_read_b64_tr_b16 v[108:109], v11 offset:14336
ds_read_b64_tr_b16 v[110:111], v11 offset:14848
v_cndmask_b32 v66, v66, v72, s[92:93]
v_cndmask_b32 v66, v66, v73, s[94:95]
v_accvgpr_read_b32 v44, a230
s_waitcnt lgkmcnt(8)
v_mfma_f32_32x32x16_bf16 a[32:47], v[88:91], v[248:251], a[32:47]
s_waitcnt vmcnt(29)
s_barrier
ds_read_b64_tr_b16 v[88:89], v8 offset:16384
ds_read_b64_tr_b16 v[90:91], v8 offset:16896
v_accvgpr_read_b32 v45, a231
v_fma_f32 v46, v44, s43, v19
v_mfma_f32_32x32x16_bf16 a[48:63], v[92:95], v[248:251], a[48:63]
ds_read_b64_tr_b16 v[92:93], v11 offset:16384
ds_read_b64_tr_b16 v[94:95], v11 offset:16896
v_fma_f32 v47, v45, s43, v19
v_cvt_pk_bf16_f32 v72, v44, v45
s_add_u32 m0, s40, 122752
s_waitcnt lgkmcnt(8)
v_mfma_f32_32x32x16_bf16 a[0:15], v[96:99], v[252:255], a[0:15]
ds_read_b64_tr_b16 v[96:97], v8 offset:18432
ds_read_b64_tr_b16 v[98:99], v8 offset:18944
buffer_load_dwordx4 v3, s[20:23], s74 offen offset:128 lds
v_exp_f32 v46, v46 clamp
v_max_f32 v44, s46, v44
v_mfma_f32_32x32x16_bf16 a[16:31], v[100:103], v[252:255], a[16:31]
ds_read_b64_tr_b16 v[100:101], v11 offset:18432
ds_read_b64_tr_b16 v[102:103], v11 offset:18944
v_exp_f32 v47, v47 clamp
v_max_f32 v45, s46, v45
s_waitcnt lgkmcnt(8)
v_mfma_f32_32x32x16_bf16 a[32:47], v[104:107], v[252:255], a[32:47]
ds_read_b64_tr_b16 v[104:105], v8 offset:20480
ds_read_b64_tr_b16 v[106:107], v8 offset:20992
v_add_f32 v44, v44, v46
v_add_f32 v45, v45, v47
v_cvt_pk_bf16_f32 v67, v44, v45
v_cndmask_b32 v67, v67, v72, s[92:93]
v_mfma_f32_32x32x16_bf16 a[48:63], v[108:111], v[252:255], a[48:63]
ds_read_b64_tr_b16 v[108:109], v11 offset:20480
ds_read_b64_tr_b16 v[110:111], v11 offset:20992
v_cndmask_b32 v67, v67, v73, s[94:95]
v_accvgpr_read_b32 v40, a232
s_add_u32 m0, s40, 126848
s_waitcnt lgkmcnt(8)
v_mfma_f32_32x32x16_bf16 a[64:79], v[88:91], v[112:115], 0
ds_read_b64_tr_b16 v[88:89], v8 offset:22528
ds_read_b64_tr_b16 v[90:91], v8 offset:23040
buffer_load_dwordx4 v3, s[20:23], s75 offen offset:128 lds
v_accvgpr_read_b32 v41, a233
v_fma_f32 v42, v40, s43, v19
v_fma_f32 v43, v41, s43, v19
v_mfma_f32_32x32x16_bf16 a[80:95], v[92:95], v[112:115], 0
ds_read_b64_tr_b16 v[92:93], v11 offset:22528
ds_read_b64_tr_b16 v[94:95], v11 offset:23040
v_cvt_pk_bf16_f32 v72, v40, v41
v_exp_f32 v42, v42 clamp
v_max_f32 v40, s46, v40
s_waitcnt lgkmcnt(8)
v_mfma_f32_32x32x16_bf16 a[96:111], v[96:99], v[112:115], 0
s_waitcnt vmcnt(28)
s_barrier
ds_read_b64_tr_b16 v[96:97], v8 offset:24576
ds_read_b64_tr_b16 v[98:99], v8 offset:25088
buffer_load_dword a182, v16, s[16:19], 0 offen
v_exp_f32 v43, v43 clamp
v_mfma_f32_32x32x16_bf16 a[112:127], v[100:103], v[112:115], 0
ds_read_b64_tr_b16 v[100:101], v11 offset:24576
ds_read_b64_tr_b16 v[102:103], v11 offset:25088
v_max_f32 v41, s46, v41
v_add_f32 v40, v40, v42
s_mov_b32 m0, s40
s_add_u32 s41, s76, 128
s_waitcnt lgkmcnt(8)
v_mfma_f32_32x32x16_bf16 a[64:79], v[104:107], v[116:119], a[64:79]
ds_read_b64_tr_b16 v[104:105], v8 offset:26624
ds_read_b64_tr_b16 v[106:107], v8 offset:27136
buffer_load_dwordx4 v3, s[20:23], s41 offen lds
v_add_f32 v41, v41, v43
v_cvt_pk_bf16_f32 v68, v40, v41
v_cndmask_b32 v68, v68, v72, s[92:93]
v_mfma_f32_32x32x16_bf16 a[80:95], v[108:111], v[116:119], a[80:95]
ds_read_b64_tr_b16 v[108:109], v11 offset:26624
ds_read_b64_tr_b16 v[110:111], v11 offset:27136
v_cndmask_b32 v68, v68, v73, s[94:95]
v_accvgpr_read_b32 v44, a234
v_accvgpr_read_b32 v45, a235
v_fma_f32 v46, v44, s43, v19
s_waitcnt lgkmcnt(8)
v_mfma_f32_32x32x16_bf16 a[96:111], v[88:91], v[116:119], a[96:111]
ds_read_b64_tr_b16 v[88:89], v8 offset:28672
ds_read_b64_tr_b16 v[90:91], v8 offset:29184
v_fma_f32 v47, v45, s43, v19
v_cvt_pk_bf16_f32 v72, v44, v45
v_exp_f32 v46, v46 clamp
v_mfma_f32_32x32x16_bf16 a[112:127], v[92:95], v[116:119], a[112:127]
ds_read_b64_tr_b16 v[92:93], v11 offset:28672
ds_read_b64_tr_b16 v[94:95], v11 offset:29184
v_max_f32 v44, s46, v44
v_exp_f32 v47, v47 clamp
s_add_u32 m0, s40, 3968
s_waitcnt lgkmcnt(8)
v_mfma_f32_32x32x16_bf16 a[64:79], v[96:99], v[120:123], a[64:79]
ds_read_b64_tr_b16 v[96:97], v8 offset:30720
ds_read_b64_tr_b16 v[98:99], v8 offset:31232
buffer_load_dwordx4 v3, s[20:23], s77 offen offset:128 lds
v_max_f32 v45, s46, v45
v_add_f32 v44, v44, v46
v_add_f32 v45, v45, v47
v_mfma_f32_32x32x16_bf16 a[80:95], v[100:103], v[120:123], a[80:95]
ds_read_b64_tr_b16 v[100:101], v11 offset:30720
ds_read_b64_tr_b16 v[102:103], v11 offset:31232
v_cvt_pk_bf16_f32 v69, v44, v45
v_cndmask_b32 v69, v69, v72, s[92:93]
v_cndmask_b32 v69, v69, v73, s[94:95]
v_accvgpr_read_b32 v40, a236
s_waitcnt lgkmcnt(8)
v_mfma_f32_32x32x16_bf16 a[96:111], v[104:107], v[120:123], a[96:111]
s_waitcnt vmcnt(29)
s_barrier
ds_read_b64_tr_b16 v[104:105], v8 offset:32768
ds_read_b64_tr_b16 v[106:107], v8 offset:33280
v_accvgpr_read_b32 v41, a237
v_fma_f32 v42, v40, s43, v19
v_mfma_f32_32x32x16_bf16 a[112:127], v[108:111], v[120:123], a[112:127]
ds_read_b64_tr_b16 v[108:109], v11 offset:32768
ds_read_b64_tr_b16 v[110:111], v11 offset:33280
v_fma_f32 v43, v41, s43, v19
v_cvt_pk_bf16_f32 v72, v40, v41
v_accvgpr_read_b32 v24, a0
s_add_u32 m0, s40, 8064
s_waitcnt lgkmcnt(8)
v_mfma_f32_32x32x16_bf16 a[64:79], v[88:91], v[124:127], a[64:79]
ds_read_b64_tr_b16 v[88:89], v8 offset:34816
ds_read_b64_tr_b16 v[90:91], v8 offset:35328
buffer_load_dwordx4 v3, s[20:23], s78 offen offset:128 lds
v_exp_f32 v42, v42 clamp
v_max_f32 v40, s46, v40
v_mfma_f32_32x32x16_bf16 a[80:95], v[92:95], v[124:127], a[80:95]
ds_read_b64_tr_b16 v[92:93], v11 offset:34816
ds_read_b64_tr_b16 v[94:95], v11 offset:35328
v_exp_f32 v43, v43 clamp
v_max_f32 v41, s46, v41
v_add_f32 v40, v40, v42
s_waitcnt lgkmcnt(8)
v_mfma_f32_32x32x16_bf16 a[96:111], v[96:99], v[124:127], a[96:111]
ds_read_b64_tr_b16 v[96:97], v8 offset:36864
ds_read_b64_tr_b16 v[98:99], v8 offset:37376
v_add_f32 v41, v41, v43
v_cvt_pk_bf16_f32 v70, v40, v41
v_cndmask_b32 v70, v70, v72, s[92:93]
v_cndmask_b32 v70, v70, v73, s[94:95]
v_mfma_f32_32x32x16_bf16 a[112:127], v[100:103], v[124:127], a[112:127]
ds_read_b64_tr_b16 v[100:101], v11 offset:36864
ds_read_b64_tr_b16 v[102:103], v11 offset:37376
v_accvgpr_read_b32 v44, a238
v_accvgpr_read_b32 v45, a239
v_fma_f32 v46, v44, s43, v19
s_add_u32 m0, s40, 12160
s_waitcnt lgkmcnt(8)
v_mfma_f32_32x32x16_bf16 a[64:79], v[104:107], v[128:131], a[64:79]
ds_read_b64_tr_b16 v[104:105], v8 offset:38912
ds_read_b64_tr_b16 v[106:107], v8 offset:39424
buffer_load_dwordx4 v3, s[20:23], s79 offen offset:128 lds
v_fma_f32 v47, v45, s43, v19
v_cvt_pk_bf16_f32 v72, v44, v45
v_accvgpr_read_b32 v25, a1
v_mfma_f32_32x32x16_bf16 a[80:95], v[108:111], v[128:131], a[80:95]
ds_read_b64_tr_b16 v[108:109], v11 offset:38912
ds_read_b64_tr_b16 v[110:111], v11 offset:39424
v_exp_f32 v46, v46 clamp
v_max_f32 v44, s46, v44
v_accvgpr_read_b32 v26, a2
s_waitcnt lgkmcnt(8)
v_mfma_f32_32x32x16_bf16 a[96:111], v[88:91], v[128:131], a[96:111]
s_waitcnt vmcnt(29)
s_barrier
ds_read_b64_tr_b16 v[88:89], v8 offset:40960
ds_read_b64_tr_b16 v[90:91], v8 offset:41472
v_exp_f32 v47, v47 clamp
v_mfma_f32_32x32x16_bf16 a[112:127], v[92:95], v[128:131], a[112:127]
ds_read_b64_tr_b16 v[92:93], v11 offset:40960
ds_read_b64_tr_b16 v[94:95], v11 offset:41472
v_max_f32 v45, s46, v45
v_add_f32 v44, v44, v46
v_add_f32 v45, v45, v47
s_add_u32 m0, s40, 16256
s_waitcnt lgkmcnt(8)
v_mfma_f32_32x32x16_bf16 a[64:79], v[96:99], v[132:135], a[64:79]
ds_read_b64_tr_b16 v[96:97], v8 offset:43008
ds_read_b64_tr_b16 v[98:99], v8 offset:43520
buffer_load_dwordx4 v3, s[20:23], s80 offen offset:128 lds
v_cvt_pk_bf16_f32 v71, v44, v45
v_cndmask_b32 v71, v71, v72, s[92:93]
v_cndmask_b32 v71, v71, v73, s[94:95]
v_mfma_f32_32x32x16_bf16 a[80:95], v[100:103], v[132:135], a[80:95]
ds_read_b64_tr_b16 v[100:101], v11 offset:43008
ds_read_b64_tr_b16 v[102:103], v11 offset:43520
ds_write_b128 v74, v[64:67] offset:4096
ds_write_b128 v74, v[68:71] offset:5120
s_lshr_b32 s7, s3, 1
s_lshl_b32 s7, s7, 12
s_waitcnt lgkmcnt(10)
v_mfma_f32_32x32x16_bf16 a[96:111], v[104:107], v[132:135], a[96:111]
ds_read_b64_tr_b16 v[104:105], v8 offset:45056
ds_read_b64_tr_b16 v[106:107], v8 offset:45568
s_add_u32 s7, s7, 131072
v_lshl_add_u32 v22, v1, 4, s7
s_and_b32 s7, s3, 1
s_lshl_b32 s7, s7, 11
v_mfma_f32_32x32x16_bf16 a[112:127], v[108:111], v[132:135], a[112:127]
ds_read_b64_tr_b16 v[108:109], v11 offset:45056
ds_read_b64_tr_b16 v[110:111], v11 offset:45568
s_add_u32 s7, s7, 133120
v_lshl_add_u32 v23, v1, 4, s7
s_mov_b32 s92, 0xf0f0
s_add_u32 m0, s40, 20352
s_waitcnt lgkmcnt(10)
v_mfma_f32_32x32x16_bf16 a[64:79], v[88:91], v[136:139], a[64:79]
ds_read_b64_tr_b16 v[88:89], v8 offset:47104
ds_read_b64_tr_b16 v[90:91], v8 offset:47616
buffer_load_dwordx4 v3, s[20:23], s81 offen offset:128 lds
s_mov_b32 s93, 0xf0f0
s_mov_b32 s94, 0xffffffff
s_mov_b32 s95, 0x0
v_mfma_f32_32x32x16_bf16 a[80:95], v[92:95], v[136:139], a[80:95]
ds_read_b64_tr_b16 v[92:93], v11 offset:47104
ds_read_b64_tr_b16 v[94:95], v11 offset:47616
v_and_b32 v41, 3, v1
v_bfe_u32 v42, v1, 3, 1
v_lshl_add_u32 v41, v42, 2, v41
v_lshrrev_b32 v42, 5, v1
s_waitcnt lgkmcnt(10)
v_mfma_f32_32x32x16_bf16 a[96:111], v[96:99], v[136:139], a[96:111]
s_waitcnt vmcnt(28) lgkmcnt(8)
s_barrier
ds_read_b64_tr_b16 v[96:97], v8 offset:49152
ds_read_b64_tr_b16 v[98:99], v8 offset:49664
v_lshl_add_u32 v41, v42, 3, v41
v_lshlrev_b32 v41, 4, v41
v_mfma_f32_32x32x16_bf16 a[112:127], v[100:103], v[136:139], a[112:127]
ds_read_b64_tr_b16 v[100:101], v11 offset:49152
ds_read_b64_tr_b16 v[102:103], v11 offset:49664
v_add_u32 v41, 4096, v41
v_lshlrev_b32 v40, 4, v1
v_accvgpr_read_b32 v27, a3
s_add_u32 m0, s40, 24448
s_waitcnt lgkmcnt(8)
v_mfma_f32_32x32x16_bf16 a[64:79], v[104:107], v[140:143], a[64:79]
ds_read_b64_tr_b16 v[104:105], v8 offset:51200
ds_read_b64_tr_b16 v[106:107], v8 offset:51712
buffer_load_dwordx4 v3, s[20:23], s82 offen offset:128 lds
s_cmp_eq_u32 s3, 2
s_cselect_b64 s[94:95], s[94:95], -1
v_accvgpr_read_b32 v28, a32
v_mfma_f32_32x32x16_bf16 a[80:95], v[108:111], v[140:143], a[80:95]
ds_read_b64_tr_b16 v[108:109], v11 offset:51200
ds_read_b64_tr_b16 v[110:111], v11 offset:51712
s_bitcmp1_b32 s3, 0
s_cselect_b64 s[94:95], s[92:93], s[94:95]
s_cselect_b64 s[92:93], -1, 0
v_cndmask_b32 v40, v40, v41, s[92:93]
s_waitcnt lgkmcnt(8)
v_mfma_f32_32x32x16_bf16 a[96:111], v[88:91], v[140:143], a[96:111]
ds_read_b64_tr_b16 v[88:89], v8 offset:53248
ds_read_b64_tr_b16 v[90:91], v8 offset:53760
v_lshrrev_b32 v40, 1, v40
s_lshl_b32 s7, s4, 4
s_add_u32 s7, s7, s5
s_lshl_b32 s7, s7, 13
v_mfma_f32_32x32x16_bf16 a[112:127], v[92:95], v[140:143], a[112:127]
ds_read_b64_tr_b16 v[92:93], v11 offset:53248
ds_read_b64_tr_b16 v[94:95], v11 offset:53760
s_add_u32 s7, s7, 67108864
v_add_u32 v40, s7, v40
v_mov_b32 v42, 0x7fffff00
s_add_u32 m0, s40, 28544
s_waitcnt lgkmcnt(8)
v_mfma_f32_32x32x16_bf16 a[64:79], v[96:99], v[144:147], a[64:79]
ds_read_b64_tr_b16 v[96:97], v8 offset:55296
ds_read_b64_tr_b16 v[98:99], v8 offset:55808
buffer_load_dwordx4 v3, s[20:23], s83 offen offset:128 lds
v_cndmask_b32 v40, v42, v40, s[94:95]
v_add_u32 v41, 140288, v41
v_accvgpr_write_b32 a181, v41
v_mfma_f32_32x32x16_bf16 a[80:95], v[100:103], v[144:147], a[80:95]
ds_read_b64_tr_b16 v[100:101], v11 offset:55296
ds_read_b64_tr_b16 v[102:103], v11 offset:55808
ds_read_b128 a[192:195], v22 offset:0
ds_read_b128 a[196:199], v23 offset:0
s_waitcnt lgkmcnt(10)
v_mfma_f32_32x32x16_bf16 a[96:111], v[104:107], v[144:147], a[96:111]
s_waitcnt vmcnt(28)
s_barrier
ds_read_b64_tr_b16 v[104:105], v8 offset:57344
ds_read_b64_tr_b16 v[106:107], v8 offset:57856
ds_read_b128 a[200:203], v22 offset:1024
v_mfma_f32_32x32x16_bf16 a[112:127], v[108:111], v[144:147], a[112:127]
ds_read_b64_tr_b16 v[108:109], v11 offset:57344
ds_read_b64_tr_b16 v[110:111], v11 offset:57856
ds_read_b128 a[204:207], v23 offset:1024
v_accvgpr_read_b32 v29, a33
s_add_u32 m0, s40, 32512
s_waitcnt lgkmcnt(12)
v_mfma_f32_32x32x16_bf16 a[64:79], v[88:91], v[148:151], a[64:79]
ds_read_b64_tr_b16 v[88:89], v8 offset:59392
ds_read_b64_tr_b16 v[90:91], v8 offset:59904
buffer_load_dwordx4 v3, s[20:23], s48 offen offset:256 lds
ds_read_b128 a[208:211], v22 offset:6144
v_accvgpr_read_b32 v30, a34
v_mfma_f32_32x32x16_bf16 a[80:95], v[92:95], v[148:151], a[80:95]
ds_read_b64_tr_b16 v[92:93], v11 offset:59392
ds_read_b64_tr_b16 v[94:95], v11 offset:59904
ds_read_b128 a[212:215], v23 offset:6144
ds_read_b128 a[216:219], v22 offset:7168
s_waitcnt lgkmcnt(15)
v_mfma_f32_32x32x16_bf16 a[96:111], v[96:99], v[148:151], a[96:111]
ds_read_b64_tr_b16 v[96:97], v8 offset:61440
ds_read_b64_tr_b16 v[98:99], v8 offset:61952
ds_read_b128 a[220:223], v23 offset:7168
ds_read_b128 a[224:227], v22 offset:12288
v_mfma_f32_32x32x16_bf16 a[112:127], v[100:103], v[148:151], a[112:127]
ds_read_b64_tr_b16 v[100:101], v11 offset:61440
ds_read_b64_tr_b16 v[102:103], v11 offset:61952
ds_read_b128 a[228:231], v23 offset:12288
v_accvgpr_read_b32 v31, a35
s_add_u32 m0, s40, 36608
s_waitcnt lgkmcnt(15)
v_mfma_f32_32x32x16_bf16 a[64:79], v[104:107], v[152:155], a[64:79]
ds_read_b64_tr_b16 v[104:105], v8 offset:63488
ds_read_b64_tr_b16 v[106:107], v8 offset:64000
buffer_load_dwordx4 v3, s[20:23], s49 offen offset:256 lds
ds_read_b128 a[232:235], v22 offset:13312
v_max_f32 v24, 0, v24
v_mfma_f32_32x32x16_bf16 a[80:95], v[108:111], v[152:155], a[80:95]
ds_read_b64_tr_b16 v[108:109], v11 offset:63488
ds_read_b64_tr_b16 v[110:111], v11 offset:64000
ds_read_b128 a[236:239], v23 offset:13312
ds_read_b128 v[48:51], v22 offset:18432
s_waitcnt lgkmcnt(15)
v_mfma_f32_32x32x16_bf16 a[96:111], v[88:91], v[152:155], a[96:111]
s_waitcnt vmcnt(26)
s_barrier
ds_read_b64_tr_b16 v[88:89], v9 offset:0
ds_read_b64_tr_b16 v[90:91], v9 offset:512
ds_read_b128 v[52:55], v23 offset:18432
v_mfma_f32_32x32x16_bf16 a[112:127], v[92:95], v[152:155], a[112:127]
ds_read_b64_tr_b16 v[92:93], v12 offset:0
ds_read_b64_tr_b16 v[94:95], v12 offset:512
ds_read_b128 v[56:59], v22 offset:19456
v_max_f32 v25, 0, v25
s_add_u32 m0, s40, 40704
s_waitcnt lgkmcnt(14)
v_mfma_f32_32x32x16_bf16 a[64:79], v[96:99], v[156:159], a[64:79]
ds_read_b64_tr_b16 v[96:97], v9 offset:2048
ds_read_b64_tr_b16 v[98:99], v9 offset:2560
buffer_load_dwordx4 v3, s[20:23], s50 offen offset:256 lds
ds_read_b128 v[60:63], v23 offset:19456
v_mfma_f32_32x32x16_bf16 v[72:87], a[192:195], a[196:199], 0
v_mfma_f32_32x32x16_bf16 a[80:95], v[100:103], v[156:159], a[80:95]
ds_read_b64_tr_b16 v[100:101], v12 offset:2048
ds_read_b64_tr_b16 v[102:103], v12 offset:2560
v_mfma_f32_32x32x16_bf16 v[72:87], a[200:203], a[204:207], v[72:87]
s_waitcnt lgkmcnt(13)
v_mfma_f32_32x32x16_bf16 a[96:111], v[104:107], v[156:159], a[96:111]
ds_read_b64_tr_b16 v[104:105], v9 offset:4096
ds_read_b64_tr_b16 v[106:107], v9 offset:4608
v_mfma_f32_32x32x16_bf16 v[72:87], a[208:211], a[212:215], v[72:87]
v_mfma_f32_32x32x16_bf16 a[112:127], v[108:111], v[156:159], a[112:127]
ds_read_b64_tr_b16 v[108:109], v12 offset:4096
ds_read_b64_tr_b16 v[110:111], v12 offset:4608
v_mfma_f32_32x32x16_bf16 v[72:87], a[216:219], a[220:223], v[72:87]
s_add_u32 m0, s40, 44800
s_waitcnt lgkmcnt(10)
v_mfma_f32_32x32x16_bf16 a[64:79], v[88:91], v[160:163], a[64:79]
ds_read_b64_tr_b16 v[88:89], v9 offset:6144
ds_read_b64_tr_b16 v[90:91], v9 offset:6656
buffer_load_dwordx4 v3, s[20:23], s51 offen offset:256 lds
v_mfma_f32_32x32x16_bf16 v[72:87], a[224:227], a[228:231], v[72:87]
v_mfma_f32_32x32x16_bf16 a[80:95], v[92:95], v[160:163], a[80:95]
ds_read_b64_tr_b16 v[92:93], v12 offset:6144
ds_read_b64_tr_b16 v[94:95], v12 offset:6656
v_mfma_f32_32x32x16_bf16 v[72:87], a[232:235], a[236:239], v[72:87]
s_waitcnt lgkmcnt(8)
v_mfma_f32_32x32x16_bf16 a[96:111], v[96:99], v[160:163], a[96:111]
s_waitcnt vmcnt(26)
s_barrier
ds_read_b64_tr_b16 v[96:97], v9 offset:8192
ds_read_b64_tr_b16 v[98:99], v9 offset:8704
v_mfma_f32_32x32x16_bf16 v[72:87], v[48:51], v[52:55], v[72:87]
v_mfma_f32_32x32x16_bf16 a[112:127], v[100:103], v[160:163], a[112:127]
ds_read_b64_tr_b16 v[100:101], v12 offset:8192
ds_read_b64_tr_b16 v[102:103], v12 offset:8704
v_mfma_f32_32x32x16_bf16 v[72:87], v[56:59], v[60:63], v[72:87]
s_add_u32 m0, s40, 48896
s_waitcnt lgkmcnt(8)
v_mfma_f32_32x32x16_bf16 a[64:79], v[104:107], v[164:167], a[64:79]
ds_read_b64_tr_b16 v[104:105], v9 offset:10240
ds_read_b64_tr_b16 v[106:107], v9 offset:10752
buffer_load_dwordx4 v3, s[20:23], s52 offen offset:256 lds
s_cmp_eq_u32 s3, 0
s_cselect_b32 s100, 4, 1
s_lshl_b32 s100, s100, 7
v_mfma_f32_32x32x16_bf16 a[80:95], v[108:111], v[164:167], a[80:95]
ds_read_b64_tr_b16 v[108:109], v12 offset:10240
ds_read_b64_tr_b16 v[110:111], v12 offset:10752
s_mul_i32 s101, s100, 3
s_cmp_eq_u32 s3, 2
s_cselect_b32 s101, 2688, s101
s_cselect_b32 s7, 3072, 0
s_waitcnt lgkmcnt(8)
v_mfma_f32_32x32x16_bf16 a[96:111], v[88:91], v[164:167], a[96:111]
ds_read_b64_tr_b16 v[88:89], v9 offset:12288
ds_read_b64_tr_b16 v[90:91], v9 offset:12800
s_cmp_eq_u32 s3, 3
s_cselect_b32 s101, 512, s101
s_cselect_b32 s7, 1536, s7
s_lshl_b32 s47, s4, 17
v_mfma_f32_32x32x16_bf16 a[112:127], v[92:95], v[164:167], a[112:127]
ds_read_b64_tr_b16 v[92:93], v12 offset:12288
ds_read_b64_tr_b16 v[94:95], v12 offset:12800
s_mul_i32 s45, s3, 768
s_add_u32 s47, s47, s45
s_lshl_b32 s45, s45, 1
s_add_u32 m0, s40, 52992
s_waitcnt lgkmcnt(8)
v_mfma_f32_32x32x16_bf16 a[64:79], v[96:99], v[168:171], a[64:79]
ds_read_b64_tr_b16 v[96:97], v9 offset:14336
ds_read_b64_tr_b16 v[98:99], v9 offset:14848
buffer_load_dwordx4 v3, s[20:23], s53 offen offset:256 lds
s_add_u32 s47, s47, 67108864
v_mul_u32_u24 v22, 12, v1
v_add_u32 v22, s47, v22
v_mfma_f32_32x32x16_bf16 a[80:95], v[100:103], v[168:171], a[80:95]
ds_read_b64_tr_b16 v[100:101], v12 offset:14336
ds_read_b64_tr_b16 v[102:103], v12 offset:14848
v_lshl_add_u32 v2, v1, 2, s40
v_cvt_pk_bf16_f32 v72, v72, v73
v_cvt_pk_bf16_f32 v73, v74, v75
buffer_store_dwordx2 v[72:73], v40, s[36:39], s7 offen sc1
s_waitcnt lgkmcnt(8)
v_mfma_f32_32x32x16_bf16 a[96:111], v[104:107], v[168:171], a[96:111]
s_waitcnt vmcnt(27)
s_barrier
ds_read_b64_tr_b16 v[104:105], v9 offset:16384
ds_read_b64_tr_b16 v[106:107], v9 offset:16896
s_add_u32 s7, s7, s100
v_cvt_pk_bf16_f32 v76, v76, v77
v_mfma_f32_32x32x16_bf16 a[112:127], v[108:111], v[168:171], a[112:127]
ds_read_b64_tr_b16 v[108:109], v12 offset:16384
ds_read_b64_tr_b16 v[110:111], v12 offset:16896
v_cvt_pk_bf16_f32 v77, v78, v79
buffer_store_dwordx2 v[76:77], v40, s[36:39], s7 offen sc1
s_add_u32 s7, s7, s100
s_add_u32 m0, s40, 57088
s_waitcnt lgkmcnt(8)
v_mfma_f32_32x32x16_bf16 a[64:79], v[88:91], v[172:175], a[64:79]
ds_read_b64_tr_b16 v[88:89], v9 offset:18432
ds_read_b64_tr_b16 v[90:91], v9 offset:18944
buffer_load_dwordx4 v3, s[20:23], s54 offen offset:256 lds
v_cvt_pk_bf16_f32 v80, v80, v81
v_cvt_pk_bf16_f32 v81, v82, v83
buffer_store_dwordx2 v[80:81], v40, s[36:39], s7 offen sc1
v_mfma_f32_32x32x16_bf16 a[80:95], v[92:95], v[172:175], a[80:95]
ds_read_b64_tr_b16 v[92:93], v12 offset:18432
ds_read_b64_tr_b16 v[94:95], v12 offset:18944
v_cvt_pk_bf16_f32 v84, v84, v85
v_cvt_pk_bf16_f32 v85, v86, v87
buffer_store_dwordx2 v[84:85], v40, s[36:39], s101 offen sc1
v_max_f32 v26, 0, v26
s_waitcnt lgkmcnt(8)
v_mfma_f32_32x32x16_bf16 a[96:111], v[96:99], v[172:175], a[96:111]
ds_read_b64_tr_b16 v[96:97], v9 offset:20480
ds_read_b64_tr_b16 v[98:99], v9 offset:20992
s_cmp_eq_u32 s3, 0
s_cselect_b32 s100, 0x01010101, 0
s_lshl_b32 s101, s5, 13
v_mfma_f32_32x32x16_bf16 v[48:63], v[64:67], a[184:187], 0
v_mfma_f32_32x32x16_bf16 a[112:127], v[100:103], v[172:175], a[112:127]
ds_read_b64_tr_b16 v[100:101], v12 offset:20480
ds_read_b64_tr_b16 v[102:103], v12 offset:20992
v_mfma_f32_32x32x16_bf16 v[48:63], v[68:71], a[188:191], v[48:63]
s_add_u32 m0, s40, 61184
s_waitcnt lgkmcnt(8)
v_mfma_f32_32x32x16_bf16 a[64:79], v[104:107], v[176:179], a[64:79]
ds_read_b64_tr_b16 v[104:105], v9 offset:22528
ds_read_b64_tr_b16 v[106:107], v9 offset:23040
buffer_load_dwordx4 v3, s[20:23], s55 offen offset:256 lds
v_accvgpr_read_b32 v40, a240
v_accvgpr_read_b32 v41, a241
v_fma_f32 v42, v40, s43, v19
v_mfma_f32_32x32x16_bf16 a[80:95], v[108:111], v[176:179], a[80:95]
ds_read_b64_tr_b16 v[108:109], v12 offset:22528
ds_read_b64_tr_b16 v[110:111], v12 offset:23040
v_fma_f32 v43, v41, s43, v19
v_exp_f32 v42, v42 clamp
v_max_f32 v40, s46, v40
s_waitcnt lgkmcnt(8)
v_mfma_f32_32x32x16_bf16 a[96:111], v[88:91], v[176:179], a[96:111]
s_waitcnt vmcnt(30)
s_barrier
ds_read_b64_tr_b16 v[88:89], v9 offset:24576
ds_read_b64_tr_b16 v[90:91], v9 offset:25088
v_exp_f32 v43, v43 clamp
v_mfma_f32_32x32x16_bf16 a[112:127], v[92:95], v[176:179], a[112:127]
ds_read_b64_tr_b16 v[92:93], v12 offset:24576
ds_read_b64_tr_b16 v[94:95], v12 offset:25088
v_max_f32 v41, s46, v41
v_add_f32 v40, v40, v42
v_add_f32 v41, v41, v43
s_add_u32 m0, s40, 65280
s_waitcnt lgkmcnt(8)
v_mfma_f32_32x32x16_bf16 a[64:79], v[96:99], v[180:183], a[64:79]
ds_read_b64_tr_b16 v[96:97], v9 offset:26624
ds_read_b64_tr_b16 v[98:99], v9 offset:27136
buffer_load_dwordx4 v3, s[20:23], s56 offen offset:256 lds
v_cvt_pk_bf16_f32 v40, v40, v41
v_accvgpr_write_b32 a240, v40
v_accvgpr_read_b32 v44, a242
v_mfma_f32_32x32x16_bf16 a[80:95], v[100:103], v[180:183], a[80:95]
ds_read_b64_tr_b16 v[100:101], v12 offset:26624
ds_read_b64_tr_b16 v[102:103], v12 offset:27136
v_accvgpr_read_b32 v45, a243
v_fma_f32 v46, v44, s43, v19
v_fma_f32 v47, v45, s43, v19
v_max_f32 v27, 0, v27
s_waitcnt lgkmcnt(8)
v_mfma_f32_32x32x16_bf16 a[96:111], v[104:107], v[180:183], a[96:111]
ds_read_b64_tr_b16 v[104:105], v9 offset:28672
ds_read_b64_tr_b16 v[106:107], v9 offset:29184
v_exp_f32 v46, v46 clamp
v_max_f32 v44, s46, v44
v_mul_f32 v24, v24, v28
v_mfma_f32_32x32x16_bf16 a[112:127], v[108:111], v[180:183], a[112:127]
ds_read_b64_tr_b16 v[108:109], v12 offset:28672
ds_read_b64_tr_b16 v[110:111], v12 offset:29184
v_exp_f32 v47, v47 clamp
v_max_f32 v45, s46, v45
s_add_u32 m0, s40, 69376
s_waitcnt lgkmcnt(8)
v_mfma_f32_32x32x16_bf16 a[64:79], v[88:91], v[184:187], a[64:79]
ds_read_b64_tr_b16 v[88:89], v9 offset:30720
ds_read_b64_tr_b16 v[90:91], v9 offset:31232
buffer_load_dwordx4 v3, s[20:23], s57 offen offset:256 lds
v_add_f32 v44, v44, v46
v_add_f32 v45, v45, v47
v_cvt_pk_bf16_f32 v44, v44, v45
v_mfma_f32_32x32x16_bf16 a[80:95], v[92:95], v[184:187], a[80:95]
ds_read_b64_tr_b16 v[92:93], v12 offset:30720
ds_read_b64_tr_b16 v[94:95], v12 offset:31232
v_accvgpr_write_b32 a241, v44
v_accvgpr_read_b32 v40, a244
v_accvgpr_read_b32 v41, a245
v_fma_f32 v42, v40, s43, v19
s_waitcnt lgkmcnt(8)
v_mfma_f32_32x32x16_bf16 a[96:111], v[96:99], v[184:187], a[96:111]
s_waitcnt vmcnt(30)
s_barrier
ds_read_b64_tr_b16 v[96:97], v9 offset:32768
ds_read_b64_tr_b16 v[98:99], v9 offset:33280
v_fma_f32 v43, v41, s43, v19
v_mul_f32 v25, v25, v29
v_mfma_f32_32x32x16_bf16 a[112:127], v[100:103], v[184:187], a[112:127]
ds_read_b64_tr_b16 v[100:101], v12 offset:32768
ds_read_b64_tr_b16 v[102:103], v12 offset:33280
v_exp_f32 v42, v42 clamp
v_max_f32 v40, s46, v40
s_add_u32 m0, s40, 73472
s_waitcnt lgkmcnt(8)
v_mfma_f32_32x32x16_bf16 a[64:79], v[104:107], v[188:191], a[64:79]
ds_read_b64_tr_b16 v[104:105], v9 offset:34816
ds_read_b64_tr_b16 v[106:107], v9 offset:35328
buffer_load_dwordx4 v3, s[20:23], s58 offen offset:256 lds
v_exp_f32 v43, v43 clamp
v_max_f32 v41, s46, v41
v_mfma_f32_32x32x16_bf16 a[80:95], v[108:111], v[188:191], a[80:95]
ds_read_b64_tr_b16 v[108:109], v12 offset:34816
ds_read_b64_tr_b16 v[110:111], v12 offset:35328
v_add_f32 v40, v40, v42
v_add_f32 v41, v41, v43
v_cvt_pk_bf16_f32 v40, v40, v41
v_accvgpr_write_b32 a242, v40
s_waitcnt lgkmcnt(8)
v_mfma_f32_32x32x16_bf16 a[96:111], v[88:91], v[188:191], a[96:111]
ds_read_b64_tr_b16 v[88:89], v9 offset:36864
ds_read_b64_tr_b16 v[90:91], v9 offset:37376
v_accvgpr_read_b32 v44, a246
v_accvgpr_read_b32 v45, a247
v_fma_f32 v46, v44, s43, v19
v_fma_f32 v47, v45, s43, v19
v_mfma_f32_32x32x16_bf16 a[112:127], v[92:95], v[188:191], a[112:127]
ds_read_b64_tr_b16 v[92:93], v12 offset:36864
ds_read_b64_tr_b16 v[94:95], v12 offset:37376
v_exp_f32 v46, v46 clamp
v_max_f32 v44, s46, v44
s_add_u32 m0, s40, 77568
s_waitcnt lgkmcnt(8)
v_mfma_f32_32x32x16_bf16 a[64:79], v[96:99], v[192:195], a[64:79]
ds_read_b64_tr_b16 v[96:97], v9 offset:38912
ds_read_b64_tr_b16 v[98:99], v9 offset:39424
buffer_load_dwordx4 v3, s[20:23], s59 offen offset:256 lds
v_exp_f32 v47, v47 clamp
v_max_f32 v45, s46, v45
v_mfma_f32_32x32x16_bf16 a[80:95], v[100:103], v[192:195], a[80:95]
ds_read_b64_tr_b16 v[100:101], v12 offset:38912
ds_read_b64_tr_b16 v[102:103], v12 offset:39424
v_add_f32 v44, v44, v46
v_add_f32 v45, v45, v47
v_cvt_pk_bf16_f32 v44, v44, v45
v_accvgpr_write_b32 a243, v44
s_waitcnt lgkmcnt(8)
v_mfma_f32_32x32x16_bf16 a[96:111], v[104:107], v[192:195], a[96:111]
s_waitcnt vmcnt(30)
s_barrier
ds_read_b64_tr_b16 v[104:105], v9 offset:40960
ds_read_b64_tr_b16 v[106:107], v9 offset:41472
v_accvgpr_read_b32 v40, a248
v_accvgpr_read_b32 v41, a249
v_mfma_f32_32x32x16_bf16 a[112:127], v[108:111], v[192:195], a[112:127]
ds_read_b64_tr_b16 v[108:109], v12 offset:40960
ds_read_b64_tr_b16 v[110:111], v12 offset:41472
v_fma_f32 v42, v40, s43, v19
v_fma_f32 v43, v41, s43, v19
v_mul_f32 v26, v26, v30
s_add_u32 m0, s40, 81664
s_waitcnt lgkmcnt(8)
v_mfma_f32_32x32x16_bf16 a[64:79], v[88:91], v[196:199], a[64:79]
ds_read_b64_tr_b16 v[88:89], v9 offset:43008
ds_read_b64_tr_b16 v[90:91], v9 offset:43520
buffer_load_dwordx4 v3, s[20:23], s60 offen offset:256 lds
v_exp_f32 v42, v42 clamp
v_max_f32 v40, s46, v40
v_mfma_f32_32x32x16_bf16 a[80:95], v[92:95], v[196:199], a[80:95]
ds_read_b64_tr_b16 v[92:93], v12 offset:43008
ds_read_b64_tr_b16 v[94:95], v12 offset:43520
v_exp_f32 v43, v43 clamp
v_max_f32 v41, s46, v41
v_add_f32 v40, v40, v42
s_waitcnt lgkmcnt(8)
v_mfma_f32_32x32x16_bf16 a[96:111], v[96:99], v[196:199], a[96:111]
ds_read_b64_tr_b16 v[96:97], v9 offset:45056
ds_read_b64_tr_b16 v[98:99], v9 offset:45568
v_add_f32 v41, v41, v43
v_cvt_pk_bf16_f32 v40, v40, v41
v_accvgpr_write_b32 a244, v40
v_accvgpr_read_b32 v44, a250
v_mfma_f32_32x32x16_bf16 a[112:127], v[100:103], v[196:199], a[112:127]
ds_read_b64_tr_b16 v[100:101], v12 offset:45056
ds_read_b64_tr_b16 v[102:103], v12 offset:45568
v_accvgpr_read_b32 v45, a251
v_fma_f32 v46, v44, s43, v19
v_fma_f32 v47, v45, s43, v19
s_add_u32 m0, s40, 85760
s_waitcnt lgkmcnt(8)
v_mfma_f32_32x32x16_bf16 a[64:79], v[104:107], v[200:203], a[64:79]
ds_read_b64_tr_b16 v[104:105], v9 offset:47104
ds_read_b64_tr_b16 v[106:107], v9 offset:47616
buffer_load_dwordx4 v3, s[20:23], s61 offen offset:256 lds
v_exp_f32 v46, v46 clamp
v_max_f32 v44, s46, v44
v_mfma_f32_32x32x16_bf16 a[80:95], v[108:111], v[200:203], a[80:95]
ds_read_b64_tr_b16 v[108:109], v12 offset:47104
ds_read_b64_tr_b16 v[110:111], v12 offset:47616
v_exp_f32 v47, v47 clamp
v_max_f32 v45, s46, v45
v_add_f32 v44, v44, v46
s_waitcnt lgkmcnt(8)
v_mfma_f32_32x32x16_bf16 a[96:111], v[88:91], v[200:203], a[96:111]
s_waitcnt vmcnt(30)
s_barrier
ds_read_b64_tr_b16 v[88:89], v9 offset:49152
ds_read_b64_tr_b16 v[90:91], v9 offset:49664
v_add_f32 v45, v45, v47
v_cvt_pk_bf16_f32 v44, v44, v45
v_mfma_f32_32x32x16_bf16 a[112:127], v[92:95], v[200:203], a[112:127]
ds_read_b64_tr_b16 v[92:93], v12 offset:49152
ds_read_b64_tr_b16 v[94:95], v12 offset:49664
v_accvgpr_write_b32 a245, v44
v_accvgpr_read_b32 v40, a252
v_accvgpr_read_b32 v41, a253
s_add_u32 m0, s40, 89856
s_waitcnt lgkmcnt(8)
v_mfma_f32_32x32x16_bf16 a[64:79], v[96:99], v[204:207], a[64:79]
ds_read_b64_tr_b16 v[96:97], v9 offset:51200
ds_read_b64_tr_b16 v[98:99], v9 offset:51712
buffer_load_dwordx4 v3, s[20:23], s62 offen offset:256 lds
v_fma_f32 v42, v40, s43, v19
v_fma_f32 v43, v41, s43, v19
v_mul_f32 v27, v27, v31
v_mfma_f32_32x32x16_bf16 a[80:95], v[100:103], v[204:207], a[80:95]
ds_read_b64_tr_b16 v[100:101], v12 offset:51200
ds_read_b64_tr_b16 v[102:103], v12 offset:51712
v_exp_f32 v42, v42 clamp
v_max_f32 v40, s46, v40
v_cvt_pk_bf16_f32 v24, v24, v25
s_waitcnt lgkmcnt(8)
v_mfma_f32_32x32x16_bf16 a[96:111], v[104:107], v[204:207], a[96:111]
ds_read_b64_tr_b16 v[104:105], v9 offset:53248
ds_read_b64_tr_b16 v[106:107], v9 offset:53760
v_cvt_pk_bf16_f32 v26, v26, v27
v_accvgpr_write_b32 a128, v24
v_accvgpr_write_b32 a129, v26
v_accvgpr_read_b32 v32, a4
v_mfma_f32_32x32x16_bf16 a[112:127], v[108:111], v[204:207], a[112:127]
ds_read_b64_tr_b16 v[108:109], v12 offset:53248
ds_read_b64_tr_b16 v[110:111], v12 offset:53760
v_accvgpr_read_b32 v33, a5
v_accvgpr_read_b32 v34, a6
v_accvgpr_read_b32 v35, a7
s_add_u32 m0, s40, 93952
s_waitcnt lgkmcnt(8)
v_mfma_f32_32x32x16_bf16 a[64:79], v[88:91], v[208:211], a[64:79]
ds_read_b64_tr_b16 v[88:89], v9 offset:55296
ds_read_b64_tr_b16 v[90:91], v9 offset:55808
buffer_load_dwordx4 v3, s[20:23], s63 offen offset:256 lds
v_accvgpr_read_b32 v36, a36
v_accvgpr_read_b32 v37, a37
v_accvgpr_read_b32 v38, a38
v_mfma_f32_32x32x16_bf16 a[80:95], v[92:95], v[208:211], a[80:95]
ds_read_b64_tr_b16 v[92:93], v12 offset:55296
ds_read_b64_tr_b16 v[94:95], v12 offset:55808
v_accvgpr_read_b32 v39, a39
v_max_f32 v32, 0, v32
v_max_f32 v33, 0, v33
v_max_f32 v34, 0, v34
s_waitcnt lgkmcnt(8)
v_mfma_f32_32x32x16_bf16 a[96:111], v[96:99], v[208:211], a[96:111]
s_waitcnt vmcnt(29)
s_barrier
ds_read_b64_tr_b16 v[96:97], v9 offset:57344
ds_read_b64_tr_b16 v[98:99], v9 offset:57856
v_max_f32 v35, 0, v35
v_mul_f32 v32, v32, v36
v_mfma_f32_32x32x16_bf16 a[112:127], v[100:103], v[208:211], a[112:127]
ds_read_b64_tr_b16 v[100:101], v12 offset:57344
ds_read_b64_tr_b16 v[102:103], v12 offset:57856
v_mul_f32 v33, v33, v37
v_mul_f32 v34, v34, v38
v_mul_f32 v35, v35, v39
s_add_u32 m0, s40, 98048
s_waitcnt lgkmcnt(8)
v_mfma_f32_32x32x16_bf16 a[64:79], v[104:107], v[212:215], a[64:79]
ds_read_b64_tr_b16 v[104:105], v9 offset:59392
ds_read_b64_tr_b16 v[106:107], v9 offset:59904
buffer_load_dwordx4 v3, s[20:23], s64 offen offset:256 lds
v_cvt_pk_bf16_f32 v32, v32, v33
v_cvt_pk_bf16_f32 v34, v34, v35
v_accvgpr_write_b32 a130, v32
v_mfma_f32_32x32x16_bf16 a[80:95], v[108:111], v[212:215], a[80:95]
ds_read_b64_tr_b16 v[108:109], v12 offset:59392
ds_read_b64_tr_b16 v[110:111], v12 offset:59904
v_accvgpr_write_b32 a131, v34
s_mov_b32 s6, 81920
buffer_store_dwordx4 a[128:131], v21, s[36:39], s6 offen offset:0 sc1
v_accvgpr_read_b32 v24, a8
s_waitcnt lgkmcnt(8)
v_mfma_f32_32x32x16_bf16 a[96:111], v[88:91], v[212:215], a[96:111]
ds_read_b64_tr_b16 v[88:89], v9 offset:61440
ds_read_b64_tr_b16 v[90:91], v9 offset:61952
v_accvgpr_read_b32 v25, a9
v_accvgpr_read_b32 v26, a10
v_accvgpr_read_b32 v27, a11
v_accvgpr_read_b32 v28, a40
v_mfma_f32_32x32x16_bf16 a[112:127], v[92:95], v[212:215], a[112:127]
ds_read_b64_tr_b16 v[92:93], v12 offset:61440
ds_read_b64_tr_b16 v[94:95], v12 offset:61952
v_accvgpr_read_b32 v29, a41
v_accvgpr_read_b32 v30, a42
v_accvgpr_read_b32 v31, a43
s_add_u32 m0, s40, 102144
s_waitcnt lgkmcnt(8)
v_mfma_f32_32x32x16_bf16 a[64:79], v[96:99], v[216:219], a[64:79]
ds_read_b64_tr_b16 v[96:97], v9 offset:63488
ds_read_b64_tr_b16 v[98:99], v9 offset:64000
buffer_load_dwordx4 v3, s[20:23], s65 offen offset:256 lds
v_max_f32 v24, 0, v24
v_max_f32 v25, 0, v25
v_max_f32 v26, 0, v26
v_mfma_f32_32x32x16_bf16 a[80:95], v[100:103], v[216:219], a[80:95]
ds_read_b64_tr_b16 v[100:101], v12 offset:63488
ds_read_b64_tr_b16 v[102:103], v12 offset:64000
v_max_f32 v27, 0, v27
v_mul_f32 v24, v24, v28
v_mul_f32 v25, v25, v29
v_mul_f32 v26, v26, v30
s_waitcnt lgkmcnt(8)
v_mfma_f32_32x32x16_bf16 a[96:111], v[104:107], v[216:219], a[96:111]
s_waitcnt vmcnt(29)
s_barrier
ds_read_b64_tr_b16 v[104:105], v8 offset:0
ds_read_b64_tr_b16 v[106:107], v8 offset:512
v_mul_f32 v27, v27, v31
v_cvt_pk_bf16_f32 v24, v24, v25
v_mfma_f32_32x32x16_bf16 a[112:127], v[108:111], v[216:219], a[112:127]
ds_read_b64_tr_b16 v[108:109], v11 offset:0
ds_read_b64_tr_b16 v[110:111], v11 offset:512
v_cvt_pk_bf16_f32 v26, v26, v27
v_accvgpr_write_b32 a132, v24
v_accvgpr_write_b32 a133, v26
s_add_u32 m0, s40, 106240
s_waitcnt lgkmcnt(8)
v_mfma_f32_32x32x16_bf16 a[64:79], v[88:91], v[220:223], a[64:79]
ds_read_b64_tr_b16 v[88:89], v8 offset:2048
ds_read_b64_tr_b16 v[90:91], v8 offset:2560
buffer_load_dwordx4 v3, s[20:23], s66 offen offset:256 lds
v_accvgpr_read_b32 v32, a12
v_accvgpr_read_b32 v33, a13
v_accvgpr_read_b32 v34, a14
v_mfma_f32_32x32x16_bf16 a[80:95], v[92:95], v[220:223], a[80:95]
ds_read_b64_tr_b16 v[92:93], v11 offset:2048
ds_read_b64_tr_b16 v[94:95], v11 offset:2560
v_accvgpr_read_b32 v35, a15
v_accvgpr_read_b32 v36, a44
v_accvgpr_read_b32 v37, a45
v_accvgpr_read_b32 v38, a46
s_waitcnt lgkmcnt(8)
v_mfma_f32_32x32x16_bf16 a[96:111], v[96:99], v[220:223], a[96:111]
ds_read_b64_tr_b16 v[96:97], v8 offset:4096
ds_read_b64_tr_b16 v[98:99], v8 offset:4608
v_accvgpr_read_b32 v39, a47
v_max_f32 v32, 0, v32
v_max_f32 v33, 0, v33
v_max_f32 v34, 0, v34
v_mfma_f32_32x32x16_bf16 a[112:127], v[100:103], v[220:223], a[112:127]
ds_read_b64_tr_b16 v[100:101], v11 offset:4096
ds_read_b64_tr_b16 v[102:103], v11 offset:4608
v_max_f32 v35, 0, v35
v_mul_f32 v32, v32, v36
v_mul_f32 v33, v33, v37
s_add_u32 m0, s40, 110336
s_waitcnt lgkmcnt(8)
v_mfma_f32_32x32x16_bf16 a[64:79], v[104:107], v[224:227], a[64:79]
ds_read_b64_tr_b16 v[104:105], v8 offset:6144
ds_read_b64_tr_b16 v[106:107], v8 offset:6656
buffer_load_dwordx4 v3, s[20:23], s67 offen offset:256 lds
v_mul_f32 v34, v34, v38
v_mul_f32 v35, v35, v39
v_cvt_pk_bf16_f32 v32, v32, v33
v_mfma_f32_32x32x16_bf16 a[80:95], v[108:111], v[224:227], a[80:95]
ds_read_b64_tr_b16 v[108:109], v11 offset:6144
ds_read_b64_tr_b16 v[110:111], v11 offset:6656
v_cvt_pk_bf16_f32 v34, v34, v35
v_accvgpr_write_b32 a134, v32
v_accvgpr_write_b32 a135, v34
v_exp_f32 v43, v43 clamp
s_waitcnt lgkmcnt(8)
v_mfma_f32_32x32x16_bf16 a[96:111], v[88:91], v[224:227], a[96:111]
s_waitcnt vmcnt(29)
s_barrier
ds_read_b64_tr_b16 v[88:89], v8 offset:8192
ds_read_b64_tr_b16 v[90:91], v8 offset:8704
s_mov_b32 s6, 81920
buffer_store_dwordx4 a[132:135], v21, s[36:39], s6 offen offset:1024 sc1
v_mfma_f32_32x32x16_bf16 a[112:127], v[92:95], v[224:227], a[112:127]
ds_read_b64_tr_b16 v[92:93], v11 offset:8192
ds_read_b64_tr_b16 v[94:95], v11 offset:8704
v_accvgpr_read_b32 v24, a16
v_accvgpr_read_b32 v25, a17
v_accvgpr_read_b32 v26, a18
s_add_u32 m0, s40, 114432
s_waitcnt lgkmcnt(8)
v_mfma_f32_32x32x16_bf16 a[64:79], v[96:99], v[228:231], a[64:79]
ds_read_b64_tr_b16 v[96:97], v8 offset:10240
ds_read_b64_tr_b16 v[98:99], v8 offset:10752
buffer_load_dwordx4 v3, s[20:23], s68 offen offset:256 lds
v_accvgpr_read_b32 v27, a19
v_accvgpr_read_b32 v28, a48
v_accvgpr_read_b32 v29, a49
v_mfma_f32_32x32x16_bf16 a[80:95], v[100:103], v[228:231], a[80:95]
ds_read_b64_tr_b16 v[100:101], v11 offset:10240
ds_read_b64_tr_b16 v[102:103], v11 offset:10752
v_accvgpr_read_b32 v30, a50
v_accvgpr_read_b32 v31, a51
v_max_f32 v24, 0, v24
v_max_f32 v25, 0, v25
s_waitcnt lgkmcnt(8)
v_mfma_f32_32x32x16_bf16 a[96:111], v[104:107], v[228:231], a[96:111]
ds_read_b64_tr_b16 v[104:105], v8 offset:12288
ds_read_b64_tr_b16 v[106:107], v8 offset:12800
v_max_f32 v26, 0, v26
v_max_f32 v27, 0, v27
v_mul_f32 v24, v24, v28
v_mul_f32 v25, v25, v29
v_mfma_f32_32x32x16_bf16 a[112:127], v[108:111], v[228:231], a[112:127]
ds_read_b64_tr_b16 v[108:109], v11 offset:12288
ds_read_b64_tr_b16 v[110:111], v11 offset:12800
v_mul_f32 v26, v26, v30
v_mul_f32 v27, v27, v31
v_cvt_pk_bf16_f32 v24, v24, v25
s_add_u32 m0, s40, 118528
s_waitcnt lgkmcnt(8)
v_mfma_f32_32x32x16_bf16 a[64:79], v[88:91], v[232:235], a[64:79]
ds_read_b64_tr_b16 v[88:89], v8 offset:14336
ds_read_b64_tr_b16 v[90:91], v8 offset:14848
buffer_load_dwordx4 v3, s[20:23], s69 offen offset:256 lds
v_cvt_pk_bf16_f32 v26, v26, v27
v_accvgpr_write_b32 a136, v24
v_accvgpr_write_b32 a137, v26
v_mfma_f32_32x32x16_bf16 a[80:95], v[92:95], v[232:235], a[80:95]
ds_read_b64_tr_b16 v[92:93], v11 offset:14336
ds_read_b64_tr_b16 v[94:95], v11 offset:14848
v_accvgpr_read_b32 v32, a20
v_accvgpr_read_b32 v33, a21
v_accvgpr_read_b32 v34, a22
v_accvgpr_read_b32 v35, a23
s_waitcnt lgkmcnt(8)
v_mfma_f32_32x32x16_bf16 a[96:111], v[96:99], v[232:235], a[96:111]
s_waitcnt vmcnt(30)
s_barrier
ds_read_b64_tr_b16 v[96:97], v8 offset:16384
ds_read_b64_tr_b16 v[98:99], v8 offset:16896
v_accvgpr_read_b32 v36, a52
v_accvgpr_read_b32 v37, a53
v_mfma_f32_32x32x16_bf16 a[112:127], v[100:103], v[232:235], a[112:127]
ds_read_b64_tr_b16 v[100:101], v11 offset:16384
ds_read_b64_tr_b16 v[102:103], v11 offset:16896
v_accvgpr_read_b32 v38, a54
v_accvgpr_read_b32 v39, a55
v_max_f32 v32, 0, v32
s_add_u32 m0, s40, 122624
s_waitcnt lgkmcnt(8)
v_mfma_f32_32x32x16_bf16 a[64:79], v[104:107], v[236:239], a[64:79]
ds_read_b64_tr_b16 v[104:105], v8 offset:18432
ds_read_b64_tr_b16 v[106:107], v8 offset:18944
buffer_load_dwordx4 v3, s[20:23], s70 offen offset:256 lds
v_max_f32 v33, 0, v33
v_max_f32 v34, 0, v34
v_max_f32 v35, 0, v35
v_mfma_f32_32x32x16_bf16 a[80:95], v[108:111], v[236:239], a[80:95]
ds_read_b64_tr_b16 v[108:109], v11 offset:18432
ds_read_b64_tr_b16 v[110:111], v11 offset:18944
v_mul_f32 v32, v32, v36
v_mul_f32 v33, v33, v37
v_mul_f32 v34, v34, v38
v_mul_f32 v35, v35, v39
s_waitcnt lgkmcnt(8)
v_mfma_f32_32x32x16_bf16 a[96:111], v[88:91], v[236:239], a[96:111]
ds_read_b64_tr_b16 v[88:89], v8 offset:20480
ds_read_b64_tr_b16 v[90:91], v8 offset:20992
v_cvt_pk_bf16_f32 v32, v32, v33
v_cvt_pk_bf16_f32 v34, v34, v35
v_accvgpr_write_b32 a138, v32
v_accvgpr_write_b32 a139, v34
v_mfma_f32_32x32x16_bf16 a[112:127], v[92:95], v[236:239], a[112:127]
ds_read_b64_tr_b16 v[92:93], v11 offset:20480
ds_read_b64_tr_b16 v[94:95], v11 offset:20992
s_mov_b32 s6, 81920
buffer_store_dwordx4 a[136:139], v21, s[36:39], s6 offen offset:2048 sc1
v_accvgpr_read_b32 v24, a24
s_add_u32 m0, s40, 126720
s_waitcnt lgkmcnt(8)
v_mfma_f32_32x32x16_bf16 a[64:79], v[96:99], v[240:243], a[64:79]
ds_read_b64_tr_b16 v[96:97], v8 offset:22528
ds_read_b64_tr_b16 v[98:99], v8 offset:23040
buffer_load_dwordx4 v3, s[20:23], s71 offen offset:256 lds
v_accvgpr_read_b32 v25, a25
v_accvgpr_read_b32 v26, a26
v_accvgpr_read_b32 v27, a27
v_mfma_f32_32x32x16_bf16 a[80:95], v[100:103], v[240:243], a[80:95]
ds_read_b64_tr_b16 v[100:101], v11 offset:22528
ds_read_b64_tr_b16 v[102:103], v11 offset:23040
v_accvgpr_read_b32 v28, a56
v_accvgpr_read_b32 v29, a57
v_accvgpr_read_b32 v30, a58
v_accvgpr_read_b32 v31, a59
s_waitcnt lgkmcnt(8)
v_mfma_f32_32x32x16_bf16 a[96:111], v[104:107], v[240:243], a[96:111]
s_waitcnt vmcnt(31)
s_barrier
ds_read_b64_tr_b16 v[104:105], v8 offset:24576
ds_read_b64_tr_b16 v[106:107], v8 offset:25088
v_max_f32 v24, 0, v24
v_max_f32 v25, 0, v25
v_mfma_f32_32x32x16_bf16 a[112:127], v[108:111], v[240:243], a[112:127]
ds_read_b64_tr_b16 v[108:109], v11 offset:24576
ds_read_b64_tr_b16 v[110:111], v11 offset:25088
v_max_f32 v26, 0, v26
v_max_f32 v27, 0, v27
s_mov_b32 m0, s40
s_add_u32 s41, s72, 256
s_waitcnt lgkmcnt(8)
v_mfma_f32_32x32x16_bf16 a[64:79], v[88:91], v[244:247], a[64:79]
ds_read_b64_tr_b16 v[88:89], v8 offset:26624
ds_read_b64_tr_b16 v[90:91], v8 offset:27136
buffer_load_dwordx4 v3, s[20:23], s41 offen lds
v_mul_f32 v24, v24, v28
v_mul_f32 v25, v25, v29
v_mul_f32 v26, v26, v30
v_mfma_f32_32x32x16_bf16 a[80:95], v[92:95], v[244:247], a[80:95]
ds_read_b64_tr_b16 v[92:93], v11 offset:26624
ds_read_b64_tr_b16 v[94:95], v11 offset:27136
v_mul_f32 v27, v27, v31
v_cvt_pk_bf16_f32 v24, v24, v25
v_cvt_pk_bf16_f32 v26, v26, v27
v_accvgpr_write_b32 a140, v24
s_waitcnt lgkmcnt(8)
v_mfma_f32_32x32x16_bf16 a[96:111], v[96:99], v[244:247], a[96:111]
ds_read_b64_tr_b16 v[96:97], v8 offset:28672
ds_read_b64_tr_b16 v[98:99], v8 offset:29184
v_accvgpr_write_b32 a141, v26
v_accvgpr_read_b32 v32, a28
v_accvgpr_read_b32 v33, a29
v_accvgpr_read_b32 v34, a30
v_mfma_f32_32x32x16_bf16 a[112:127], v[100:103], v[244:247], a[112:127]
ds_read_b64_tr_b16 v[100:101], v11 offset:28672
ds_read_b64_tr_b16 v[102:103], v11 offset:29184
v_accvgpr_read_b32 v35, a31
v_accvgpr_read_b32 v36, a60
v_accvgpr_read_b32 v37, a61
s_add_u32 m0, s40, 3840
s_waitcnt lgkmcnt(8)
v_mfma_f32_32x32x16_bf16 a[64:79], v[104:107], v[248:251], a[64:79]
ds_read_b64_tr_b16 v[104:105], v8 offset:30720
ds_read_b64_tr_b16 v[106:107], v8 offset:31232
buffer_load_dwordx4 v3, s[20:23], s73 offen offset:256 lds
v_accvgpr_read_b32 v38, a62
v_accvgpr_read_b32 v39, a63
v_max_f32 v32, 0, v32
v_mfma_f32_32x32x16_bf16 a[80:95], v[108:111], v[248:251], a[80:95]
ds_read_b64_tr_b16 v[108:109], v11 offset:30720
ds_read_b64_tr_b16 v[110:111], v11 offset:31232
v_max_f32 v33, 0, v33
v_max_f32 v34, 0, v34
v_max_f32 v35, 0, v35
v_mul_f32 v32, v32, v36
s_waitcnt lgkmcnt(8)
v_mfma_f32_32x32x16_bf16 a[96:111], v[88:91], v[248:251], a[96:111]
s_waitcnt vmcnt(31)
s_barrier
ds_read_b64_tr_b16 v[88:89], v8 offset:32768
ds_read_b64_tr_b16 v[90:91], v8 offset:33280
v_mul_f32 v33, v33, v37
v_mul_f32 v34, v34, v38
v_mfma_f32_32x32x16_bf16 a[112:127], v[92:95], v[248:251], a[112:127]
ds_read_b64_tr_b16 v[92:93], v11 offset:32768
ds_read_b64_tr_b16 v[94:95], v11 offset:33280
v_mul_f32 v35, v35, v39
v_cvt_pk_bf16_f32 v32, v32, v33
v_cvt_pk_bf16_f32 v34, v34, v35
s_add_u32 m0, s40, 7936
s_waitcnt lgkmcnt(8)
v_mfma_f32_32x32x16_bf16 a[64:79], v[96:99], v[252:255], a[64:79]
ds_read_b64_tr_b16 v[96:97], v8 offset:34816
ds_read_b64_tr_b16 v[98:99], v8 offset:35328
buffer_load_dwordx4 v3, s[20:23], s74 offen offset:256 lds
v_accvgpr_write_b32 a142, v32
v_accvgpr_write_b32 a143, v34
v_max_f32 v41, s46, v41
v_mfma_f32_32x32x16_bf16 a[80:95], v[100:103], v[252:255], a[80:95]
ds_read_b64_tr_b16 v[100:101], v11 offset:34816
ds_read_b64_tr_b16 v[102:103], v11 offset:35328
s_mov_b32 s6, 81920
buffer_store_dwordx4 a[140:143], v21, s[36:39], s6 offen offset:3072 sc1
v_add_f32 v40, v40, v42
v_add_f32 v41, v41, v43
s_waitcnt lgkmcnt(8)
v_mfma_f32_32x32x16_bf16 a[96:111], v[104:107], v[252:255], a[96:111]
ds_read_b64_tr_b16 v[104:105], v8 offset:36864
ds_read_b64_tr_b16 v[106:107], v8 offset:37376
v_cvt_pk_bf16_f32 v40, v40, v41
v_accvgpr_write_b32 a246, v40
v_accvgpr_read_b32 v44, a254
v_accvgpr_read_b32 v45, a255
v_mfma_f32_32x32x16_bf16 a[112:127], v[108:111], v[252:255], a[112:127]
ds_read_b64_tr_b16 v[108:109], v11 offset:36864
ds_read_b64_tr_b16 v[110:111], v11 offset:37376
v_fma_f32 v46, v44, s43, v19
v_fma_f32 v47, v45, s43, v19
s_add_u32 m0, s40, 12032
s_waitcnt lgkmcnt(8)
v_mfma_f32_32x32x16_bf16 a[0:15], v[88:91], v[112:115], 0
ds_read_b64_tr_b16 v[88:89], v8 offset:38912
ds_read_b64_tr_b16 v[90:91], v8 offset:39424
buffer_load_dwordx4 v3, s[20:23], s75 offen offset:256 lds
v_exp_f32 v46, v46 clamp
v_max_f32 v44, s46, v44
v_mfma_f32_32x32x16_bf16 a[16:31], v[92:95], v[112:115], 0
ds_read_b64_tr_b16 v[92:93], v11 offset:38912
ds_read_b64_tr_b16 v[94:95], v11 offset:39424
v_exp_f32 v47, v47 clamp
v_max_f32 v45, s46, v45
s_waitcnt lgkmcnt(8)
v_mfma_f32_32x32x16_bf16 a[32:47], v[96:99], v[112:115], 0
s_waitcnt vmcnt(32)
s_barrier
ds_read_b64_tr_b16 v[96:97], v8 offset:40960
ds_read_b64_tr_b16 v[98:99], v8 offset:41472
v_add_f32 v44, v44, v46
v_add_f32 v45, v45, v47
v_mfma_f32_32x32x16_bf16 a[48:63], v[100:103], v[112:115], 0
ds_read_b64_tr_b16 v[100:101], v11 offset:40960
ds_read_b64_tr_b16 v[102:103], v11 offset:41472
v_cvt_pk_bf16_f32 v44, v44, v45
s_add_u32 m0, s40, 16128
s_waitcnt lgkmcnt(8)
v_mfma_f32_32x32x16_bf16 a[0:15], v[104:107], v[116:119], a[0:15]
ds_read_b64_tr_b16 v[104:105], v8 offset:43008
ds_read_b64_tr_b16 v[106:107], v8 offset:43520
buffer_load_dwordx4 v3, s[20:23], s76 offen offset:256 lds
v_accvgpr_write_b32 a247, v44
v_cvt_pk_bf16_f32 v52, v52, v53
v_cvt_pk_bf16_f32 v54, v54, v55
v_mfma_f32_32x32x16_bf16 a[16:31], v[108:111], v[116:119], a[16:31]
ds_read_b64_tr_b16 v[108:109], v11 offset:43008
ds_read_b64_tr_b16 v[110:111], v11 offset:43520
v_accvgpr_write_b32 a248, 0
v_accvgpr_write_b32 a249, 0
v_accvgpr_write_b32 a250, v52
s_waitcnt lgkmcnt(8)
v_mfma_f32_32x32x16_bf16 a[32:47], v[88:91], v[116:119], a[32:47]
ds_read_b64_tr_b16 v[88:89], v8 offset:45056
ds_read_b64_tr_b16 v[90:91], v8 offset:45568
v_accvgpr_write_b32 a251, v54
v_mov_b32 v19, 1
v_accvgpr_read_b32 v43, a183
v_accvgpr_read_b32 v44, a181
v_mfma_f32_32x32x16_bf16 a[48:63], v[92:95], v[116:119], a[48:63]
ds_read_b64_tr_b16 v[92:93], v11 offset:45056
ds_read_b64_tr_b16 v[94:95], v11 offset:45568
v_accvgpr_write_b32 a252, v44
v_accvgpr_read_b32 v24, a64
s_add_u32 m0, s40, 20224
s_waitcnt lgkmcnt(8)
v_mfma_f32_32x32x16_bf16 a[0:15], v[96:99], v[120:123], a[0:15]
ds_read_b64_tr_b16 v[96:97], v8 offset:47104
ds_read_b64_tr_b16 v[98:99], v8 offset:47616
buffer_load_dwordx4 v3, s[20:23], s77 offen offset:256 lds
v_accvgpr_read_b32 v25, a65
v_accvgpr_read_b32 v26, a66
v_mfma_f32_32x32x16_bf16 a[16:31], v[100:103], v[120:123], a[16:31]
ds_read_b64_tr_b16 v[100:101], v11 offset:47104
ds_read_b64_tr_b16 v[102:103], v11 offset:47616
v_accvgpr_read_b32 v27, a67
v_accvgpr_read_b32 v28, a96
v_accvgpr_read_b32 v29, a97
s_waitcnt lgkmcnt(8)
v_mfma_f32_32x32x16_bf16 a[32:47], v[104:107], v[120:123], a[32:47]
s_waitcnt vmcnt(32)
s_waitcnt vmcnt(27)
s_barrier
ds_read_b64_tr_b16 v[104:105], v8 offset:49152
ds_read_b64_tr_b16 v[106:107], v8 offset:49664
buffer_store_byte v19, v0, s[32:35], 0 offen sc1
v_mfma_f32_32x32x16_bf16 a[48:63], v[108:111], v[120:123], a[48:63]
ds_read_b64_tr_b16 v[108:109], v11 offset:49152
ds_read_b64_tr_b16 v[110:111], v11 offset:49664
s_and_b32 s7, s4, 1
s_mul_i32 s47, s7, -82944
s_add_u32 m0, s40, 24320
s_waitcnt lgkmcnt(8)
v_mfma_f32_32x32x16_bf16 a[0:15], v[88:91], v[124:127], a[0:15]
ds_read_b64_tr_b16 v[88:89], v8 offset:51200
ds_read_b64_tr_b16 v[90:91], v8 offset:51712
buffer_load_dwordx4 v3, s[20:23], s78 offen offset:256 lds
s_add_u32 s47, s47, 41472
v_add_u32 v45, s47, v43
s_lshl_b32 s7, s7, 2
v_mfma_f32_32x32x16_bf16 a[16:31], v[92:95], v[124:127], a[16:31]
ds_read_b64_tr_b16 v[92:93], v11 offset:51200
ds_read_b64_tr_b16 v[94:95], v11 offset:51712
s_add_u32 s7, s7, s3
s_lshl_b32 s7, s7, 7
s_waitcnt lgkmcnt(8)
v_mfma_f32_32x32x16_bf16 a[32:47], v[96:99], v[124:127], a[32:47]
ds_read_b64_tr_b16 v[96:97], v8 offset:53248
ds_read_b64_tr_b16 v[98:99], v8 offset:53760
s_add_u32 s7, s7, 128
s_add_u32 m0, s40, 131072
s_nop 0
buffer_load_dwordx4 v43, s[16:19], s7 offen lds
v_accvgpr_read_b32 v30, a98
v_mfma_f32_32x32x16_bf16 a[48:63], v[100:103], v[124:127], a[48:63]
ds_read_b64_tr_b16 v[100:101], v11 offset:53248
ds_read_b64_tr_b16 v[102:103], v11 offset:53760
s_add_u32 m0, s40, 135168
s_nop 0
buffer_load_dwordx4 v45, s[16:19], s7 offen lds
s_add_u32 m0, s40, 28416
s_waitcnt lgkmcnt(8)
v_mfma_f32_32x32x16_bf16 a[0:15], v[104:107], v[128:131], a[0:15]
ds_read_b64_tr_b16 v[104:105], v8 offset:55296
ds_read_b64_tr_b16 v[106:107], v8 offset:55808
buffer_load_dwordx4 v3, s[20:23], s79 offen offset:256 lds
s_mov_b32 m0, 139264
s_nop 0
buffer_load_dwordx4 v43, s[16:19], 0 offen lds
v_accvgpr_read_b32 v31, a99
v_mfma_f32_32x32x16_bf16 a[16:31], v[108:111], v[128:131], a[16:31]
ds_read_b64_tr_b16 v[108:109], v11 offset:55296
ds_read_b64_tr_b16 v[110:111], v11 offset:55808
v_max_f32 v24, 0, v24
v_max_f32 v25, 0, v25
v_max_f32 v26, 0, v26
s_waitcnt lgkmcnt(8)
v_mfma_f32_32x32x16_bf16 a[32:47], v[88:91], v[128:131], a[32:47]
s_waitcnt vmcnt(32)
s_barrier
ds_read_b64_tr_b16 v[88:89], v8 offset:57344
ds_read_b64_tr_b16 v[90:91], v8 offset:57856
buffer_load_dword a182, v13, s[24:27], 0 offen offset:0
v_mfma_f32_32x32x16_bf16 a[48:63], v[92:95], v[128:131], a[48:63]
ds_read_b64_tr_b16 v[92:93], v11 offset:57344
ds_read_b64_tr_b16 v[94:95], v11 offset:57856
v_max_f32 v27, 0, v27
v_mul_f32 v24, v24, v28
s_add_u32 m0, s40, 32512
s_waitcnt lgkmcnt(8)
v_mfma_f32_32x32x16_bf16 a[0:15], v[96:99], v[132:135], a[0:15]
ds_read_b64_tr_b16 v[96:97], v8 offset:59392
ds_read_b64_tr_b16 v[98:99], v8 offset:59904
buffer_load_dwordx4 v3, s[20:23], s80 offen offset:256 lds
v_mul_f32 v25, v25, v29
v_mul_f32 v26, v26, v30
v_mul_f32 v27, v27, v31
v_mfma_f32_32x32x16_bf16 a[16:31], v[100:103], v[132:135], a[16:31]
ds_read_b64_tr_b16 v[100:101], v11 offset:59392
ds_read_b64_tr_b16 v[102:103], v11 offset:59904
v_cvt_pk_bf16_f32 v24, v24, v25
v_cvt_pk_bf16_f32 v26, v26, v27
v_accvgpr_write_b32 a144, v24
s_waitcnt lgkmcnt(8)
v_mfma_f32_32x32x16_bf16 a[32:47], v[104:107], v[132:135], a[32:47]
ds_read_b64_tr_b16 v[104:105], v8 offset:61440
ds_read_b64_tr_b16 v[106:107], v8 offset:61952
v_accvgpr_write_b32 a145, v26
v_accvgpr_read_b32 v32, a68
v_accvgpr_read_b32 v33, a69
v_accvgpr_read_b32 v34, a70
v_mfma_f32_32x32x16_bf16 a[48:63], v[108:111], v[132:135], a[48:63]
ds_read_b64_tr_b16 v[108:109], v11 offset:61440
ds_read_b64_tr_b16 v[110:111], v11 offset:61952
v_accvgpr_read_b32 v35, a71
s_add_u32 m0, s40, 36608
s_waitcnt lgkmcnt(8)
v_mfma_f32_32x32x16_bf16 a[0:15], v[88:91], v[136:139], a[0:15]
ds_read_b64_tr_b16 v[88:89], v8 offset:63488
ds_read_b64_tr_b16 v[90:91], v8 offset:64000
buffer_load_dwordx4 v3, s[20:23], s81 offen offset:256 lds
v_accvgpr_read_b32 v36, a100
v_accvgpr_read_b32 v37, a101
v_accvgpr_read_b32 v38, a102
v_mfma_f32_32x32x16_bf16 a[16:31], v[92:95], v[136:139], a[16:31]
ds_read_b64_tr_b16 v[92:93], v11 offset:63488
ds_read_b64_tr_b16 v[94:95], v11 offset:64000
v_accvgpr_read_b32 v39, a103
v_max_f32 v32, 0, v32
v_max_f32 v33, 0, v33
s_waitcnt lgkmcnt(8)
v_mfma_f32_32x32x16_bf16 a[32:47], v[96:99], v[136:139], a[32:47]
s_waitcnt vmcnt(33)
s_barrier
ds_read_b64_tr_b16 v[96:97], v9 offset:0
ds_read_b64_tr_b16 v[98:99], v9 offset:512
v_max_f32 v34, 0, v34
v_max_f32 v35, 0, v35
v_mfma_f32_32x32x16_bf16 a[48:63], v[100:103], v[136:139], a[48:63]
ds_read_b64_tr_b16 v[100:101], v12 offset:0
ds_read_b64_tr_b16 v[102:103], v12 offset:512
v_mul_f32 v32, v32, v36
v_mul_f32 v33, v33, v37
s_add_u32 m0, s40, 40704
s_waitcnt lgkmcnt(8)
v_mfma_f32_32x32x16_bf16 a[0:15], v[104:107], v[140:143], a[0:15]
ds_read_b64_tr_b16 v[104:105], v9 offset:2048
ds_read_b64_tr_b16 v[106:107], v9 offset:2560
buffer_load_dwordx4 v3, s[20:23], s82 offen offset:256 lds
v_mul_f32 v34, v34, v38
v_mul_f32 v35, v35, v39
v_mfma_f32_32x32x16_bf16 a[16:31], v[108:111], v[140:143], a[16:31]
ds_read_b64_tr_b16 v[108:109], v12 offset:2048
ds_read_b64_tr_b16 v[110:111], v12 offset:2560
v_cvt_pk_bf16_f32 v32, v32, v33
v_cvt_pk_bf16_f32 v34, v34, v35
v_accvgpr_write_b32 a146, v32
s_waitcnt lgkmcnt(8)
v_mfma_f32_32x32x16_bf16 a[32:47], v[88:91], v[140:143], a[32:47]
ds_read_b64_tr_b16 v[88:89], v9 offset:4096
ds_read_b64_tr_b16 v[90:91], v9 offset:4608
v_accvgpr_write_b32 a147, v34
s_mov_b32 s6, 98304
buffer_store_dwordx4 a[144:147], v21, s[36:39], s6 offen offset:0 sc1
v_accvgpr_read_b32 v24, a72
v_mfma_f32_32x32x16_bf16 a[48:63], v[92:95], v[140:143], a[48:63]
ds_read_b64_tr_b16 v[92:93], v12 offset:4096
ds_read_b64_tr_b16 v[94:95], v12 offset:4608
v_accvgpr_read_b32 v25, a73
v_accvgpr_read_b32 v26, a74
s_add_u32 m0, s40, 44800
s_waitcnt lgkmcnt(8)
v_mfma_f32_32x32x16_bf16 a[0:15], v[96:99], v[144:147], a[0:15]
ds_read_b64_tr_b16 v[96:97], v9 offset:6144
ds_read_b64_tr_b16 v[98:99], v9 offset:6656
buffer_load_dwordx4 v3, s[20:23], s83 offen offset:256 lds
v_accvgpr_read_b32 v27, a75
v_accvgpr_read_b32 v28, a104
v_accvgpr_read_b32 v29, a105
v_mfma_f32_32x32x16_bf16 a[16:31], v[100:103], v[144:147], a[16:31]
ds_read_b64_tr_b16 v[100:101], v12 offset:6144
ds_read_b64_tr_b16 v[102:103], v12 offset:6656
v_accvgpr_read_b32 v30, a106
v_accvgpr_read_b32 v31, a107
s_waitcnt lgkmcnt(8)
v_mfma_f32_32x32x16_bf16 a[32:47], v[104:107], v[144:147], a[32:47]
s_waitcnt vmcnt(34)
s_barrier
ds_read_b64_tr_b16 v[104:105], v9 offset:8192
ds_read_b64_tr_b16 v[106:107], v9 offset:8704
v_max_f32 v24, 0, v24
v_max_f32 v25, 0, v25
v_mfma_f32_32x32x16_bf16 a[48:63], v[108:111], v[144:147], a[48:63]
ds_read_b64_tr_b16 v[108:109], v12 offset:8192
ds_read_b64_tr_b16 v[110:111], v12 offset:8704
v_max_f32 v26, 0, v26
v_max_f32 v27, 0, v27
s_add_u32 m0, s40, 48768
s_waitcnt lgkmcnt(8)
v_mfma_f32_32x32x16_bf16 a[0:15], v[88:91], v[148:151], a[0:15]
ds_read_b64_tr_b16 v[88:89], v9 offset:10240
ds_read_b64_tr_b16 v[90:91], v9 offset:10752
buffer_load_dwordx4 v3, s[20:23], s48 offen offset:384 lds
v_mul_f32 v24, v24, v28
v_mul_f32 v25, v25, v29
v_mul_f32 v26, v26, v30
v_mfma_f32_32x32x16_bf16 a[16:31], v[92:95], v[148:151], a[16:31]
ds_read_b64_tr_b16 v[92:93], v12 offset:10240
ds_read_b64_tr_b16 v[94:95], v12 offset:10752
v_mul_f32 v27, v27, v31
v_cvt_pk_bf16_f32 v24, v24, v25
v_cvt_pk_bf16_f32 v26, v26, v27
s_waitcnt lgkmcnt(8)
v_mfma_f32_32x32x16_bf16 a[32:47], v[96:99], v[148:151], a[32:47]
ds_read_b64_tr_b16 v[96:97], v9 offset:12288
ds_read_b64_tr_b16 v[98:99], v9 offset:12800
v_accvgpr_write_b32 a148, v24
v_accvgpr_write_b32 a149, v26
v_accvgpr_read_b32 v32, a76
v_mfma_f32_32x32x16_bf16 a[48:63], v[100:103], v[148:151], a[48:63]
ds_read_b64_tr_b16 v[100:101], v12 offset:12288
ds_read_b64_tr_b16 v[102:103], v12 offset:12800
v_accvgpr_read_b32 v33, a77
v_accvgpr_read_b32 v34, a78
s_add_u32 m0, s40, 52864
s_waitcnt lgkmcnt(8)
v_mfma_f32_32x32x16_bf16 a[0:15], v[104:107], v[152:155], a[0:15]
ds_read_b64_tr_b16 v[104:105], v9 offset:14336
ds_read_b64_tr_b16 v[106:107], v9 offset:14848
buffer_load_dwordx4 v3, s[20:23], s49 offen offset:384 lds
v_accvgpr_read_b32 v35, a79
v_accvgpr_read_b32 v36, a108
v_accvgpr_read_b32 v37, a109
v_mfma_f32_32x32x16_bf16 a[16:31], v[108:111], v[152:155], a[16:31]
ds_read_b64_tr_b16 v[108:109], v12 offset:14336
ds_read_b64_tr_b16 v[110:111], v12 offset:14848
v_accvgpr_read_b32 v38, a110
v_accvgpr_read_b32 v39, a111
v_max_f32 v32, 0, v32
s_waitcnt lgkmcnt(8)
v_mfma_f32_32x32x16_bf16 a[32:47], v[88:91], v[152:155], a[32:47]
s_waitcnt vmcnt(34)
s_barrier
ds_read_b64_tr_b16 v[88:89], v9 offset:16384
ds_read_b64_tr_b16 v[90:91], v9 offset:16896
v_max_f32 v33, 0, v33
v_max_f32 v34, 0, v34
v_mfma_f32_32x32x16_bf16 a[48:63], v[92:95], v[152:155], a[48:63]
ds_read_b64_tr_b16 v[92:93], v12 offset:16384
ds_read_b64_tr_b16 v[94:95], v12 offset:16896
v_max_f32 v35, 0, v35
s_add_u32 m0, s40, 56960
s_waitcnt lgkmcnt(8)
v_mfma_f32_32x32x16_bf16 a[0:15], v[96:99], v[156:159], a[0:15]
ds_read_b64_tr_b16 v[96:97], v9 offset:18432
ds_read_b64_tr_b16 v[98:99], v9 offset:18944
buffer_load_dwordx4 v3, s[20:23], s50 offen offset:384 lds
v_mul_f32 v32, v32, v36
v_mul_f32 v33, v33, v37
v_mul_f32 v34, v34, v38
v_mfma_f32_32x32x16_bf16 a[16:31], v[100:103], v[156:159], a[16:31]
ds_read_b64_tr_b16 v[100:101], v12 offset:18432
ds_read_b64_tr_b16 v[102:103], v12 offset:18944
v_mul_f32 v35, v35, v39
v_cvt_pk_bf16_f32 v32, v32, v33
v_cvt_pk_bf16_f32 v34, v34, v35
s_waitcnt lgkmcnt(8)
v_mfma_f32_32x32x16_bf16 a[32:47], v[104:107], v[156:159], a[32:47]
ds_read_b64_tr_b16 v[104:105], v9 offset:20480
ds_read_b64_tr_b16 v[106:107], v9 offset:20992
v_accvgpr_write_b32 a150, v32
v_accvgpr_write_b32 a151, v34
s_mov_b32 s6, 98304
buffer_store_dwordx4 a[148:151], v21, s[36:39], s6 offen offset:1024 sc1
v_mfma_f32_32x32x16_bf16 a[48:63], v[108:111], v[156:159], a[48:63]
ds_read_b64_tr_b16 v[108:109], v12 offset:20480
ds_read_b64_tr_b16 v[110:111], v12 offset:20992
v_accvgpr_read_b32 v24, a80
v_accvgpr_read_b32 v25, a81
s_add_u32 m0, s40, 61056
s_waitcnt lgkmcnt(8)
v_mfma_f32_32x32x16_bf16 a[0:15], v[88:91], v[160:163], a[0:15]
ds_read_b64_tr_b16 v[88:89], v9 offset:22528
ds_read_b64_tr_b16 v[90:91], v9 offset:23040
buffer_load_dwordx4 v3, s[20:23], s51 offen offset:384 lds
v_accvgpr_read_b32 v26, a82
v_accvgpr_read_b32 v27, a83
v_mfma_f32_32x32x16_bf16 a[16:31], v[92:95], v[160:163], a[16:31]
ds_read_b64_tr_b16 v[92:93], v12 offset:22528
ds_read_b64_tr_b16 v[94:95], v12 offset:23040
v_accvgpr_read_b32 v28, a112
v_accvgpr_read_b32 v29, a113
v_accvgpr_read_b32 v30, a114
s_waitcnt lgkmcnt(8)
v_mfma_f32_32x32x16_bf16 a[32:47], v[96:99], v[160:163], a[32:47]
s_waitcnt vmcnt(35)
s_barrier
ds_read_b64_tr_b16 v[96:97], v9 offset:24576
ds_read_b64_tr_b16 v[98:99], v9 offset:25088
v_accvgpr_read_b32 v31, a115
v_max_f32 v24, 0, v24
v_mfma_f32_32x32x16_bf16 a[48:63], v[100:103], v[160:163], a[48:63]
ds_read_b64_tr_b16 v[100:101], v12 offset:24576
ds_read_b64_tr_b16 v[102:103], v12 offset:25088
v_max_f32 v25, 0, v25
v_max_f32 v26, 0, v26
s_add_u32 m0, s40, 65152
s_waitcnt lgkmcnt(8)
v_mfma_f32_32x32x16_bf16 a[0:15], v[104:107], v[164:167], a[0:15]
ds_read_b64_tr_b16 v[104:105], v9 offset:26624
ds_read_b64_tr_b16 v[106:107], v9 offset:27136
buffer_load_dwordx4 v3, s[20:23], s52 offen offset:384 lds
v_max_f32 v27, 0, v27
v_mul_f32 v24, v24, v28
v_mul_f32 v25, v25, v29
v_mfma_f32_32x32x16_bf16 a[16:31], v[108:111], v[164:167], a[16:31]
ds_read_b64_tr_b16 v[108:109], v12 offset:26624
ds_read_b64_tr_b16 v[110:111], v12 offset:27136
v_mul_f32 v26, v26, v30
v_mul_f32 v27, v27, v31
s_waitcnt lgkmcnt(8)
v_mfma_f32_32x32x16_bf16 a[32:47], v[88:91], v[164:167], a[32:47]
ds_read_b64_tr_b16 v[88:89], v9 offset:28672
ds_read_b64_tr_b16 v[90:91], v9 offset:29184
v_cvt_pk_bf16_f32 v24, v24, v25
v_cvt_pk_bf16_f32 v26, v26, v27
v_accvgpr_write_b32 a152, v24
v_accvgpr_write_b32 a153, v26
v_mfma_f32_32x32x16_bf16 a[48:63], v[92:95], v[164:167], a[48:63]
ds_read_b64_tr_b16 v[92:93], v12 offset:28672
ds_read_b64_tr_b16 v[94:95], v12 offset:29184
v_accvgpr_read_b32 v32, a84
v_accvgpr_read_b32 v33, a85
s_add_u32 m0, s40, 69248
s_waitcnt lgkmcnt(8)
v_mfma_f32_32x32x16_bf16 a[0:15], v[96:99], v[168:171], a[0:15]
ds_read_b64_tr_b16 v[96:97], v9 offset:30720
ds_read_b64_tr_b16 v[98:99], v9 offset:31232
buffer_load_dwordx4 v3, s[20:23], s53 offen offset:384 lds
v_accvgpr_read_b32 v34, a86
v_accvgpr_read_b32 v35, a87
v_accvgpr_read_b32 v36, a116
v_mfma_f32_32x32x16_bf16 a[16:31], v[100:103], v[168:171], a[16:31]
ds_read_b64_tr_b16 v[100:101], v12 offset:30720
ds_read_b64_tr_b16 v[102:103], v12 offset:31232
v_accvgpr_read_b32 v37, a117
v_accvgpr_read_b32 v38, a118
v_accvgpr_read_b32 v39, a119
s_waitcnt lgkmcnt(8)
v_mfma_f32_32x32x16_bf16 a[32:47], v[104:107], v[168:171], a[32:47]
s_waitcnt vmcnt(34)
s_barrier
ds_read_b64_tr_b16 v[104:105], v9 offset:32768
ds_read_b64_tr_b16 v[106:107], v9 offset:33280
buffer_load_dword a182, v13, s[24:27], 0 offen offset:1792
v_mfma_f32_32x32x16_bf16 a[48:63], v[108:111], v[168:171], a[48:63]
ds_read_b64_tr_b16 v[108:109], v12 offset:32768
ds_read_b64_tr_b16 v[110:111], v12 offset:33280
v_max_f32 v32, 0, v32
v_max_f32 v33, 0, v33
s_add_u32 m0, s40, 73344
s_waitcnt lgkmcnt(8)
v_mfma_f32_32x32x16_bf16 a[0:15], v[88:91], v[172:175], a[0:15]
ds_read_b64_tr_b16 v[88:89], v9 offset:34816
ds_read_b64_tr_b16 v[90:91], v9 offset:35328
buffer_load_dwordx4 v3, s[20:23], s54 offen offset:384 lds
v_max_f32 v34, 0, v34
v_max_f32 v35, 0, v35
v_mul_f32 v32, v32, v36
v_mfma_f32_32x32x16_bf16 a[16:31], v[92:95], v[172:175], a[16:31]
ds_read_b64_tr_b16 v[92:93], v12 offset:34816
ds_read_b64_tr_b16 v[94:95], v12 offset:35328
v_mul_f32 v33, v33, v37
v_mul_f32 v34, v34, v38
v_mul_f32 v35, v35, v39
s_waitcnt lgkmcnt(8)
v_mfma_f32_32x32x16_bf16 a[32:47], v[96:99], v[172:175], a[32:47]
ds_read_b64_tr_b16 v[96:97], v9 offset:36864
ds_read_b64_tr_b16 v[98:99], v9 offset:37376
v_cvt_pk_bf16_f32 v32, v32, v33
v_cvt_pk_bf16_f32 v34, v34, v35
v_accvgpr_write_b32 a154, v32
v_accvgpr_write_b32 a155, v34
v_mfma_f32_32x32x16_bf16 a[48:63], v[100:103], v[172:175], a[48:63]
ds_read_b64_tr_b16 v[100:101], v12 offset:36864
ds_read_b64_tr_b16 v[102:103], v12 offset:37376
s_mov_b32 s6, 98304
buffer_store_dwordx4 a[152:155], v21, s[36:39], s6 offen offset:2048 sc1
s_add_u32 m0, s40, 77440
s_waitcnt lgkmcnt(8)
v_mfma_f32_32x32x16_bf16 a[0:15], v[104:107], v[176:179], a[0:15]
ds_read_b64_tr_b16 v[104:105], v9 offset:38912
ds_read_b64_tr_b16 v[106:107], v9 offset:39424
buffer_load_dwordx4 v3, s[20:23], s55 offen offset:384 lds
v_accvgpr_read_b32 v24, a88
v_accvgpr_read_b32 v25, a89
v_accvgpr_read_b32 v26, a90
v_mfma_f32_32x32x16_bf16 a[16:31], v[108:111], v[176:179], a[16:31]
ds_read_b64_tr_b16 v[108:109], v12 offset:38912
ds_read_b64_tr_b16 v[110:111], v12 offset:39424
v_accvgpr_read_b32 v27, a91
v_accvgpr_read_b32 v28, a120
v_accvgpr_read_b32 v29, a121
s_waitcnt lgkmcnt(8)
v_mfma_f32_32x32x16_bf16 a[32:47], v[88:91], v[176:179], a[32:47]
s_waitcnt vmcnt(36)
s_barrier
ds_read_b64_tr_b16 v[88:89], v9 offset:40960
ds_read_b64_tr_b16 v[90:91], v9 offset:41472
v_accvgpr_read_b32 v30, a122
v_accvgpr_read_b32 v31, a123
v_mfma_f32_32x32x16_bf16 a[48:63], v[92:95], v[176:179], a[48:63]
ds_read_b64_tr_b16 v[92:93], v12 offset:40960
ds_read_b64_tr_b16 v[94:95], v12 offset:41472
v_max_f32 v24, 0, v24
v_max_f32 v25, 0, v25
s_add_u32 m0, s40, 81536
s_waitcnt lgkmcnt(8)
v_mfma_f32_32x32x16_bf16 a[0:15], v[96:99], v[180:183], a[0:15]
ds_read_b64_tr_b16 v[96:97], v9 offset:43008
ds_read_b64_tr_b16 v[98:99], v9 offset:43520
buffer_load_dwordx4 v3, s[20:23], s56 offen offset:384 lds
v_max_f32 v26, 0, v26
v_max_f32 v27, 0, v27
v_mfma_f32_32x32x16_bf16 a[16:31], v[100:103], v[180:183], a[16:31]
ds_read_b64_tr_b16 v[100:101], v12 offset:43008
ds_read_b64_tr_b16 v[102:103], v12 offset:43520
v_mul_f32 v24, v24, v28
v_mul_f32 v25, v25, v29
v_mul_f32 v26, v26, v30
s_waitcnt lgkmcnt(8)
v_mfma_f32_32x32x16_bf16 a[32:47], v[104:107], v[180:183], a[32:47]
ds_read_b64_tr_b16 v[104:105], v9 offset:45056
ds_read_b64_tr_b16 v[106:107], v9 offset:45568
v_mul_f32 v27, v27, v31
v_cvt_pk_bf16_f32 v24, v24, v25
v_cvt_pk_bf16_f32 v26, v26, v27
v_accvgpr_write_b32 a156, v24
v_mfma_f32_32x32x16_bf16 a[48:63], v[108:111], v[180:183], a[48:63]
ds_read_b64_tr_b16 v[108:109], v12 offset:45056
ds_read_b64_tr_b16 v[110:111], v12 offset:45568
v_accvgpr_write_b32 a157, v26
v_accvgpr_read_b32 v32, a92
s_add_u32 m0, s40, 85632
s_waitcnt lgkmcnt(8)
v_mfma_f32_32x32x16_bf16 a[0:15], v[88:91], v[184:187], a[0:15]
ds_read_b64_tr_b16 v[88:89], v9 offset:47104
ds_read_b64_tr_b16 v[90:91], v9 offset:47616
buffer_load_dwordx4 v3, s[20:23], s57 offen offset:384 lds
v_accvgpr_read_b32 v33, a93
v_accvgpr_read_b32 v34, a94
v_accvgpr_read_b32 v35, a95
v_mfma_f32_32x32x16_bf16 a[16:31], v[92:95], v[184:187], a[16:31]
ds_read_b64_tr_b16 v[92:93], v12 offset:47104
ds_read_b64_tr_b16 v[94:95], v12 offset:47616
v_accvgpr_read_b32 v36, a124
v_accvgpr_read_b32 v37, a125
s_waitcnt lgkmcnt(8)
v_mfma_f32_32x32x16_bf16 a[32:47], v[96:99], v[184:187], a[32:47]
s_waitcnt vmcnt(35)
s_barrier
ds_read_b64_tr_b16 v[96:97], v9 offset:49152
ds_read_b64_tr_b16 v[98:99], v9 offset:49664
v_accvgpr_read_b32 v38, a126
v_accvgpr_read_b32 v39, a127
v_mfma_f32_32x32x16_bf16 a[48:63], v[100:103], v[184:187], a[48:63]
ds_read_b64_tr_b16 v[100:101], v12 offset:49152
ds_read_b64_tr_b16 v[102:103], v12 offset:49664
v_max_f32 v32, 0, v32
v_max_f32 v33, 0, v33
s_add_u32 m0, s40, 89728
s_waitcnt lgkmcnt(8)
v_mfma_f32_32x32x16_bf16 a[0:15], v[104:107], v[188:191], a[0:15]
ds_read_b64_tr_b16 v[104:105], v9 offset:51200
ds_read_b64_tr_b16 v[106:107], v9 offset:51712
buffer_load_dwordx4 v3, s[20:23], s58 offen offset:384 lds
v_max_f32 v34, 0, v34
v_max_f32 v35, 0, v35
v_mul_f32 v32, v32, v36
v_mfma_f32_32x32x16_bf16 a[16:31], v[108:111], v[188:191], a[16:31]
ds_read_b64_tr_b16 v[108:109], v12 offset:51200
ds_read_b64_tr_b16 v[110:111], v12 offset:51712
v_mul_f32 v33, v33, v37
v_mul_f32 v34, v34, v38
v_mul_f32 v35, v35, v39
s_waitcnt lgkmcnt(8)
v_mfma_f32_32x32x16_bf16 a[32:47], v[88:91], v[188:191], a[32:47]
ds_read_b64_tr_b16 v[88:89], v9 offset:53248
ds_read_b64_tr_b16 v[90:91], v9 offset:53760
v_cvt_pk_bf16_f32 v32, v32, v33
v_cvt_pk_bf16_f32 v34, v34, v35
v_accvgpr_write_b32 a158, v32
v_mfma_f32_32x32x16_bf16 a[48:63], v[92:95], v[188:191], a[48:63]
ds_read_b64_tr_b16 v[92:93], v12 offset:53248
ds_read_b64_tr_b16 v[94:95], v12 offset:53760
v_accvgpr_write_b32 a159, v34
s_add_u32 m0, s40, 93824
s_waitcnt lgkmcnt(8)
v_mfma_f32_32x32x16_bf16 a[0:15], v[96:99], v[192:195], a[0:15]
ds_read_b64_tr_b16 v[96:97], v9 offset:55296
ds_read_b64_tr_b16 v[98:99], v9 offset:55808
buffer_load_dwordx4 v3, s[20:23], s59 offen offset:384 lds
s_mov_b32 s6, 98304
buffer_store_dwordx4 a[156:159], v21, s[36:39], s6 offen offset:3072 sc1
v_mfma_f32_32x32x16_bf16 a[16:31], v[100:103], v[192:195], a[16:31]
ds_read_b64_tr_b16 v[100:101], v12 offset:55296
ds_read_b64_tr_b16 v[102:103], v12 offset:55808
s_waitcnt lgkmcnt(8)
v_mfma_f32_32x32x16_bf16 a[32:47], v[104:107], v[192:195], a[32:47]
s_waitcnt vmcnt(35)
s_barrier
ds_read_b64_tr_b16 v[104:105], v9 offset:57344
ds_read_b64_tr_b16 v[106:107], v9 offset:57856
v_mfma_f32_32x32x16_bf16 a[48:63], v[108:111], v[192:195], a[48:63]
ds_read_b64_tr_b16 v[108:109], v12 offset:57344
ds_read_b64_tr_b16 v[110:111], v12 offset:57856
s_add_u32 m0, s40, 97920
s_waitcnt lgkmcnt(8)
v_mfma_f32_32x32x16_bf16 a[0:15], v[88:91], v[196:199], a[0:15]
ds_read_b64_tr_b16 v[88:89], v9 offset:59392
ds_read_b64_tr_b16 v[90:91], v9 offset:59904
buffer_load_dwordx4 v3, s[20:23], s60 offen offset:384 lds
v_mfma_f32_32x32x16_bf16 a[16:31], v[92:95], v[196:199], a[16:31]
ds_read_b64_tr_b16 v[92:93], v12 offset:59392
ds_read_b64_tr_b16 v[94:95], v12 offset:59904
s_waitcnt lgkmcnt(8)
v_mfma_f32_32x32x16_bf16 a[32:47], v[96:99], v[196:199], a[32:47]
ds_read_b64_tr_b16 v[96:97], v9 offset:61440
ds_read_b64_tr_b16 v[98:99], v9 offset:61952
v_mfma_f32_32x32x16_bf16 a[48:63], v[100:103], v[196:199], a[48:63]
ds_read_b64_tr_b16 v[100:101], v12 offset:61440
ds_read_b64_tr_b16 v[102:103], v12 offset:61952
s_add_u32 m0, s40, 102016
s_waitcnt lgkmcnt(8)
v_mfma_f32_32x32x16_bf16 a[0:15], v[104:107], v[200:203], a[0:15]
ds_read_b64_tr_b16 v[104:105], v9 offset:63488
ds_read_b64_tr_b16 v[106:107], v9 offset:64000
buffer_load_dwordx4 v3, s[20:23], s61 offen offset:384 lds
v_mfma_f32_32x32x16_bf16 a[16:31], v[108:111], v[200:203], a[16:31]
ds_read_b64_tr_b16 v[108:109], v12 offset:63488
ds_read_b64_tr_b16 v[110:111], v12 offset:64000
s_waitcnt lgkmcnt(8)
v_mfma_f32_32x32x16_bf16 a[32:47], v[88:91], v[200:203], a[32:47]
s_waitcnt vmcnt(35)
s_barrier
ds_read_b64_tr_b16 v[88:89], v8 offset:0
ds_read_b64_tr_b16 v[90:91], v8 offset:512
v_mfma_f32_32x32x16_bf16 a[48:63], v[92:95], v[200:203], a[48:63]
ds_read_b64_tr_b16 v[92:93], v11 offset:0
ds_read_b64_tr_b16 v[94:95], v11 offset:512
s_add_u32 m0, s40, 106112
s_waitcnt lgkmcnt(8)
v_mfma_f32_32x32x16_bf16 a[0:15], v[96:99], v[204:207], a[0:15]
ds_read_b64_tr_b16 v[96:97], v8 offset:2048
ds_read_b64_tr_b16 v[98:99], v8 offset:2560
buffer_load_dwordx4 v3, s[20:23], s62 offen offset:384 lds
v_mfma_f32_32x32x16_bf16 a[16:31], v[100:103], v[204:207], a[16:31]
ds_read_b64_tr_b16 v[100:101], v11 offset:2048
ds_read_b64_tr_b16 v[102:103], v11 offset:2560
s_waitcnt lgkmcnt(8)
v_mfma_f32_32x32x16_bf16 a[32:47], v[104:107], v[204:207], a[32:47]
ds_read_b64_tr_b16 v[104:105], v8 offset:4096
ds_read_b64_tr_b16 v[106:107], v8 offset:4608
v_mfma_f32_32x32x16_bf16 a[48:63], v[108:111], v[204:207], a[48:63]
ds_read_b64_tr_b16 v[108:109], v11 offset:4096
ds_read_b64_tr_b16 v[110:111], v11 offset:4608
s_add_u32 m0, s40, 110208
s_waitcnt lgkmcnt(8)
v_mfma_f32_32x32x16_bf16 a[0:15], v[88:91], v[208:211], a[0:15]
ds_read_b64_tr_b16 v[88:89], v8 offset:6144
ds_read_b64_tr_b16 v[90:91], v8 offset:6656
buffer_load_dwordx4 v3, s[20:23], s63 offen offset:384 lds
v_mfma_f32_32x32x16_bf16 a[16:31], v[92:95], v[208:211], a[16:31]
ds_read_b64_tr_b16 v[92:93], v11 offset:6144
ds_read_b64_tr_b16 v[94:95], v11 offset:6656
s_waitcnt lgkmcnt(8)
v_mfma_f32_32x32x16_bf16 a[32:47], v[96:99], v[208:211], a[32:47]
s_waitcnt vmcnt(34)
s_barrier
ds_read_b64_tr_b16 v[96:97], v8 offset:8192
ds_read_b64_tr_b16 v[98:99], v8 offset:8704
buffer_load_dword a182, v13, s[24:27], 0 offen offset:3584
v_mfma_f32_32x32x16_bf16 a[48:63], v[100:103], v[208:211], a[48:63]
ds_read_b64_tr_b16 v[100:101], v11 offset:8192
ds_read_b64_tr_b16 v[102:103], v11 offset:8704
s_add_u32 m0, s40, 114304
s_waitcnt lgkmcnt(8)
v_mfma_f32_32x32x16_bf16 a[0:15], v[104:107], v[212:215], a[0:15]
ds_read_b64_tr_b16 v[104:105], v8 offset:10240
ds_read_b64_tr_b16 v[106:107], v8 offset:10752
buffer_load_dwordx4 v3, s[20:23], s64 offen offset:384 lds
v_mfma_f32_32x32x16_bf16 a[16:31], v[108:111], v[212:215], a[16:31]
ds_read_b64_tr_b16 v[108:109], v11 offset:10240
ds_read_b64_tr_b16 v[110:111], v11 offset:10752
buffer_load_dword v19, v2, s[32:35], 0 offen sc1
s_waitcnt lgkmcnt(8)
v_mfma_f32_32x32x16_bf16 a[32:47], v[88:91], v[212:215], a[32:47]
ds_read_b64_tr_b16 v[88:89], v8 offset:12288
ds_read_b64_tr_b16 v[90:91], v8 offset:12800
v_mfma_f32_32x32x16_bf16 a[48:63], v[92:95], v[212:215], a[48:63]
ds_read_b64_tr_b16 v[92:93], v11 offset:12288
ds_read_b64_tr_b16 v[94:95], v11 offset:12800
s_add_u32 m0, s40, 118400
s_waitcnt lgkmcnt(8)
v_mfma_f32_32x32x16_bf16 a[0:15], v[96:99], v[216:219], a[0:15]
ds_read_b64_tr_b16 v[96:97], v8 offset:14336
ds_read_b64_tr_b16 v[98:99], v8 offset:14848
buffer_load_dwordx4 v3, s[20:23], s65 offen offset:384 lds
v_mfma_f32_32x32x16_bf16 a[16:31], v[100:103], v[216:219], a[16:31]
ds_read_b64_tr_b16 v[100:101], v11 offset:14336
ds_read_b64_tr_b16 v[102:103], v11 offset:14848
s_waitcnt lgkmcnt(8)
v_mfma_f32_32x32x16_bf16 a[32:47], v[104:107], v[216:219], a[32:47]
s_waitcnt vmcnt(36)
s_barrier
ds_read_b64_tr_b16 v[104:105], v8 offset:16384
ds_read_b64_tr_b16 v[106:107], v8 offset:16896
v_mfma_f32_32x32x16_bf16 a[48:63], v[108:111], v[216:219], a[48:63]
ds_read_b64_tr_b16 v[108:109], v11 offset:16384
ds_read_b64_tr_b16 v[110:111], v11 offset:16896
s_add_u32 m0, s40, 122496
s_waitcnt lgkmcnt(8)
v_mfma_f32_32x32x16_bf16 a[0:15], v[88:91], v[220:223], a[0:15]
ds_read_b64_tr_b16 v[88:89], v8 offset:18432
ds_read_b64_tr_b16 v[90:91], v8 offset:18944
buffer_load_dwordx4 v3, s[20:23], s66 offen offset:384 lds
v_mfma_f32_32x32x16_bf16 a[16:31], v[92:95], v[220:223], a[16:31]
ds_read_b64_tr_b16 v[92:93], v11 offset:18432
ds_read_b64_tr_b16 v[94:95], v11 offset:18944
s_waitcnt lgkmcnt(8)
v_mfma_f32_32x32x16_bf16 a[32:47], v[96:99], v[220:223], a[32:47]
ds_read_b64_tr_b16 v[96:97], v8 offset:20480
ds_read_b64_tr_b16 v[98:99], v8 offset:20992
v_mfma_f32_32x32x16_bf16 a[48:63], v[100:103], v[220:223], a[48:63]
ds_read_b64_tr_b16 v[100:101], v11 offset:20480
ds_read_b64_tr_b16 v[102:103], v11 offset:20992
s_add_u32 m0, s40, 126592
s_waitcnt lgkmcnt(8)
v_mfma_f32_32x32x16_bf16 a[0:15], v[104:107], v[224:227], a[0:15]
ds_read_b64_tr_b16 v[104:105], v8 offset:22528
ds_read_b64_tr_b16 v[106:107], v8 offset:23040
buffer_load_dwordx4 v3, s[20:23], s67 offen offset:384 lds
v_mfma_f32_32x32x16_bf16 a[16:31], v[108:111], v[224:227], a[16:31]
ds_read_b64_tr_b16 v[108:109], v11 offset:22528
ds_read_b64_tr_b16 v[110:111], v11 offset:23040
s_waitcnt lgkmcnt(8)
v_mfma_f32_32x32x16_bf16 a[32:47], v[88:91], v[224:227], a[32:47]
s_waitcnt vmcnt(33)
s_barrier
ds_read_b64_tr_b16 v[88:89], v8 offset:24576
ds_read_b64_tr_b16 v[90:91], v8 offset:25088
v_mfma_f32_32x32x16_bf16 a[48:63], v[92:95], v[224:227], a[48:63]
ds_read_b64_tr_b16 v[92:93], v11 offset:24576
ds_read_b64_tr_b16 v[94:95], v11 offset:25088
s_mov_b32 m0, s40
s_add_u32 s41, s68, 384
s_waitcnt lgkmcnt(8)
v_mfma_f32_32x32x16_bf16 a[0:15], v[96:99], v[228:231], a[0:15]
ds_read_b64_tr_b16 v[96:97], v8 offset:26624
ds_read_b64_tr_b16 v[98:99], v8 offset:27136
buffer_load_dwordx4 v3, s[20:23], s41 offen lds
v_mfma_f32_32x32x16_bf16 a[16:31], v[100:103], v[228:231], a[16:31]
ds_read_b64_tr_b16 v[100:101], v11 offset:26624
ds_read_b64_tr_b16 v[102:103], v11 offset:27136
s_waitcnt lgkmcnt(8)
v_mfma_f32_32x32x16_bf16 a[32:47], v[104:107], v[228:231], a[32:47]
ds_read_b64_tr_b16 v[104:105], v8 offset:28672
ds_read_b64_tr_b16 v[106:107], v8 offset:29184
v_mfma_f32_32x32x16_bf16 a[48:63], v[108:111], v[228:231], a[48:63]
ds_read_b64_tr_b16 v[108:109], v11 offset:28672
ds_read_b64_tr_b16 v[110:111], v11 offset:29184
s_add_u32 m0, s40, 3712
s_waitcnt lgkmcnt(8)
v_mfma_f32_32x32x16_bf16 a[0:15], v[88:91], v[232:235], a[0:15]
ds_read_b64_tr_b16 v[88:89], v8 offset:30720
ds_read_b64_tr_b16 v[90:91], v8 offset:31232
buffer_load_dwordx4 v3, s[20:23], s69 offen offset:384 lds
v_mfma_f32_32x32x16_bf16 a[16:31], v[92:95], v[232:235], a[16:31]
ds_read_b64_tr_b16 v[92:93], v11 offset:30720
ds_read_b64_tr_b16 v[94:95], v11 offset:31232
s_waitcnt lgkmcnt(8)
v_mfma_f32_32x32x16_bf16 a[32:47], v[96:99], v[232:235], a[32:47]
s_waitcnt vmcnt(31)
s_barrier
ds_read_b64_tr_b16 v[96:97], v8 offset:32768
ds_read_b64_tr_b16 v[98:99], v8 offset:33280
v_mfma_f32_32x32x16_bf16 a[48:63], v[100:103], v[232:235], a[48:63]
ds_read_b64_tr_b16 v[100:101], v11 offset:32768
ds_read_b64_tr_b16 v[102:103], v11 offset:33280
s_add_u32 m0, s40, 7808
s_waitcnt lgkmcnt(8)
v_mfma_f32_32x32x16_bf16 a[0:15], v[104:107], v[236:239], a[0:15]
ds_read_b64_tr_b16 v[104:105], v8 offset:34816
ds_read_b64_tr_b16 v[106:107], v8 offset:35328
buffer_load_dwordx4 v3, s[20:23], s70 offen offset:384 lds
v_mfma_f32_32x32x16_bf16 a[16:31], v[108:111], v[236:239], a[16:31]
ds_read_b64_tr_b16 v[108:109], v11 offset:34816
ds_read_b64_tr_b16 v[110:111], v11 offset:35328
s_waitcnt lgkmcnt(8)
v_mfma_f32_32x32x16_bf16 a[32:47], v[88:91], v[236:239], a[32:47]
ds_read_b64_tr_b16 v[88:89], v8 offset:36864
ds_read_b64_tr_b16 v[90:91], v8 offset:37376
v_mfma_f32_32x32x16_bf16 a[48:63], v[92:95], v[236:239], a[48:63]
ds_read_b64_tr_b16 v[92:93], v11 offset:36864
ds_read_b64_tr_b16 v[94:95], v11 offset:37376
s_add_u32 m0, s40, 11904
s_waitcnt lgkmcnt(8)
v_mfma_f32_32x32x16_bf16 a[0:15], v[96:99], v[240:243], a[0:15]
ds_read_b64_tr_b16 v[96:97], v8 offset:38912
ds_read_b64_tr_b16 v[98:99], v8 offset:39424
buffer_load_dwordx4 v3, s[20:23], s71 offen offset:384 lds
v_mfma_f32_32x32x16_bf16 a[16:31], v[100:103], v[240:243], a[16:31]
ds_read_b64_tr_b16 v[100:101], v11 offset:38912
ds_read_b64_tr_b16 v[102:103], v11 offset:39424
s_waitcnt lgkmcnt(8)
v_mfma_f32_32x32x16_bf16 a[32:47], v[104:107], v[240:243], a[32:47]
s_waitcnt vmcnt(30)
s_barrier
ds_read_b64_tr_b16 v[104:105], v8 offset:40960
ds_read_b64_tr_b16 v[106:107], v8 offset:41472
v_mfma_f32_32x32x16_bf16 a[48:63], v[108:111], v[240:243], a[48:63]
ds_read_b64_tr_b16 v[108:109], v11 offset:40960
ds_read_b64_tr_b16 v[110:111], v11 offset:41472
s_add_u32 m0, s40, 16000
s_waitcnt lgkmcnt(8)
v_mfma_f32_32x32x16_bf16 a[0:15], v[88:91], v[244:247], a[0:15]
ds_read_b64_tr_b16 v[88:89], v8 offset:43008
ds_read_b64_tr_b16 v[90:91], v8 offset:43520
buffer_load_dwordx4 v3, s[20:23], s72 offen offset:384 lds
v_mfma_f32_32x32x16_bf16 a[16:31], v[92:95], v[244:247], a[16:31]
ds_read_b64_tr_b16 v[92:93], v11 offset:43008
ds_read_b64_tr_b16 v[94:95], v11 offset:43520
s_waitcnt lgkmcnt(8)
v_mfma_f32_32x32x16_bf16 a[32:47], v[96:99], v[244:247], a[32:47]
ds_read_b64_tr_b16 v[96:97], v8 offset:45056
ds_read_b64_tr_b16 v[98:99], v8 offset:45568
v_mfma_f32_32x32x16_bf16 a[48:63], v[100:103], v[244:247], a[48:63]
ds_read_b64_tr_b16 v[100:101], v11 offset:45056
ds_read_b64_tr_b16 v[102:103], v11 offset:45568
s_add_u32 m0, s40, 20096
s_waitcnt lgkmcnt(8)
v_mfma_f32_32x32x16_bf16 a[0:15], v[104:107], v[248:251], a[0:15]
ds_read_b64_tr_b16 v[104:105], v8 offset:47104
ds_read_b64_tr_b16 v[106:107], v8 offset:47616
buffer_load_dwordx4 v3, s[20:23], s73 offen offset:384 lds
v_mfma_f32_32x32x16_bf16 a[16:31], v[108:111], v[248:251], a[16:31]
ds_read_b64_tr_b16 v[108:109], v11 offset:47104
ds_read_b64_tr_b16 v[110:111], v11 offset:47616
s_waitcnt lgkmcnt(8)
v_mfma_f32_32x32x16_bf16 a[32:47], v[88:91], v[248:251], a[32:47]
s_waitcnt vmcnt(30)
s_barrier
ds_read_b64_tr_b16 v[88:89], v8 offset:49152
ds_read_b64_tr_b16 v[90:91], v8 offset:49664
v_mfma_f32_32x32x16_bf16 a[48:63], v[92:95], v[248:251], a[48:63]
ds_read_b64_tr_b16 v[92:93], v11 offset:49152
ds_read_b64_tr_b16 v[94:95], v11 offset:49664
s_add_u32 m0, s40, 24192
s_waitcnt lgkmcnt(8)
v_mfma_f32_32x32x16_bf16 a[0:15], v[96:99], v[252:255], a[0:15]
ds_read_b64_tr_b16 v[96:97], v8 offset:51200
ds_read_b64_tr_b16 v[98:99], v8 offset:51712
buffer_load_dwordx4 v3, s[20:23], s74 offen offset:384 lds
v_mfma_f32_32x32x16_bf16 a[16:31], v[100:103], v[252:255], a[16:31]
ds_read_b64_tr_b16 v[100:101], v11 offset:51200
ds_read_b64_tr_b16 v[102:103], v11 offset:51712
s_waitcnt vmcnt(10)
v_cmp_ne_u32 vcc, s100, v19
s_cmp_lg_u64 vcc, 0
s_cbranch_scc1 L_slow0
L_back0:
s_waitcnt lgkmcnt(8)
v_mfma_f32_32x32x16_bf16 a[32:47], v[104:107], v[252:255], a[32:47]
ds_read_b64_tr_b16 v[104:105], v8 offset:53248
ds_read_b64_tr_b16 v[106:107], v8 offset:53760
v_mfma_f32_32x32x16_bf16 a[48:63], v[108:111], v[252:255], a[48:63]
ds_read_b64_tr_b16 v[108:109], v11 offset:53248
ds_read_b64_tr_b16 v[110:111], v11 offset:53760
s_add_u32 m0, s40, 28288
s_waitcnt lgkmcnt(8)
v_mfma_f32_32x32x16_bf16 a[64:79], v[88:91], v[112:115], 0
ds_read_b64_tr_b16 v[88:89], v8 offset:55296
ds_read_b64_tr_b16 v[90:91], v8 offset:55808
buffer_load_dwordx4 v3, s[20:23], s75 offen offset:384 lds
v_mfma_f32_32x32x16_bf16 a[80:95], v[92:95], v[112:115], 0
ds_read_b64_tr_b16 v[92:93], v11 offset:55296
ds_read_b64_tr_b16 v[94:95], v11 offset:55808
s_waitcnt lgkmcnt(8)
v_mfma_f32_32x32x16_bf16 a[96:111], v[96:99], v[112:115], 0
s_barrier
ds_read_b64_tr_b16 v[96:97], v8 offset:57344
ds_read_b64_tr_b16 v[98:99], v8 offset:57856
s_xor_b32 s7, s101, 0
buffer_load_dwordx3 v[46:48], v22, s[36:39], s7 offen sc1
v_accvgpr_read_b32 v24, a0
v_mfma_f32_32x32x16_bf16 a[112:127], v[100:103], v[112:115], 0
ds_read_b64_tr_b16 v[100:101], v11 offset:57344
ds_read_b64_tr_b16 v[102:103], v11 offset:57856
v_accvgpr_read_b32 v25, a1
v_accvgpr_read_b32 v26, a2
v_accvgpr_read_b32 v27, a3
s_add_u32 m0, s40, 32384
s_waitcnt lgkmcnt(8)
v_mfma_f32_32x32x16_bf16 a[64:79], v[104:107], v[116:119], a[64:79]
ds_read_b64_tr_b16 v[104:105], v8 offset:59392
ds_read_b64_tr_b16 v[106:107], v8 offset:59904
buffer_load_dwordx4 v3, s[20:23], s76 offen offset:384 lds
s_xor_b32 s7, s101, 8192
buffer_load_dwordx3 v[50:52], v22, s[36:39], s7 offen sc1
v_accvgpr_read_b32 v28, a32
v_mfma_f32_32x32x16_bf16 a[80:95], v[108:111], v[116:119], a[80:95]
ds_read_b64_tr_b16 v[108:109], v11 offset:59392
ds_read_b64_tr_b16 v[110:111], v11 offset:59904
v_accvgpr_read_b32 v29, a33
v_accvgpr_read_b32 v30, a34
v_accvgpr_read_b32 v31, a35
v_max_f32 v24, 0, v24
s_waitcnt lgkmcnt(8)
v_mfma_f32_32x32x16_bf16 a[96:111], v[88:91], v[116:119], a[96:111]
ds_read_b64_tr_b16 v[88:89], v8 offset:61440
ds_read_b64_tr_b16 v[90:91], v8 offset:61952
s_xor_b32 s7, s101, 16384
buffer_load_dwordx3 v[54:56], v22, s[36:39], s7 offen sc1
v_max_f32 v25, 0, v25
v_max_f32 v26, 0, v26
v_mfma_f32_32x32x16_bf16 a[112:127], v[92:95], v[116:119], a[112:127]
ds_read_b64_tr_b16 v[92:93], v11 offset:61440
ds_read_b64_tr_b16 v[94:95], v11 offset:61952
v_max_f32 v27, 0, v27
v_mul_f32 v24, v24, v28
v_mul_f32 v25, v25, v29
s_add_u32 m0, s40, 36480
s_waitcnt lgkmcnt(8)
v_mfma_f32_32x32x16_bf16 a[64:79], v[96:99], v[120:123], a[64:79]
ds_read_b64_tr_b16 v[96:97], v8 offset:63488
ds_read_b64_tr_b16 v[98:99], v8 offset:64000
buffer_load_dwordx4 v3, s[20:23], s77 offen offset:384 lds
s_xor_b32 s7, s101, 24576
buffer_load_dwordx3 v[58:60], v22, s[36:39], s7 offen sc1
v_mul_f32 v26, v26, v30
v_mfma_f32_32x32x16_bf16 a[80:95], v[100:103], v[120:123], a[80:95]
ds_read_b64_tr_b16 v[100:101], v11 offset:63488
ds_read_b64_tr_b16 v[102:103], v11 offset:64000
v_mul_f32 v27, v27, v31
v_cvt_pk_bf16_f32 v24, v24, v25
v_cvt_pk_bf16_f32 v26, v26, v27
v_accvgpr_write_b32 a160, v24
s_waitcnt lgkmcnt(8)
v_mfma_f32_32x32x16_bf16 a[96:111], v[104:107], v[120:123], a[96:111]
s_barrier
ds_read_b64_tr_b16 v[104:105], v9 offset:0
ds_read_b64_tr_b16 v[106:107], v9 offset:512
s_xor_b32 s7, s101, 32768
buffer_load_dwordx3 v[62:64], v22, s[36:39], s7 offen sc1
v_accvgpr_write_b32 a161, v26
v_mfma_f32_32x32x16_bf16 a[112:127], v[108:111], v[120:123], a[112:127]
ds_read_b64_tr_b16 v[108:109], v12 offset:0
ds_read_b64_tr_b16 v[110:111], v12 offset:512
v_accvgpr_read_b32 v32, a4
v_accvgpr_read_b32 v33, a5
v_accvgpr_read_b32 v34, a6
s_add_u32 m0, s40, 40576
s_waitcnt lgkmcnt(8)
v_mfma_f32_32x32x16_bf16 a[64:79], v[88:91], v[124:127], a[64:79]
ds_read_b64_tr_b16 v[88:89], v9 offset:2048
ds_read_b64_tr_b16 v[90:91], v9 offset:2560
buffer_load_dwordx4 v3, s[20:23], s78 offen offset:384 lds
s_xor_b32 s7, s101, 40960
buffer_load_dwordx3 v[66:68], v22, s[36:39], s7 offen sc1
v_accvgpr_read_b32 v35, a7
v_mfma_f32_32x32x16_bf16 a[80:95], v[92:95], v[124:127], a[80:95]
ds_read_b64_tr_b16 v[92:93], v12 offset:2048
ds_read_b64_tr_b16 v[94:95], v12 offset:2560
v_accvgpr_read_b32 v36, a36
v_accvgpr_read_b32 v37, a37
v_accvgpr_read_b32 v38, a38
v_accvgpr_read_b32 v39, a39
s_waitcnt lgkmcnt(8)
v_mfma_f32_32x32x16_bf16 a[96:111], v[96:99], v[124:127], a[96:111]
ds_read_b64_tr_b16 v[96:97], v9 offset:4096
ds_read_b64_tr_b16 v[98:99], v9 offset:4608
s_xor_b32 s7, s101, 49152
buffer_load_dwordx3 v[70:72], v22, s[36:39], s7 offen sc1
v_max_f32 v32, 0, v32
v_max_f32 v33, 0, v33
v_mfma_f32_32x32x16_bf16 a[112:127], v[100:103], v[124:127], a[112:127]
ds_read_b64_tr_b16 v[100:101], v12 offset:4096
ds_read_b64_tr_b16 v[102:103], v12 offset:4608
v_max_f32 v34, 0, v34
v_max_f32 v35, 0, v35
v_mul_f32 v32, v32, v36
s_add_u32 m0, s40, 44672
s_waitcnt lgkmcnt(8)
v_mfma_f32_32x32x16_bf16 a[64:79], v[104:107], v[128:131], a[64:79]
ds_read_b64_tr_b16 v[104:105], v9 offset:6144
ds_read_b64_tr_b16 v[106:107], v9 offset:6656
buffer_load_dwordx4 v3, s[20:23], s79 offen offset:384 lds
s_xor_b32 s7, s101, 57344
buffer_load_dwordx3 v[74:76], v22, s[36:39], s7 offen sc1
v_mul_f32 v33, v33, v37
v_mfma_f32_32x32x16_bf16 a[80:95], v[108:111], v[128:131], a[80:95]
ds_read_b64_tr_b16 v[108:109], v12 offset:6144
ds_read_b64_tr_b16 v[110:111], v12 offset:6656
v_mul_f32 v34, v34, v38
v_mul_f32 v35, v35, v39
v_cvt_pk_bf16_f32 v32, v32, v33
v_cvt_pk_bf16_f32 v34, v34, v35
s_waitcnt lgkmcnt(8)
v_mfma_f32_32x32x16_bf16 a[96:111], v[88:91], v[128:131], a[96:111]
s_barrier
ds_read_b64_tr_b16 v[88:89], v9 offset:8192
ds_read_b64_tr_b16 v[90:91], v9 offset:8704
s_xor_b32 s7, s101, 65536
buffer_load_dwordx3 v[78:80], v22, s[36:39], s7 offen sc1
v_accvgpr_write_b32 a162, v32
v_mfma_f32_32x32x16_bf16 a[112:127], v[92:95], v[128:131], a[112:127]
ds_read_b64_tr_b16 v[92:93], v12 offset:8192
ds_read_b64_tr_b16 v[94:95], v12 offset:8704
v_accvgpr_write_b32 a163, v34
s_mov_b32 s6, 114688
buffer_store_dwordx4 a[160:163], v21, s[36:39], s6 offen offset:0 sc1
s_add_u32 m0, s40, 48768
s_waitcnt lgkmcnt(8)
v_mfma_f32_32x32x16_bf16 a[64:79], v[96:99], v[132:135], a[64:79]
ds_read_b64_tr_b16 v[96:97], v9 offset:10240
ds_read_b64_tr_b16 v[98:99], v9 offset:10752
buffer_load_dwordx4 v3, s[20:23], s80 offen offset:384 lds
s_xor_b32 s7, s101, 73728
buffer_load_dwordx3 v[82:84], v22, s[36:39], s7 offen sc1
v_accvgpr_read_b32 v24, a8
v_mfma_f32_32x32x16_bf16 a[80:95], v[100:103], v[132:135], a[80:95]
ds_read_b64_tr_b16 v[100:101], v12 offset:10240
ds_read_b64_tr_b16 v[102:103], v12 offset:10752
v_accvgpr_read_b32 v25, a9
v_accvgpr_read_b32 v26, a10
v_accvgpr_read_b32 v27, a11
v_accvgpr_read_b32 v28, a40
s_waitcnt lgkmcnt(8)
v_mfma_f32_32x32x16_bf16 a[96:111], v[104:107], v[132:135], a[96:111]
ds_read_b64_tr_b16 v[104:105], v9 offset:12288
ds_read_b64_tr_b16 v[106:107], v9 offset:12800
s_xor_b32 s7, s101, 81920
buffer_load_dwordx3 a[192:194], v22, s[36:39], s7 offen sc1
v_accvgpr_read_b32 v29, a41
v_accvgpr_read_b32 v30, a42
v_mfma_f32_32x32x16_bf16 a[112:127], v[108:111], v[132:135], a[112:127]
ds_read_b64_tr_b16 v[108:109], v12 offset:12288
ds_read_b64_tr_b16 v[110:111], v12 offset:12800
v_accvgpr_read_b32 v31, a43
v_max_f32 v24, 0, v24
v_max_f32 v25, 0, v25
s_add_u32 m0, s40, 52864
s_waitcnt lgkmcnt(8)
v_mfma_f32_32x32x16_bf16 a[64:79], v[88:91], v[136:139], a[64:79]
ds_read_b64_tr_b16 v[88:89], v9 offset:14336
ds_read_b64_tr_b16 v[90:91], v9 offset:14848
buffer_load_dwordx4 v3, s[20:23], s81 offen offset:384 lds
s_xor_b32 s7, s101, 90112
buffer_load_dwordx3 a[196:198], v22, s[36:39], s7 offen sc1
v_max_f32 v26, 0, v26
v_mfma_f32_32x32x16_bf16 a[80:95], v[92:95], v[136:139], a[80:95]
ds_read_b64_tr_b16 v[92:93], v12 offset:14336
ds_read_b64_tr_b16 v[94:95], v12 offset:14848
v_max_f32 v27, 0, v27
v_mul_f32 v24, v24, v28
v_mul_f32 v25, v25, v29
v_mul_f32 v26, v26, v30
s_waitcnt lgkmcnt(8)
v_mfma_f32_32x32x16_bf16 a[96:111], v[96:99], v[136:139], a[96:111]
s_barrier
ds_read_b64_tr_b16 v[96:97], v9 offset:16384
ds_read_b64_tr_b16 v[98:99], v9 offset:16896
s_xor_b32 s7, s101, 98304
buffer_load_dwordx3 a[200:202], v22, s[36:39], s7 offen sc1
v_mul_f32 v27, v27, v31
v_mfma_f32_32x32x16_bf16 a[112:127], v[100:103], v[136:139], a[112:127]
ds_read_b64_tr_b16 v[100:101], v12 offset:16384
ds_read_b64_tr_b16 v[102:103], v12 offset:16896
v_cvt_pk_bf16_f32 v24, v24, v25
v_cvt_pk_bf16_f32 v26, v26, v27
v_accvgpr_write_b32 a164, v24
s_add_u32 m0, s40, 56960
s_waitcnt lgkmcnt(8)
v_mfma_f32_32x32x16_bf16 a[64:79], v[104:107], v[140:143], a[64:79]
ds_read_b64_tr_b16 v[104:105], v9 offset:18432
ds_read_b64_tr_b16 v[106:107], v9 offset:18944
buffer_load_dwordx4 v3, s[20:23], s82 offen offset:384 lds
s_xor_b32 s7, s101, 106496
buffer_load_dwordx3 a[204:206], v22, s[36:39], s7 offen sc1
v_accvgpr_write_b32 a165, v26
v_mfma_f32_32x32x16_bf16 a[80:95], v[108:111], v[140:143], a[80:95]
ds_read_b64_tr_b16 v[108:109], v12 offset:18432
ds_read_b64_tr_b16 v[110:111], v12 offset:18944
v_accvgpr_read_b32 v32, a12
v_accvgpr_read_b32 v33, a13
v_accvgpr_read_b32 v34, a14
v_accvgpr_read_b32 v35, a15
s_waitcnt lgkmcnt(8)
v_mfma_f32_32x32x16_bf16 a[96:111], v[88:91], v[140:143], a[96:111]
ds_read_b64_tr_b16 v[88:89], v9 offset:20480
ds_read_b64_tr_b16 v[90:91], v9 offset:20992
s_xor_b32 s7, s101, 114688
buffer_load_dwordx3 a[208:210], v22, s[36:39], s7 offen sc1
v_accvgpr_read_b32 v36, a44
v_accvgpr_read_b32 v37, a45
v_mfma_f32_32x32x16_bf16 a[112:127], v[92:95], v[140:143], a[112:127]
ds_read_b64_tr_b16 v[92:93], v12 offset:20480
ds_read_b64_tr_b16 v[94:95], v12 offset:20992
v_accvgpr_read_b32 v38, a46
v_accvgpr_read_b32 v39, a47
v_max_f32 v32, 0, v32
s_add_u32 m0, s40, 61056
s_waitcnt lgkmcnt(8)
v_mfma_f32_32x32x16_bf16 a[64:79], v[96:99], v[144:147], a[64:79]
ds_read_b64_tr_b16 v[96:97], v9 offset:22528
ds_read_b64_tr_b16 v[98:99], v9 offset:23040
buffer_load_dwordx4 v3, s[20:23], s83 offen offset:384 lds
s_xor_b32 s7, s101, 122880
buffer_load_dwordx3 a[212:214], v22, s[36:39], s7 offen sc1
v_max_f32 v33, 0, v33
v_mfma_f32_32x32x16_bf16 a[80:95], v[100:103], v[144:147], a[80:95]
ds_read_b64_tr_b16 v[100:101], v12 offset:22528
ds_read_b64_tr_b16 v[102:103], v12 offset:23040
v_max_f32 v34, 0, v34
v_max_f32 v35, 0, v35
v_mul_f32 v32, v32, v36
v_mul_f32 v33, v33, v37
s_waitcnt lgkmcnt(8)
v_mfma_f32_32x32x16_bf16 a[96:111], v[104:107], v[144:147], a[96:111]
s_barrier
ds_read_b64_tr_b16 v[104:105], v9 offset:24576
ds_read_b64_tr_b16 v[106:107], v9 offset:25088
v_mul_f32 v34, v34, v38
v_mul_f32 v35, v35, v39
v_cvt_pk_bf16_f32 v32, v32, v33
v_mfma_f32_32x32x16_bf16 a[112:127], v[108:111], v[144:147], a[112:127]
ds_read_b64_tr_b16 v[108:109], v12 offset:24576
ds_read_b64_tr_b16 v[110:111], v12 offset:25088
v_cvt_pk_bf16_f32 v34, v34, v35
v_accvgpr_write_b32 a166, v32
v_accvgpr_write_b32 a167, v34
s_add_u32 m0, s40, 65536
s_waitcnt lgkmcnt(8)
v_mfma_f32_32x32x16_bf16 a[64:79], v[88:91], v[148:151], a[64:79]
ds_read_b64_tr_b16 v[88:89], v9 offset:26624
ds_read_b64_tr_b16 v[90:91], v9 offset:27136
buffer_load_dwordx4 v4, s[20:23], s48 offen offset:0 lds
s_and_b32 s7, s4, 1
s_lshl_b32 s47, s7, 9
s_add_u32 s47, s47, 128
v_mfma_f32_32x32x16_bf16 a[80:95], v[92:95], v[148:151], a[80:95]
ds_read_b64_tr_b16 v[92:93], v12 offset:26624
ds_read_b64_tr_b16 v[94:95], v12 offset:27136
v_add_u32 v2, s47, v5
v_add_u32 v3, s47, v6
v_add_u32 v10, s47, v7
s_lshl_b32 s7, s7, 1
s_waitcnt lgkmcnt(8)
v_mfma_f32_32x32x16_bf16 a[96:111], v[96:99], v[148:151], a[96:111]
ds_read_b64_tr_b16 v[96:97], v9 offset:28672
ds_read_b64_tr_b16 v[98:99], v9 offset:29184
s_sub_u32 s7, 1, s7
s_mul_i32 s47, s7, 368640
v_add_u32 v13, s47, v2
s_mul_i32 s47, s7, 36864
v_mfma_f32_32x32x16_bf16 a[112:127], v[100:103], v[148:151], a[112:127]
ds_read_b64_tr_b16 v[100:101], v12 offset:28672
ds_read_b64_tr_b16 v[102:103], v12 offset:29184
v_add_u32 v16, s47, v3
s_mul_i32 s47, s7, 41472
v_add_u32 v19, s47, v10
s_add_u32 m0, s40, 69632
s_waitcnt lgkmcnt(8)
v_mfma_f32_32x32x16_bf16 a[64:79], v[104:107], v[152:155], a[64:79]
ds_read_b64_tr_b16 v[104:105], v9 offset:30720
ds_read_b64_tr_b16 v[106:107], v9 offset:31232
buffer_load_dwordx4 v4, s[20:23], s50 offen offset:0 lds
s_mov_b32 s6, 114688
buffer_store_dwordx4 a[164:167], v21, s[36:39], s6 offen offset:1024 sc1
v_accvgpr_read_b32 v24, a16
v_mfma_f32_32x32x16_bf16 a[80:95], v[108:111], v[152:155], a[80:95]
ds_read_b64_tr_b16 v[108:109], v12 offset:30720
ds_read_b64_tr_b16 v[110:111], v12 offset:31232
v_accvgpr_read_b32 v25, a17
v_accvgpr_read_b32 v26, a18
v_accvgpr_read_b32 v27, a19
v_accvgpr_read_b32 v28, a48
s_waitcnt lgkmcnt(8)
v_mfma_f32_32x32x16_bf16 a[96:111], v[88:91], v[152:155], a[96:111]
s_barrier
ds_read_b64_tr_b16 v[88:89], v9 offset:32768
ds_read_b64_tr_b16 v[90:91], v9 offset:33280
v_accvgpr_read_b32 v29, a49
v_accvgpr_read_b32 v30, a50
v_accvgpr_read_b32 v31, a51
v_mfma_f32_32x32x16_bf16 a[112:127], v[92:95], v[152:155], a[112:127]
ds_read_b64_tr_b16 v[92:93], v12 offset:32768
ds_read_b64_tr_b16 v[94:95], v12 offset:33280
v_max_f32 v24, 0, v24
v_max_f32 v25, 0, v25
v_max_f32 v26, 0, v26
s_add_u32 m0, s40, 73728
s_waitcnt lgkmcnt(8)
v_mfma_f32_32x32x16_bf16 a[64:79], v[96:99], v[156:159], a[64:79]
ds_read_b64_tr_b16 v[96:97], v9 offset:34816
ds_read_b64_tr_b16 v[98:99], v9 offset:35328
buffer_load_dwordx4 v4, s[20:23], s52 offen offset:0 lds
v_max_f32 v27, 0, v27
v_mul_f32 v24, v24, v28
v_mul_f32 v25, v25, v29
v_mfma_f32_32x32x16_bf16 a[80:95], v[100:103], v[156:159], a[80:95]
ds_read_b64_tr_b16 v[100:101], v12 offset:34816
ds_read_b64_tr_b16 v[102:103], v12 offset:35328
v_mul_f32 v26, v26, v30
v_mul_f32 v27, v27, v31
v_cvt_pk_bf16_f32 v24, v24, v25
v_cvt_pk_bf16_f32 v26, v26, v27
s_waitcnt lgkmcnt(8)
v_mfma_f32_32x32x16_bf16 a[96:111], v[104:107], v[156:159], a[96:111]
ds_read_b64_tr_b16 v[104:105], v9 offset:36864
ds_read_b64_tr_b16 v[106:107], v9 offset:37376
v_accvgpr_write_b32 a168, v24
v_accvgpr_write_b32 a169, v26
v_accvgpr_read_b32 v32, a20
v_accvgpr_read_b32 v33, a21
v_mfma_f32_32x32x16_bf16 a[112:127], v[108:111], v[156:159], a[112:127]
ds_read_b64_tr_b16 v[108:109], v12 offset:36864
ds_read_b64_tr_b16 v[110:111], v12 offset:37376
v_accvgpr_read_b32 v34, a22
v_accvgpr_read_b32 v35, a23
v_accvgpr_read_b32 v36, a52
s_add_u32 m0, s40, 77824
s_waitcnt lgkmcnt(8)
v_mfma_f32_32x32x16_bf16 a[64:79], v[88:91], v[160:163], a[64:79]
ds_read_b64_tr_b16 v[88:89], v9 offset:38912
ds_read_b64_tr_b16 v[90:91], v9 offset:39424
buffer_load_dwordx4 v4, s[20:23], s54 offen offset:0 lds
v_accvgpr_read_b32 v37, a53
v_accvgpr_read_b32 v38, a54
v_accvgpr_read_b32 v39, a55
v_mfma_f32_32x32x16_bf16 a[80:95], v[92:95], v[160:163], a[80:95]
ds_read_b64_tr_b16 v[92:93], v12 offset:38912
ds_read_b64_tr_b16 v[94:95], v12 offset:39424
v_max_f32 v32, 0, v32
v_max_f32 v33, 0, v33
v_max_f32 v34, 0, v34
v_max_f32 v35, 0, v35
s_waitcnt lgkmcnt(8)
v_mfma_f32_32x32x16_bf16 a[96:111], v[96:99], v[160:163], a[96:111]
s_barrier
ds_read_b64_tr_b16 v[96:97], v9 offset:40960
ds_read_b64_tr_b16 v[98:99], v9 offset:41472
v_mul_f32 v32, v32, v36
v_mul_f32 v33, v33, v37
v_mul_f32 v34, v34, v38
v_mfma_f32_32x32x16_bf16 a[112:127], v[100:103], v[160:163], a[112:127]
ds_read_b64_tr_b16 v[100:101], v12 offset:40960
ds_read_b64_tr_b16 v[102:103], v12 offset:41472
v_mul_f32 v35, v35, v39
v_cvt_pk_bf16_f32 v32, v32, v33
v_cvt_pk_bf16_f32 v34, v34, v35
s_add_u32 m0, s40, 81920
s_waitcnt lgkmcnt(8)
v_mfma_f32_32x32x16_bf16 a[64:79], v[104:107], v[164:167], a[64:79]
ds_read_b64_tr_b16 v[104:105], v9 offset:43008
ds_read_b64_tr_b16 v[106:107], v9 offset:43520
buffer_load_dwordx4 v4, s[20:23], s56 offen offset:0 lds
v_accvgpr_write_b32 a170, v32
v_accvgpr_write_b32 a171, v34
v_mfma_f32_32x32x16_bf16 a[80:95], v[108:111], v[164:167], a[80:95]
ds_read_b64_tr_b16 v[108:109], v12 offset:43008
ds_read_b64_tr_b16 v[110:111], v12 offset:43520
s_mov_b32 s6, 114688
buffer_store_dwordx4 a[168:171], v21, s[36:39], s6 offen offset:2048 sc1
v_accvgpr_read_b32 v24, a24
v_accvgpr_read_b32 v25, a25
s_waitcnt lgkmcnt(8)
v_mfma_f32_32x32x16_bf16 a[96:111], v[88:91], v[164:167], a[96:111]
ds_read_b64_tr_b16 v[88:89], v9 offset:45056
ds_read_b64_tr_b16 v[90:91], v9 offset:45568
s_mov_b32 s12, 0x3f80
s_mov_b32 s13, 0x3f800000
s_waitcnt vmcnt(31)
v_dot2_f32_bf16 v40, v46, s12, 0
v_dot2_f32_bf16 v41, v46, s13, 0
v_mfma_f32_32x32x16_bf16 a[112:127], v[92:95], v[164:167], a[112:127]
ds_read_b64_tr_b16 v[92:93], v12 offset:45056
ds_read_b64_tr_b16 v[94:95], v12 offset:45568
v_dot2_f32_bf16 v42, v47, s12, 0
v_dot2_f32_bf16 v43, v47, s13, 0
v_dot2_f32_bf16 v44, v48, s12, 0
s_add_u32 m0, s40, 86016
s_waitcnt lgkmcnt(8)
v_mfma_f32_32x32x16_bf16 a[64:79], v[96:99], v[168:171], a[64:79]
ds_read_b64_tr_b16 v[96:97], v9 offset:47104
ds_read_b64_tr_b16 v[98:99], v9 offset:47616
buffer_load_dwordx4 v4, s[20:23], s58 offen offset:0 lds
v_dot2_f32_bf16 v45, v48, s13, 0
s_waitcnt vmcnt(30)
v_dot2_f32_bf16 v40, v50, s12, v40
v_dot2_f32_bf16 v41, v50, s13, v41
v_mfma_f32_32x32x16_bf16 a[80:95], v[100:103], v[168:171], a[80:95]
ds_read_b64_tr_b16 v[100:101], v12 offset:47104
ds_read_b64_tr_b16 v[102:103], v12 offset:47616
v_dot2_f32_bf16 v42, v51, s12, v42
v_dot2_f32_bf16 v43, v51, s13, v43
v_dot2_f32_bf16 v44, v52, s12, v44
v_dot2_f32_bf16 v45, v52, s13, v45
s_waitcnt lgkmcnt(8)
v_mfma_f32_32x32x16_bf16 a[96:111], v[104:107], v[168:171], a[96:111]
s_barrier
ds_read_b64_tr_b16 v[104:105], v9 offset:49152
ds_read_b64_tr_b16 v[106:107], v9 offset:49664
s_waitcnt vmcnt(29)
v_dot2_f32_bf16 v40, v54, s12, v40
v_dot2_f32_bf16 v41, v54, s13, v41
v_dot2_f32_bf16 v42, v55, s12, v42
v_mfma_f32_32x32x16_bf16 a[112:127], v[108:111], v[168:171], a[112:127]
ds_read_b64_tr_b16 v[108:109], v12 offset:49152
ds_read_b64_tr_b16 v[110:111], v12 offset:49664
v_dot2_f32_bf16 v43, v55, s13, v43
v_dot2_f32_bf16 v44, v56, s12, v44
v_dot2_f32_bf16 v45, v56, s13, v45
s_add_u32 m0, s40, 90112
s_waitcnt lgkmcnt(8)
v_mfma_f32_32x32x16_bf16 a[64:79], v[88:91], v[172:175], a[64:79]
ds_read_b64_tr_b16 v[88:89], v9 offset:51200
ds_read_b64_tr_b16 v[90:91], v9 offset:51712
buffer_load_dwordx4 v4, s[20:23], s60 offen offset:0 lds
s_waitcnt vmcnt(28)
v_dot2_f32_bf16 v40, v58, s12, v40
v_dot2_f32_bf16 v41, v58, s13, v41
v_dot2_f32_bf16 v42, v59, s12, v42
v_mfma_f32_32x32x16_bf16 a[80:95], v[92:95], v[172:175], a[80:95]
ds_read_b64_tr_b16 v[92:93], v12 offset:51200
ds_read_b64_tr_b16 v[94:95], v12 offset:51712
v_dot2_f32_bf16 v43, v59, s13, v43
v_dot2_f32_bf16 v44, v60, s12, v44
v_dot2_f32_bf16 v45, v60, s13, v45
s_waitcnt vmcnt(27)
v_dot2_f32_bf16 v40, v62, s12, v40
s_waitcnt lgkmcnt(8)
v_mfma_f32_32x32x16_bf16 a[96:111], v[96:99], v[172:175], a[96:111]
ds_read_b64_tr_b16 v[96:97], v9 offset:53248
ds_read_b64_tr_b16 v[98:99], v9 offset:53760
v_dot2_f32_bf16 v41, v62, s13, v41
v_dot2_f32_bf16 v42, v63, s12, v42
v_dot2_f32_bf16 v43, v63, s13, v43
v_dot2_f32_bf16 v44, v64, s12, v44
v_mfma_f32_32x32x16_bf16 a[112:127], v[100:103], v[172:175], a[112:127]
ds_read_b64_tr_b16 v[100:101], v12 offset:53248
ds_read_b64_tr_b16 v[102:103], v12 offset:53760
v_dot2_f32_bf16 v45, v64, s13, v45
s_waitcnt vmcnt(25)
v_dot2_f32_bf16 v40, v66, s12, v40
v_dot2_f32_bf16 v41, v66, s13, v41
s_add_u32 m0, s40, 94208
s_waitcnt lgkmcnt(8)
v_mfma_f32_32x32x16_bf16 a[64:79], v[104:107], v[176:179], a[64:79]
ds_read_b64_tr_b16 v[104:105], v9 offset:55296
ds_read_b64_tr_b16 v[106:107], v9 offset:55808
buffer_load_dwordx4 v4, s[20:23], s62 offen offset:0 lds
v_dot2_f32_bf16 v42, v67, s12, v42
v_dot2_f32_bf16 v43, v67, s13, v43
v_dot2_f32_bf16 v44, v68, s12, v44
v_mfma_f32_32x32x16_bf16 a[80:95], v[108:111], v[176:179], a[80:95]
ds_read_b64_tr_b16 v[108:109], v12 offset:55296
ds_read_b64_tr_b16 v[110:111], v12 offset:55808
v_dot2_f32_bf16 v45, v68, s13, v45
s_waitcnt vmcnt(25)
v_dot2_f32_bf16 v40, v70, s12, v40
v_dot2_f32_bf16 v41, v70, s13, v41
v_dot2_f32_bf16 v42, v71, s12, v42
s_waitcnt lgkmcnt(8)
v_mfma_f32_32x32x16_bf16 a[96:111], v[88:91], v[176:179], a[96:111]
s_barrier
ds_read_b64_tr_b16 v[88:89], v9 offset:57344
ds_read_b64_tr_b16 v[90:91], v9 offset:57856
v_dot2_f32_bf16 v43, v71, s13, v43
v_dot2_f32_bf16 v44, v72, s12, v44
v_dot2_f32_bf16 v45, v72, s13, v45
v_mfma_f32_32x32x16_bf16 a[112:127], v[92:95], v[176:179], a[112:127]
ds_read_b64_tr_b16 v[92:93], v12 offset:57344
ds_read_b64_tr_b16 v[94:95], v12 offset:57856
s_waitcnt vmcnt(23)
v_dot2_f32_bf16 v40, v74, s12, v40
v_dot2_f32_bf16 v41, v74, s13, v41
v_dot2_f32_bf16 v42, v75, s12, v42
s_add_u32 m0, s40, 98304
s_waitcnt lgkmcnt(8)
v_mfma_f32_32x32x16_bf16 a[64:79], v[96:99], v[180:183], a[64:79]
ds_read_b64_tr_b16 v[96:97], v9 offset:59392
ds_read_b64_tr_b16 v[98:99], v9 offset:59904
buffer_load_dwordx4 v4, s[20:23], s64 offen offset:0 lds
v_dot2_f32_bf16 v43, v75, s13, v43
v_dot2_f32_bf16 v44, v76, s12, v44
v_dot2_f32_bf16 v45, v76, s13, v45
v_mfma_f32_32x32x16_bf16 a[80:95], v[100:103], v[180:183], a[80:95]
ds_read_b64_tr_b16 v[100:101], v12 offset:59392
ds_read_b64_tr_b16 v[102:103], v12 offset:59904
s_waitcnt vmcnt(23)
v_dot2_f32_bf16 v40, v78, s12, v40
v_dot2_f32_bf16 v41, v78, s13, v41
v_dot2_f32_bf16 v42, v79, s12, v42
v_dot2_f32_bf16 v43, v79, s13, v43
s_waitcnt lgkmcnt(8)
v_mfma_f32_32x32x16_bf16 a[96:111], v[104:107], v[180:183], a[96:111]
ds_read_b64_tr_b16 v[104:105], v9 offset:61440
ds_read_b64_tr_b16 v[106:107], v9 offset:61952
v_dot2_f32_bf16 v44, v80, s12, v44
v_dot2_f32_bf16 v45, v80, s13, v45
s_waitcnt vmcnt(20)
v_dot2_f32_bf16 v40, v82, s12, v40
v_dot2_f32_bf16 v41, v82, s13, v41
v_mfma_f32_32x32x16_bf16 a[112:127], v[108:111], v[180:183], a[112:127]
ds_read_b64_tr_b16 v[108:109], v12 offset:61440
ds_read_b64_tr_b16 v[110:111], v12 offset:61952
v_dot2_f32_bf16 v42, v83, s12, v42
v_dot2_f32_bf16 v43, v83, s13, v43
v_dot2_f32_bf16 v44, v84, s12, v44
s_add_u32 m0, s40, 102400
s_waitcnt lgkmcnt(8)
v_mfma_f32_32x32x16_bf16 a[64:79], v[88:91], v[184:187], a[64:79]
ds_read_b64_tr_b16 v[88:89], v9 offset:63488
ds_read_b64_tr_b16 v[90:91], v9 offset:64000
buffer_load_dwordx4 v4, s[20:23], s66 offen offset:0 lds
v_dot2_f32_bf16 v45, v84, s13, v45
s_waitcnt vmcnt(20)
v_accvgpr_read_b32 v46, a192
v_accvgpr_read_b32 v47, a193
v_mfma_f32_32x32x16_bf16 a[80:95], v[92:95], v[184:187], a[80:95]
ds_read_b64_tr_b16 v[92:93], v12 offset:63488
ds_read_b64_tr_b16 v[94:95], v12 offset:64000
v_accvgpr_read_b32 v48, a194
v_dot2_f32_bf16 v40, v46, s12, v40
v_dot2_f32_bf16 v41, v46, s13, v41
v_dot2_f32_bf16 v42, v47, s12, v42
s_waitcnt lgkmcnt(8)
v_mfma_f32_32x32x16_bf16 a[96:111], v[96:99], v[184:187], a[96:111]
s_barrier
ds_read_b64_tr_b16 v[96:97], v8 offset:0
ds_read_b64_tr_b16 v[98:99], v8 offset:512
v_dot2_f32_bf16 v43, v47, s13, v43
v_dot2_f32_bf16 v44, v48, s12, v44
v_dot2_f32_bf16 v45, v48, s13, v45
v_mfma_f32_32x32x16_bf16 a[112:127], v[100:103], v[184:187], a[112:127]
ds_read_b64_tr_b16 v[100:101], v11 offset:0
ds_read_b64_tr_b16 v[102:103], v11 offset:512
s_waitcnt vmcnt(18)
v_accvgpr_read_b32 v50, a196
v_accvgpr_read_b32 v51, a197
v_accvgpr_read_b32 v52, a198
s_add_u32 m0, s40, 106496
s_waitcnt lgkmcnt(8)
v_mfma_f32_32x32x16_bf16 a[64:79], v[104:107], v[188:191], a[64:79]
ds_read_b64_tr_b16 v[104:105], v8 offset:2048
ds_read_b64_tr_b16 v[106:107], v8 offset:2560
buffer_load_dwordx4 v4, s[20:23], s68 offen offset:0 lds
v_dot2_f32_bf16 v40, v50, s12, v40
v_dot2_f32_bf16 v41, v50, s13, v41
v_dot2_f32_bf16 v42, v51, s12, v42
v_mfma_f32_32x32x16_bf16 a[80:95], v[108:111], v[188:191], a[80:95]
ds_read_b64_tr_b16 v[108:109], v11 offset:2048
ds_read_b64_tr_b16 v[110:111], v11 offset:2560
v_dot2_f32_bf16 v43, v51, s13, v43
v_dot2_f32_bf16 v44, v52, s12, v44
v_dot2_f32_bf16 v45, v52, s13, v45
s_waitcnt vmcnt(18)
v_accvgpr_read_b32 v54, a200
s_waitcnt lgkmcnt(8)
v_mfma_f32_32x32x16_bf16 a[96:111], v[88:91], v[188:191], a[96:111]
ds_read_b64_tr_b16 v[88:89], v8 offset:4096
ds_read_b64_tr_b16 v[90:91], v8 offset:4608
v_accvgpr_read_b32 v55, a201
v_accvgpr_read_b32 v56, a202
v_dot2_f32_bf16 v40, v54, s12, v40
v_dot2_f32_bf16 v41, v54, s13, v41
v_mfma_f32_32x32x16_bf16 a[112:127], v[92:95], v[188:191], a[112:127]
ds_read_b64_tr_b16 v[92:93], v11 offset:4096
ds_read_b64_tr_b16 v[94:95], v11 offset:4608
v_dot2_f32_bf16 v42, v55, s12, v42
v_dot2_f32_bf16 v43, v55, s13, v43
v_dot2_f32_bf16 v44, v56, s12, v44
s_add_u32 m0, s40, 110592
s_waitcnt lgkmcnt(8)
v_mfma_f32_32x32x16_bf16 a[64:79], v[96:99], v[192:195], a[64:79]
ds_read_b64_tr_b16 v[96:97], v8 offset:6144
ds_read_b64_tr_b16 v[98:99], v8 offset:6656
buffer_load_dwordx4 v4, s[20:23], s70 offen offset:0 lds
v_dot2_f32_bf16 v45, v56, s13, v45
s_waitcnt vmcnt(17)
v_accvgpr_read_b32 v58, a204
v_accvgpr_read_b32 v59, a205
v_mfma_f32_32x32x16_bf16 a[80:95], v[100:103], v[192:195], a[80:95]
ds_read_b64_tr_b16 v[100:101], v11 offset:6144
ds_read_b64_tr_b16 v[102:103], v11 offset:6656
v_accvgpr_read_b32 v60, a206
v_dot2_f32_bf16 v40, v58, s12, v40
v_dot2_f32_bf16 v41, v58, s13, v41
v_dot2_f32_bf16 v42, v59, s12, v42
s_waitcnt lgkmcnt(8)
v_mfma_f32_32x32x16_bf16 a[96:111], v[104:107], v[192:195], a[96:111]
s_barrier
ds_read_b64_tr_b16 v[104:105], v8 offset:8192
ds_read_b64_tr_b16 v[106:107], v8 offset:8704
v_dot2_f32_bf16 v43, v59, s13, v43
v_dot2_f32_bf16 v44, v60, s12, v44
v_dot2_f32_bf16 v45, v60, s13, v45
v_mfma_f32_32x32x16_bf16 a[112:127], v[108:111], v[192:195], a[112:127]
ds_read_b64_tr_b16 v[108:109], v11 offset:8192
ds_read_b64_tr_b16 v[110:111], v11 offset:8704
s_waitcnt vmcnt(16)
v_accvgpr_read_b32 v62, a208
v_accvgpr_read_b32 v63, a209
v_accvgpr_read_b32 v64, a210
s_add_u32 m0, s40, 114688
s_waitcnt lgkmcnt(8)
v_mfma_f32_32x32x16_bf16 a[64:79], v[88:91], v[196:199], a[64:79]
ds_read_b64_tr_b16 v[88:89], v8 offset:10240
ds_read_b64_tr_b16 v[90:91], v8 offset:10752
buffer_load_dwordx4 v4, s[20:23], s72 offen offset:0 lds
v_dot2_f32_bf16 v40, v62, s12, v40
v_dot2_f32_bf16 v41, v62, s13, v41
v_dot2_f32_bf16 v42, v63, s12, v42
v_mfma_f32_32x32x16_bf16 a[80:95], v[92:95], v[196:199], a[80:95]
ds_read_b64_tr_b16 v[92:93], v11 offset:10240
ds_read_b64_tr_b16 v[94:95], v11 offset:10752
v_dot2_f32_bf16 v43, v63, s13, v43
v_dot2_f32_bf16 v44, v64, s12, v44
v_dot2_f32_bf16 v45, v64, s13, v45
s_waitcnt vmcnt(15)
v_accvgpr_read_b32 v66, a212
s_waitcnt lgkmcnt(8)
v_mfma_f32_32x32x16_bf16 a[96:111], v[96:99], v[196:199], a[96:111]
ds_read_b64_tr_b16 v[96:97], v8 offset:12288
ds_read_b64_tr_b16 v[98:99], v8 offset:12800
v_accvgpr_read_b32 v67, a213
v_accvgpr_read_b32 v68, a214
v_dot2_f32_bf16 v40, v66, s12, v40
v_dot2_f32_bf16 v41, v66, s13, v41
v_mfma_f32_32x32x16_bf16 a[112:127], v[100:103], v[196:199], a[112:127]
ds_read_b64_tr_b16 v[100:101], v11 offset:12288
ds_read_b64_tr_b16 v[102:103], v11 offset:12800
v_dot2_f32_bf16 v42, v67, s12, v42
v_dot2_f32_bf16 v43, v67, s13, v43
v_dot2_f32_bf16 v44, v68, s12, v44
s_add_u32 m0, s40, 118784
s_waitcnt lgkmcnt(8)
v_mfma_f32_32x32x16_bf16 a[64:79], v[104:107], v[200:203], a[64:79]
ds_read_b64_tr_b16 v[104:105], v8 offset:14336
ds_read_b64_tr_b16 v[106:107], v8 offset:14848
buffer_load_dwordx4 v4, s[20:23], s74 offen offset:0 lds
v_dot2_f32_bf16 v45, v68, s13, v45
s_add_u32 s45, s45, 140288
v_mul_u32_u24 v22, 24, v1
v_mfma_f32_32x32x16_bf16 a[80:95], v[108:111], v[200:203], a[80:95]
ds_read_b64_tr_b16 v[108:109], v11 offset:14336
ds_read_b64_tr_b16 v[110:111], v11 offset:14848
v_add_u32 v22, s45, v22
ds_write_b64 v22, v[40:41] offset:0
ds_write_b64 v22, v[42:43] offset:8
ds_write_b64 v22, v[44:45] offset:16
s_waitcnt lgkmcnt(11)
v_mfma_f32_32x32x16_bf16 a[96:111], v[88:91], v[200:203], a[96:111]
s_barrier
ds_read_b64_tr_b16 v[88:89], v8 offset:16384
ds_read_b64_tr_b16 v[90:91], v8 offset:16896
v_lshlrev_b32 v22, 4, v1
v_add_u32 v22, 140288, v22
v_accvgpr_read_b32 v23, a252
v_mfma_f32_32x32x16_bf16 a[112:127], v[92:95], v[200:203], a[112:127]
ds_read_b64_tr_b16 v[92:93], v11 offset:16384
ds_read_b64_tr_b16 v[94:95], v11 offset:16896
s_mov_b32 s92, 0xf0f0f3f
s_mov_b32 s93, 0xf0f0f3f
s_mov_b32 s94, 0xf0f0f3f
s_add_u32 m0, s40, 122880
s_waitcnt lgkmcnt(11)
v_mfma_f32_32x32x16_bf16 a[64:79], v[96:99], v[204:207], a[64:79]
ds_read_b64_tr_b16 v[96:97], v8 offset:18432
ds_read_b64_tr_b16 v[98:99], v8 offset:18944
buffer_load_dwordx4 v4, s[20:23], s76 offen offset:0 lds
s_mov_b32 s95, 0xf0f0f0c0
v_accvgpr_write_b32 a232, 0
v_accvgpr_write_b32 a233, 0
v_mfma_f32_32x32x16_bf16 a[80:95], v[100:103], v[204:207], a[80:95]
ds_read_b64_tr_b16 v[100:101], v11 offset:18432
ds_read_b64_tr_b16 v[102:103], v11 offset:18944
v_accvgpr_write_b32 a236, 0
v_accvgpr_write_b32 a237, 0
v_accvgpr_write_b32 a208, 0
v_accvgpr_write_b32 a209, 0
s_waitcnt lgkmcnt(11)
v_mfma_f32_32x32x16_bf16 a[96:111], v[104:107], v[204:207], a[96:111]
ds_read_b64_tr_b16 v[104:105], v8 offset:20480
ds_read_b64_tr_b16 v[106:107], v8 offset:20992
v_accvgpr_read_b32 v26, a26
v_accvgpr_read_b32 v27, a27
v_accvgpr_read_b32 v28, a56
v_accvgpr_read_b32 v29, a57
v_mfma_f32_32x32x16_bf16 a[112:127], v[108:111], v[204:207], a[112:127]
ds_read_b64_tr_b16 v[108:109], v11 offset:20480
ds_read_b64_tr_b16 v[110:111], v11 offset:20992
v_accvgpr_read_b32 v30, a58
v_accvgpr_read_b32 v31, a59
v_max_f32 v24, 0, v24
s_add_u32 m0, s40, 126976
s_waitcnt lgkmcnt(8)
v_mfma_f32_32x32x16_bf16 a[64:79], v[88:91], v[208:211], a[64:79]
ds_read_b64_tr_b16 v[88:89], v8 offset:22528
ds_read_b64_tr_b16 v[90:91], v8 offset:23040
buffer_load_dwordx4 v4, s[20:23], s78 offen offset:0 lds
v_max_f32 v25, 0, v25
v_max_f32 v26, 0, v26
v_max_f32 v27, 0, v27
v_mfma_f32_32x32x16_bf16 a[80:95], v[92:95], v[208:211], a[80:95]
ds_read_b64_tr_b16 v[92:93], v11 offset:22528
ds_read_b64_tr_b16 v[94:95], v11 offset:23040
v_mul_f32 v24, v24, v28
v_mul_f32 v25, v25, v29
v_mul_f32 v26, v26, v30
v_mul_f32 v27, v27, v31
s_waitcnt lgkmcnt(8)
v_mfma_f32_32x32x16_bf16 a[96:111], v[96:99], v[208:211], a[96:111]
s_barrier
ds_read_b64_tr_b16 v[96:97], v8 offset:24576
ds_read_b64_tr_b16 v[98:99], v8 offset:25088
ds_read_b128 v[40:43], v22 offset:0
v_cvt_pk_bf16_f32 v24, v24, v25
v_mfma_f32_32x32x16_bf16 a[112:127], v[100:103], v[208:211], a[112:127]
ds_read_b64_tr_b16 v[100:101], v11 offset:24576
ds_read_b64_tr_b16 v[102:103], v11 offset:25088
ds_read_b128 v[44:47], v22 offset:1024
v_cvt_pk_bf16_f32 v26, v26, v27
s_add_u32 m0, s40, 0
s_waitcnt lgkmcnt(10)
v_mfma_f32_32x32x16_bf16 a[64:79], v[104:107], v[212:215], a[64:79]
ds_read_b64_tr_b16 v[104:105], v8 offset:26624
ds_read_b64_tr_b16 v[106:107], v8 offset:27136
buffer_load_dwordx4 v4, s[20:23], s80 offen offset:0 lds
ds_read_b128 v[48:51], v22 offset:2048
v_accvgpr_write_b32 a172, v24
v_mfma_f32_32x32x16_bf16 a[80:95], v[108:111], v[212:215], a[80:95]
ds_read_b64_tr_b16 v[108:109], v11 offset:26624
ds_read_b64_tr_b16 v[110:111], v11 offset:27136
ds_read_b128 v[52:55], v22 offset:3072
ds_read_b128 v[56:59], v23 offset:0
s_waitcnt lgkmcnt(13)
v_mfma_f32_32x32x16_bf16 a[96:111], v[88:91], v[212:215], a[96:111]
ds_read_b64_tr_b16 v[88:89], v8 offset:28672
ds_read_b64_tr_b16 v[90:91], v8 offset:29184
ds_read_b128 v[60:63], v23 offset:256
ds_read_b128 v[64:67], v23 offset:512
v_mfma_f32_32x32x16_bf16 a[112:127], v[92:95], v[212:215], a[112:127]
ds_read_b64_tr_b16 v[92:93], v11 offset:28672
ds_read_b64_tr_b16 v[94:95], v11 offset:29184
ds_read_b128 v[68:71], v23 offset:768
v_accvgpr_write_b32 a173, v26
s_add_u32 m0, s40, 4096
s_waitcnt lgkmcnt(15)
v_mfma_f32_32x32x16_bf16 a[64:79], v[96:99], v[216:219], a[64:79]
ds_read_b64_tr_b16 v[96:97], v8 offset:30720
ds_read_b64_tr_b16 v[98:99], v8 offset:31232
buffer_load_dwordx4 v4, s[20:23], s82 offen offset:0 lds
ds_read_b128 v[72:75], v23 offset:1024
ds_read_b128 v[76:79], v22 offset:5376
v_mfma_f32_32x32x16_bf16 a[80:95], v[100:103], v[216:219], a[80:95]
ds_read_b64_tr_b16 v[100:101], v11 offset:30720
ds_read_b64_tr_b16 v[102:103], v11 offset:31232
s_waitcnt lgkmcnt(14)
v_cvt_pk_bf16_f32 v40, v40, v41
v_cvt_pk_bf16_f32 v42, v42, v43
v_cvt_pk_bf16_f32 v44, v44, v45
v_cvt_pk_bf16_f32 v46, v46, v47
v_mfma_f32_32x32x16_bf16 a[96:111], v[104:107], v[216:219], a[96:111]
s_barrier
ds_read_b64_tr_b16 v[104:105], v8 offset:32768
ds_read_b64_tr_b16 v[106:107], v8 offset:33280
v_cvt_pk_bf16_f32 v48, v48, v49
v_cvt_pk_bf16_f32 v50, v50, v51
v_cvt_pk_bf16_f32 v52, v52, v53
v_mfma_f32_32x32x16_bf16 a[112:127], v[108:111], v[216:219], a[112:127]
ds_read_b64_tr_b16 v[108:109], v11 offset:32768
ds_read_b64_tr_b16 v[110:111], v11 offset:33280
v_cvt_pk_bf16_f32 v54, v54, v55
v_cndmask_b32 v40, 0, v40, s[92:93]
v_cndmask_b32 v42, 0, v42, s[94:95]
s_add_u32 m0, s40, 8192
s_waitcnt lgkmcnt(11)
v_mfma_f32_32x32x16_bf16 a[64:79], v[88:91], v[220:223], a[64:79]
ds_read_b64_tr_b16 v[88:89], v8 offset:34816
ds_read_b64_tr_b16 v[90:91], v8 offset:35328
buffer_load_dwordx4 v5, s[24:27], s84 offen offset:0 lds
v_cndmask_b32 v44, 0, v44, s[94:95]
v_cndmask_b32 v46, 0, v46, s[94:95]
v_cndmask_b32 v48, 0, v48, s[94:95]
v_mfma_f32_32x32x16_bf16 a[80:95], v[92:95], v[220:223], a[80:95]
ds_read_b64_tr_b16 v[92:93], v11 offset:34816
ds_read_b64_tr_b16 v[94:95], v11 offset:35328
v_cndmask_b32 v50, 0, v50, s[94:95]
v_cndmask_b32 v52, 0, v52, s[94:95]
v_cndmask_b32 v54, 0, v54, s[94:95]
v_accvgpr_write_b32 a216, v40
s_waitcnt lgkmcnt(8)
v_mfma_f32_32x32x16_bf16 a[96:111], v[96:99], v[220:223], a[96:111]
ds_read_b64_tr_b16 v[96:97], v8 offset:36864
ds_read_b64_tr_b16 v[98:99], v8 offset:37376
v_accvgpr_write_b32 a217, v42
v_accvgpr_write_b32 a218, v44
v_accvgpr_write_b32 a219, v46
v_accvgpr_write_b32 a220, v48
v_mfma_f32_32x32x16_bf16 a[112:127], v[100:103], v[220:223], a[112:127]
ds_read_b64_tr_b16 v[100:101], v11 offset:36864
ds_read_b64_tr_b16 v[102:103], v11 offset:37376
v_accvgpr_write_b32 a221, v50
v_accvgpr_write_b32 a222, v52
v_accvgpr_write_b32 a223, v54
s_add_u32 m0, s40, 12288
s_waitcnt lgkmcnt(8)
v_mfma_f32_32x32x16_bf16 a[64:79], v[104:107], v[224:227], a[64:79]
ds_read_b64_tr_b16 v[104:105], v8 offset:38912
ds_read_b64_tr_b16 v[106:107], v8 offset:39424
buffer_load_dwordx4 v5, s[24:27], s85 offen offset:0 lds
s_mov_b32 s92, 0x11
s_mov_b32 s93, 0x11
s_mov_b32 s94, 0x11
v_mfma_f32_32x32x16_bf16 a[80:95], v[108:111], v[224:227], a[80:95]
ds_read_b64_tr_b16 v[108:109], v11 offset:38912
ds_read_b64_tr_b16 v[110:111], v11 offset:39424
s_mov_b32 s95, 0xf022
v_cvt_pk_bf16_f32 v56, v56, v57
v_cvt_pk_bf16_f32 v58, v58, v59
v_cvt_pk_bf16_f32 v60, v60, v61
s_waitcnt lgkmcnt(8)
v_mfma_f32_32x32x16_bf16 a[96:111], v[88:91], v[224:227], a[96:111]
s_barrier
ds_read_b64_tr_b16 v[88:89], v8 offset:40960
ds_read_b64_tr_b16 v[90:91], v8 offset:41472
v_cvt_pk_bf16_f32 v62, v62, v63
v_cvt_pk_bf16_f32 v64, v64, v65
v_cvt_pk_bf16_f32 v66, v66, v67
v_mfma_f32_32x32x16_bf16 a[112:127], v[92:95], v[224:227], a[112:127]
ds_read_b64_tr_b16 v[92:93], v11 offset:40960
ds_read_b64_tr_b16 v[94:95], v11 offset:41472
v_cvt_pk_bf16_f32 v68, v68, v69
v_cvt_pk_bf16_f32 v70, v70, v71
v_cndmask_b32 v56, 0, v56, s[92:93]
s_add_u32 m0, s40, 16384
s_waitcnt lgkmcnt(8)
v_mfma_f32_32x32x16_bf16 a[64:79], v[96:99], v[228:231], a[64:79]
ds_read_b64_tr_b16 v[96:97], v8 offset:43008
ds_read_b64_tr_b16 v[98:99], v8 offset:43520
buffer_load_dwordx4 v5, s[24:27], s86 offen offset:0 lds
v_cndmask_b32 v58, 0, v58, s[94:95]
v_cndmask_b32 v60, 0, v60, s[94:95]
v_cndmask_b32 v62, 0, v62, s[94:95]
v_mfma_f32_32x32x16_bf16 a[80:95], v[100:103], v[228:231], a[80:95]
ds_read_b64_tr_b16 v[100:101], v11 offset:43008
ds_read_b64_tr_b16 v[102:103], v11 offset:43520
v_cndmask_b32 v64, 0, v64, s[94:95]
v_cndmask_b32 v66, 0, v66, s[94:95]
v_cndmask_b32 v68, 0, v68, s[94:95]
v_cndmask_b32 v70, 0, v70, s[94:95]
s_waitcnt lgkmcnt(8)
v_mfma_f32_32x32x16_bf16 a[96:111], v[104:107], v[228:231], a[96:111]
ds_read_b64_tr_b16 v[104:105], v8 offset:45056
ds_read_b64_tr_b16 v[106:107], v8 offset:45568
v_accvgpr_write_b32 a224, v56
v_accvgpr_write_b32 a225, v58
v_accvgpr_write_b32 a226, v60
v_accvgpr_write_b32 a227, v62
v_mfma_f32_32x32x16_bf16 a[112:127], v[108:111], v[228:231], a[112:127]
ds_read_b64_tr_b16 v[108:109], v11 offset:45056
ds_read_b64_tr_b16 v[110:111], v11 offset:45568
v_accvgpr_write_b32 a228, v64
v_accvgpr_write_b32 a229, v66
v_accvgpr_write_b32 a230, v68
s_add_u32 m0, s40, 20480
s_waitcnt lgkmcnt(8)
v_mfma_f32_32x32x16_bf16 a[64:79], v[88:91], v[232:235], a[64:79]
ds_read_b64_tr_b16 v[88:89], v8 offset:47104
ds_read_b64_tr_b16 v[90:91], v8 offset:47616
buffer_load_dwordx4 v5, s[24:27], s87 offen offset:0 lds
v_accvgpr_write_b32 a231, v70
s_mov_b32 s92, 0xf022
s_mov_b32 s93, 0x0
v_mfma_f32_32x32x16_bf16 a[80:95], v[92:95], v[232:235], a[80:95]
ds_read_b64_tr_b16 v[92:93], v11 offset:47104
ds_read_b64_tr_b16 v[94:95], v11 offset:47616
s_mov_b32 s94, 0xf0f0f0c0
s_mov_b32 s95, 0x0
v_cvt_pk_bf16_f32 v72, v72, v73
v_cvt_pk_bf16_f32 v74, v74, v75
s_waitcnt lgkmcnt(8)
v_mfma_f32_32x32x16_bf16 a[96:111], v[96:99], v[232:235], a[96:111]
s_barrier
ds_read_b64_tr_b16 v[96:97], v8 offset:49152
ds_read_b64_tr_b16 v[98:99], v8 offset:49664
v_cndmask_b32 v72, 0, v72, s[92:93]
v_cndmask_b32 v74, 0, v74, s[92:93]
v_accvgpr_write_b32 a238, v72
v_mfma_f32_32x32x16_bf16 a[112:127], v[100:103], v[232:235], a[112:127]
ds_read_b64_tr_b16 v[100:101], v11 offset:49152
ds_read_b64_tr_b16 v[102:103], v11 offset:49664
v_accvgpr_write_b32 a239, v74
v_cvt_pk_bf16_f32 v76, v76, v77
v_cvt_pk_bf16_f32 v78, v78, v79
s_add_u32 m0, s40, 24576
s_waitcnt lgkmcnt(8)
v_mfma_f32_32x32x16_bf16 a[64:79], v[104:107], v[236:239], a[64:79]
ds_read_b64_tr_b16 v[104:105], v8 offset:51200
ds_read_b64_tr_b16 v[106:107], v8 offset:51712
buffer_load_dwordx4 v5, s[24:27], s88 offen offset:0 lds
v_cndmask_b32 v76, 0, v76, s[94:95]
v_cndmask_b32 v78, 0, v78, s[94:95]
v_accvgpr_write_b32 a234, v76
v_mfma_f32_32x32x16_bf16 a[80:95], v[108:111], v[236:239], a[80:95]
ds_read_b64_tr_b16 v[108:109], v11 offset:51200
ds_read_b64_tr_b16 v[110:111], v11 offset:51712
v_accvgpr_write_b32 a235, v78
s_mov_b32 s92, 0x0
s_mov_b32 s93, 0xffffffff
v_mfma_f32_32x32x16_bf16 v[60:75], a[224:227], a[240:243], 0
s_waitcnt lgkmcnt(8)
v_mfma_f32_32x32x16_bf16 a[96:111], v[88:91], v[236:239], a[96:111]
ds_read_b64_tr_b16 v[88:89], v8 offset:53248
ds_read_b64_tr_b16 v[90:91], v8 offset:53760
v_mfma_f32_32x32x16_bf16 v[44:59], a[216:219], a[240:243], 0
v_mfma_f32_32x32x16_bf16 a[112:127], v[92:95], v[236:239], a[112:127]
ds_read_b64_tr_b16 v[92:93], v11 offset:53248
ds_read_b64_tr_b16 v[94:95], v11 offset:53760
v_mfma_f32_32x32x16_bf16 v[60:75], a[228:231], a[244:247], v[60:75]
s_add_u32 m0, s40, 28672
s_waitcnt lgkmcnt(8)
v_mfma_f32_32x32x16_bf16 a[64:79], v[96:99], v[240:243], a[64:79]
ds_read_b64_tr_b16 v[96:97], v8 offset:55296
ds_read_b64_tr_b16 v[98:99], v8 offset:55808
buffer_load_dwordx4 v5, s[24:27], s89 offen offset:0 lds
v_mfma_f32_32x32x16_bf16 v[44:59], a[220:223], a[244:247], v[44:59]
v_mfma_f32_32x32x16_bf16 a[80:95], v[100:103], v[240:243], a[80:95]
ds_read_b64_tr_b16 v[100:101], v11 offset:55296
ds_read_b64_tr_b16 v[102:103], v11 offset:55808
v_mfma_f32_32x32x16_bf16 v[60:75], a[236:239], a[248:251], v[60:75]
s_waitcnt lgkmcnt(8)
v_mfma_f32_32x32x16_bf16 a[96:111], v[104:107], v[240:243], a[96:111]
s_barrier
ds_read_b64_tr_b16 v[104:105], v8 offset:57344
ds_read_b64_tr_b16 v[106:107], v8 offset:57856
v_mfma_f32_32x32x16_bf16 v[44:59], a[232:235], a[248:251], v[44:59]
v_mfma_f32_32x32x16_bf16 a[112:127], v[108:111], v[240:243], a[112:127]
ds_read_b64_tr_b16 v[108:109], v11 offset:57344
ds_read_b64_tr_b16 v[110:111], v11 offset:57856
v_accvgpr_read_b32 v32, a28
v_accvgpr_read_b32 v33, a29
v_accvgpr_read_b32 v34, a30
s_add_u32 m0, s40, 32768
s_waitcnt lgkmcnt(8)
v_mfma_f32_32x32x16_bf16 a[64:79], v[88:91], v[244:247], a[64:79]
ds_read_b64_tr_b16 v[88:89], v8 offset:59392
ds_read_b64_tr_b16 v[90:91], v8 offset:59904
buffer_load_dwordx4 v5, s[24:27], s90 offen offset:0 lds
v_accvgpr_read_b32 v35, a31
v_accvgpr_read_b32 v36, a60
v_accvgpr_read_b32 v37, a61
v_mfma_f32_32x32x16_bf16 a[80:95], v[92:95], v[244:247], a[80:95]
ds_read_b64_tr_b16 v[92:93], v11 offset:59392
ds_read_b64_tr_b16 v[94:95], v11 offset:59904
v_accvgpr_read_b32 v38, a62
v_accvgpr_read_b32 v39, a63
v_max_f32 v32, 0, v32
v_max_f32 v33, 0, v33
s_waitcnt lgkmcnt(8)
v_mfma_f32_32x32x16_bf16 a[96:111], v[96:99], v[244:247], a[96:111]
ds_read_b64_tr_b16 v[96:97], v8 offset:61440
ds_read_b64_tr_b16 v[98:99], v8 offset:61952
v_add_f32 v60, s46, v60
v_add_f32 v61, s46, v61
v_rcp_f32 v60, v60
v_mfma_f32_32x32x16_bf16 a[112:127], v[100:103], v[244:247], a[112:127]
ds_read_b64_tr_b16 v[100:101], v11 offset:61440
ds_read_b64_tr_b16 v[102:103], v11 offset:61952
v_max_f32 v34, 0, v34
v_max_f32 v35, 0, v35
v_mul_f32 v32, v32, v36
s_add_u32 m0, s40, 36864
s_waitcnt lgkmcnt(8)
v_mfma_f32_32x32x16_bf16 a[64:79], v[104:107], v[248:251], a[64:79]
ds_read_b64_tr_b16 v[104:105], v8 offset:63488
ds_read_b64_tr_b16 v[106:107], v8 offset:64000
buffer_load_dwordx4 v5, s[24:27], s91 offen offset:0 lds
v_mul_f32 v33, v33, v37
v_mul_f32 v34, v34, v38
v_mul_f32 v35, v35, v39
v_mfma_f32_32x32x16_bf16 a[80:95], v[108:111], v[248:251], a[80:95]
ds_read_b64_tr_b16 v[108:109], v11 offset:63488
ds_read_b64_tr_b16 v[110:111], v11 offset:64000
v_cvt_pk_bf16_f32 v32, v32, v33
v_cvt_pk_bf16_f32 v34, v34, v35
v_accvgpr_write_b32 a174, v32
v_accvgpr_write_b32 a175, v34
s_waitcnt lgkmcnt(8)
v_mfma_f32_32x32x16_bf16 a[96:111], v[88:91], v[248:251], a[96:111]
s_waitcnt vmcnt(26)
s_barrier
ds_read_b64_tr_b16 v[88:89], v15 offset:0
ds_read_b64_tr_b16 v[90:91], v15 offset:256
s_mov_b32 s6, 114688
buffer_store_dwordx4 a[172:175], v21, s[36:39], s6 offen offset:3072 sc1
v_mfma_f32_32x32x16_bf16 a[112:127], v[92:95], v[248:251], a[112:127]
ds_read_b64_tr_b16 v[92:93], v15 offset:2048
ds_read_b64_tr_b16 v[94:95], v15 offset:2304
v_rcp_f32 v61, v61
v_mul_f32 v44, v44, v60
s_add_u32 m0, s40, 40960
s_waitcnt lgkmcnt(8)
v_mfma_f32_32x32x16_bf16 a[64:79], v[96:99], v[252:255], a[64:79]
ds_read_b64_tr_b16 v[96:97], v15 offset:1024
ds_read_b64_tr_b16 v[98:99], v15 offset:1280
buffer_load_dwordx4 v2, s[24:27], s84 offen offset:0 lds
v_mul_f32 v45, v45, v60
v_cndmask_b32 v61, v60, v61, s[92:93]
v_mul_f32 v46, v46, v61
v_mfma_f32_32x32x16_bf16 a[80:95], v[100:103], v[252:255], a[80:95]
ds_read_b64_tr_b16 v[100:101], v15 offset:3072
ds_read_b64_tr_b16 v[102:103], v15 offset:3328
v_mul_f32 v47, v47, v61
v_mul_f32 v48, v48, v61
v_mul_f32 v49, v49, v61
v_mul_f32 v50, v50, v61
s_waitcnt lgkmcnt(8)
v_mfma_f32_32x32x16_bf16 a[96:111], v[104:107], v[252:255], a[96:111]
ds_read_b64_tr_b16 v[104:105], v15 offset:4096
ds_read_b64_tr_b16 v[106:107], v15 offset:4352
v_mul_f32 v51, v51, v61
v_mul_f32 v52, v52, v61
v_mul_f32 v53, v53, v61
v_mul_f32 v54, v54, v61
v_mfma_f32_32x32x16_bf16 a[112:127], v[108:111], v[252:255], a[112:127]
ds_read_b64_tr_b16 v[108:109], v15 offset:6144
ds_read_b64_tr_b16 v[110:111], v15 offset:6400
v_mul_f32 v55, v55, v61
v_mul_f32 v56, v56, v61
v_mul_f32 v57, v57, v61
s_add_u32 m0, s40, 45056
s_waitcnt lgkmcnt(8)
v_mfma_f32_32x32x16_bf16 a[0:15], v[88:91], v[112:115], 0
ds_read_b64_tr_b16 v[88:89], v15 offset:5120
ds_read_b64_tr_b16 v[90:91], v15 offset:5376
buffer_load_dwordx4 v2, s[24:27], s85 offen offset:0 lds
v_mul_f32 v58, v58, v61
v_mul_f32 v59, v59, v61
v_mul_f32 v64, v64, v61
v_mfma_f32_32x32x16_bf16 a[32:47], v[92:95], v[112:115], 0
ds_read_b64_tr_b16 v[92:93], v15 offset:7168
ds_read_b64_tr_b16 v[94:95], v15 offset:7424
v_mul_f32 v65, v65, v61
v_mul_f32 v66, v66, v61
v_mul_f32 v67, v67, v61
v_cvt_pk_bf16_f32 v44, v44, v45
s_waitcnt lgkmcnt(8)
v_mfma_f32_32x32x16_bf16 a[0:15], v[96:99], v[116:119], a[0:15]
s_waitcnt vmcnt(26)
s_barrier
ds_read_b64_tr_b16 v[96:97], v15 offset:8192
ds_read_b64_tr_b16 v[98:99], v15 offset:8448
v_cvt_pk_bf16_f32 v46, v46, v47
v_cvt_pk_bf16_f32 v48, v48, v49
v_mfma_f32_32x32x16_bf16 a[32:47], v[100:103], v[116:119], a[32:47]
ds_read_b64_tr_b16 v[100:101], v15 offset:10240
ds_read_b64_tr_b16 v[102:103], v15 offset:10496
v_cvt_pk_bf16_f32 v50, v50, v51
v_cvt_pk_bf16_f32 v52, v52, v53
v_cvt_pk_bf16_f32 v54, v54, v55
s_add_u32 m0, s40, 49152
s_waitcnt lgkmcnt(8)
v_mfma_f32_32x32x16_bf16 a[0:15], v[104:107], v[120:123], a[0:15]
ds_read_b64_tr_b16 v[104:105], v15 offset:9216
ds_read_b64_tr_b16 v[106:107], v15 offset:9472
buffer_load_dwordx4 v2, s[24:27], s86 offen offset:0 lds
v_cvt_pk_bf16_f32 v56, v56, v57
v_cvt_pk_bf16_f32 v58, v58, v59
v_cvt_pk_bf16_f32 v64, v64, v65
v_mfma_f32_32x32x16_bf16 a[32:47], v[108:111], v[120:123], a[32:47]
ds_read_b64_tr_b16 v[108:109], v15 offset:11264
ds_read_b64_tr_b16 v[110:111], v15 offset:11520
v_cvt_pk_bf16_f32 v66, v66, v67
v_cndmask_b32 v64, 0, v64, s[92:93]
v_cndmask_b32 v66, 0, v66, s[92:93]
v_accvgpr_write_b32 a200, v44
s_waitcnt lgkmcnt(8)
v_mfma_f32_32x32x16_bf16 a[0:15], v[88:91], v[124:127], a[0:15]
ds_read_b64_tr_b16 v[88:89], v15 offset:12288
ds_read_b64_tr_b16 v[90:91], v15 offset:12544
v_accvgpr_write_b32 a201, v46
v_accvgpr_write_b32 a202, v48
v_accvgpr_write_b32 a203, v50
v_accvgpr_write_b32 a204, v52
v_mfma_f32_32x32x16_bf16 a[32:47], v[92:95], v[124:127], a[32:47]
ds_read_b64_tr_b16 v[92:93], v15 offset:14336
ds_read_b64_tr_b16 v[94:95], v15 offset:14592
v_accvgpr_write_b32 a205, v54
v_accvgpr_write_b32 a206, v56
v_accvgpr_write_b32 a207, v58
s_add_u32 m0, s40, 53248
s_waitcnt lgkmcnt(8)
v_mfma_f32_32x32x16_bf16 a[0:15], v[96:99], v[128:131], a[0:15]
ds_read_b64_tr_b16 v[96:97], v15 offset:13312
ds_read_b64_tr_b16 v[98:99], v15 offset:13568
buffer_load_dwordx4 v2, s[24:27], s87 offen offset:0 lds
v_accvgpr_write_b32 a210, v64
v_accvgpr_write_b32 a211, v66
v_accvgpr_read_b32 v24, a64
v_mfma_f32_32x32x16_bf16 a[32:47], v[100:103], v[128:131], a[32:47]
ds_read_b64_tr_b16 v[100:101], v15 offset:15360
ds_read_b64_tr_b16 v[102:103], v15 offset:15616
s_mov_b32 s7, 147456
buffer_store_dwordx4 a[200:203], v21, s[36:39], s7 offen offset:2048 sc1
s_mov_b32 s7, 147456
buffer_store_dwordx4 a[204:207], v21, s[36:39], s7 offen offset:3072 sc1
s_waitcnt lgkmcnt(8)
v_mfma_f32_32x32x16_bf16 a[0:15], v[104:107], v[132:135], a[0:15]
s_waitcnt vmcnt(27)
s_barrier
ds_read_b64_tr_b16 v[104:105], v15 offset:16384
ds_read_b64_tr_b16 v[106:107], v15 offset:16640
s_mov_b32 s7, 163840
buffer_store_dwordx4 a[208:211], v21, s[36:39], s7 offen offset:0 sc1
v_mfma_f32_32x32x16_bf16 a[32:47], v[108:111], v[132:135], a[32:47]
ds_read_b64_tr_b16 v[108:109], v15 offset:18432
ds_read_b64_tr_b16 v[110:111], v15 offset:18688
v_accvgpr_read_b32 v25, a65
v_accvgpr_read_b32 v26, a66
v_accvgpr_read_b32 v27, a67
s_add_u32 m0, s40, 57344
s_waitcnt lgkmcnt(8)
v_mfma_f32_32x32x16_bf16 a[0:15], v[88:91], v[136:139], a[0:15]
ds_read_b64_tr_b16 v[88:89], v15 offset:17408
ds_read_b64_tr_b16 v[90:91], v15 offset:17664
buffer_load_dwordx4 v2, s[24:27], s88 offen offset:0 lds
v_accvgpr_read_b32 v28, a96
v_accvgpr_read_b32 v29, a97
v_accvgpr_read_b32 v30, a98
v_mfma_f32_32x32x16_bf16 a[32:47], v[92:95], v[136:139], a[32:47]
ds_read_b64_tr_b16 v[92:93], v15 offset:19456
ds_read_b64_tr_b16 v[94:95], v15 offset:19712
v_accvgpr_read_b32 v31, a99
v_max_f32 v24, 0, v24
v_max_f32 v25, 0, v25
v_max_f32 v26, 0, v26
s_waitcnt lgkmcnt(8)
v_mfma_f32_32x32x16_bf16 a[0:15], v[96:99], v[140:143], a[0:15]
ds_read_b64_tr_b16 v[96:97], v15 offset:20480
ds_read_b64_tr_b16 v[98:99], v15 offset:20736
v_max_f32 v27, 0, v27
v_mul_f32 v24, v24, v28
v_mul_f32 v25, v25, v29
v_mul_f32 v26, v26, v30
v_mfma_f32_32x32x16_bf16 a[32:47], v[100:103], v[140:143], a[32:47]
ds_read_b64_tr_b16 v[100:101], v15 offset:22528
ds_read_b64_tr_b16 v[102:103], v15 offset:22784
v_mul_f32 v27, v27, v31
v_cvt_pk_bf16_f32 v24, v24, v25
v_cvt_pk_bf16_f32 v26, v26, v27
s_add_u32 m0, s40, 61440
s_waitcnt lgkmcnt(8)
v_mfma_f32_32x32x16_bf16 a[0:15], v[104:107], v[144:147], a[0:15]
ds_read_b64_tr_b16 v[104:105], v15 offset:21504
ds_read_b64_tr_b16 v[106:107], v15 offset:21760
buffer_load_dwordx4 v2, s[24:27], s89 offen offset:0 lds
v_accvgpr_write_b32 a176, v24
v_accvgpr_write_b32 a177, v26
v_accvgpr_read_b32 v32, a68
v_mfma_f32_32x32x16_bf16 a[32:47], v[108:111], v[144:147], a[32:47]
ds_read_b64_tr_b16 v[108:109], v15 offset:23552
ds_read_b64_tr_b16 v[110:111], v15 offset:23808
v_accvgpr_read_b32 v33, a69
v_accvgpr_read_b32 v34, a70
v_accvgpr_read_b32 v35, a71
v_accvgpr_read_b32 v36, a100
s_waitcnt lgkmcnt(8)
v_mfma_f32_32x32x16_bf16 a[0:15], v[88:91], v[148:151], a[0:15]
s_waitcnt vmcnt(28)
s_barrier
ds_read_b64_tr_b16 v[88:89], v15 offset:24576
ds_read_b64_tr_b16 v[90:91], v15 offset:24832
v_accvgpr_read_b32 v37, a101
v_accvgpr_read_b32 v38, a102
v_mfma_f32_32x32x16_bf16 a[32:47], v[92:95], v[148:151], a[32:47]
ds_read_b64_tr_b16 v[92:93], v15 offset:26624
ds_read_b64_tr_b16 v[94:95], v15 offset:26880
v_accvgpr_read_b32 v39, a103
v_max_f32 v32, 0, v32
v_max_f32 v33, 0, v33
s_add_u32 m0, s40, 65536
s_waitcnt lgkmcnt(8)
v_mfma_f32_32x32x16_bf16 a[0:15], v[96:99], v[152:155], a[0:15]
ds_read_b64_tr_b16 v[96:97], v15 offset:25600
ds_read_b64_tr_b16 v[98:99], v15 offset:25856
buffer_load_dwordx4 v2, s[24:27], s90 offen offset:0 lds
v_max_f32 v34, 0, v34
v_max_f32 v35, 0, v35
v_mul_f32 v32, v32, v36
v_mfma_f32_32x32x16_bf16 a[32:47], v[100:103], v[152:155], a[32:47]
ds_read_b64_tr_b16 v[100:101], v15 offset:27648
ds_read_b64_tr_b16 v[102:103], v15 offset:27904
v_mul_f32 v33, v33, v37
v_mul_f32 v34, v34, v38
v_mul_f32 v35, v35, v39
v_cvt_pk_bf16_f32 v32, v32, v33
s_waitcnt lgkmcnt(8)
v_mfma_f32_32x32x16_bf16 a[0:15], v[104:107], v[156:159], a[0:15]
ds_read_b64_tr_b16 v[104:105], v15 offset:28672
ds_read_b64_tr_b16 v[106:107], v15 offset:28928
v_cvt_pk_bf16_f32 v34, v34, v35
v_accvgpr_write_b32 a178, v32
v_accvgpr_write_b32 a179, v34
v_mfma_f32_32x32x16_bf16 a[32:47], v[108:111], v[156:159], a[32:47]
ds_read_b64_tr_b16 v[108:109], v15 offset:30720
ds_read_b64_tr_b16 v[110:111], v15 offset:30976
s_mov_b32 s6, 131072
buffer_store_dwordx4 a[176:179], v21, s[36:39], s6 offen offset:0 sc1
v_accvgpr_read_b32 v24, a72
s_add_u32 m0, s40, 69632
s_waitcnt lgkmcnt(8)
v_mfma_f32_32x32x16_bf16 a[0:15], v[88:91], v[160:163], a[0:15]
ds_read_b64_tr_b16 v[88:89], v15 offset:29696
ds_read_b64_tr_b16 v[90:91], v15 offset:29952
buffer_load_dwordx4 v2, s[24:27], s91 offen offset:0 lds
v_accvgpr_read_b32 v25, a73
v_accvgpr_read_b32 v26, a74
v_accvgpr_read_b32 v27, a75
v_mfma_f32_32x32x16_bf16 a[32:47], v[92:95], v[160:163], a[32:47]
ds_read_b64_tr_b16 v[92:93], v15 offset:31744
ds_read_b64_tr_b16 v[94:95], v15 offset:32000
v_accvgpr_read_b32 v28, a104
v_accvgpr_read_b32 v29, a105
v_accvgpr_read_b32 v30, a106
v_accvgpr_read_b32 v31, a107
s_waitcnt lgkmcnt(8)
v_mfma_f32_32x32x16_bf16 a[0:15], v[96:99], v[164:167], a[0:15]
s_waitcnt vmcnt(29)
s_barrier
ds_read_b64_tr_b16 v[96:97], v15 offset:32768
ds_read_b64_tr_b16 v[98:99], v15 offset:33024
v_max_f32 v24, 0, v24
v_max_f32 v25, 0, v25
v_mfma_f32_32x32x16_bf16 a[32:47], v[100:103], v[164:167], a[32:47]
ds_read_b64_tr_b16 v[100:101], v15 offset:34816
ds_read_b64_tr_b16 v[102:103], v15 offset:35072
v_max_f32 v26, 0, v26
v_max_f32 v27, 0, v27
v_mul_f32 v24, v24, v28
s_add_u32 m0, s40, 73600
s_waitcnt lgkmcnt(8)
v_mfma_f32_32x32x16_bf16 a[0:15], v[104:107], v[168:171], a[0:15]
ds_read_b64_tr_b16 v[104:105], v15 offset:33792
ds_read_b64_tr_b16 v[106:107], v15 offset:34048
buffer_load_dwordx4 v2, s[24:27], s84 offen offset:128 lds
v_mul_f32 v25, v25, v29
v_mul_f32 v26, v26, v30
v_mul_f32 v27, v27, v31
v_mfma_f32_32x32x16_bf16 a[32:47], v[108:111], v[168:171], a[32:47]
ds_read_b64_tr_b16 v[108:109], v15 offset:35840
ds_read_b64_tr_b16 v[110:111], v15 offset:36096
v_cvt_pk_bf16_f32 v24, v24, v25
v_cvt_pk_bf16_f32 v26, v26, v27
v_accvgpr_write_b32 a180, v24
v_accvgpr_write_b32 a181, v26
s_waitcnt lgkmcnt(8)
v_mfma_f32_32x32x16_bf16 a[0:15], v[88:91], v[172:175], a[0:15]
ds_read_b64_tr_b16 v[88:89], v15 offset:36864
ds_read_b64_tr_b16 v[90:91], v15 offset:37120
v_accvgpr_read_b32 v32, a76
v_accvgpr_read_b32 v33, a77
v_accvgpr_read_b32 v34, a78
v_accvgpr_read_b32 v35, a79
v_mfma_f32_32x32x16_bf16 a[32:47], v[92:95], v[172:175], a[32:47]
ds_read_b64_tr_b16 v[92:93], v15 offset:38912
ds_read_b64_tr_b16 v[94:95], v15 offset:39168
v_accvgpr_read_b32 v36, a108
v_accvgpr_read_b32 v37, a109
v_accvgpr_read_b32 v38, a110
s_add_u32 m0, s40, 77696
s_waitcnt lgkmcnt(8)
v_mfma_f32_32x32x16_bf16 a[0:15], v[96:99], v[176:179], a[0:15]
ds_read_b64_tr_b16 v[96:97], v15 offset:37888
ds_read_b64_tr_b16 v[98:99], v15 offset:38144
buffer_load_dwordx4 v2, s[24:27], s85 offen offset:128 lds
v_accvgpr_read_b32 v39, a111
v_max_f32 v32, 0, v32
v_max_f32 v33, 0, v33
v_mfma_f32_32x32x16_bf16 a[32:47], v[100:103], v[176:179], a[32:47]
ds_read_b64_tr_b16 v[100:101], v15 offset:39936
ds_read_b64_tr_b16 v[102:103], v15 offset:40192
v_max_f32 v34, 0, v34
v_max_f32 v35, 0, v35
v_mul_f32 v32, v32, v36
v_mul_f32 v33, v33, v37
s_waitcnt lgkmcnt(8)
v_mfma_f32_32x32x16_bf16 a[0:15], v[104:107], v[180:183], a[0:15]
s_waitcnt vmcnt(29)
s_barrier
ds_read_b64_tr_b16 v[104:105], v15 offset:40960
ds_read_b64_tr_b16 v[106:107], v15 offset:41216
v_mul_f32 v34, v34, v38
v_mul_f32 v35, v35, v39
v_mfma_f32_32x32x16_bf16 a[32:47], v[108:111], v[180:183], a[32:47]
ds_read_b64_tr_b16 v[108:109], v15 offset:43008
ds_read_b64_tr_b16 v[110:111], v15 offset:43264
v_cvt_pk_bf16_f32 v32, v32, v33
v_cvt_pk_bf16_f32 v34, v34, v35
v_accvgpr_write_b32 a182, v32
s_add_u32 m0, s40, 81792
s_waitcnt lgkmcnt(8)
v_mfma_f32_32x32x16_bf16 a[0:15], v[88:91], v[184:187], a[0:15]
ds_read_b64_tr_b16 v[88:89], v15 offset:41984
ds_read_b64_tr_b16 v[90:91], v15 offset:42240
buffer_load_dwordx4 v2, s[24:27], s86 offen offset:128 lds
v_accvgpr_write_b32 a183, v34
s_mov_b32 s6, 131072
buffer_store_dwordx4 a[180:183], v21, s[36:39], s6 offen offset:1024 sc1
v_mfma_f32_32x32x16_bf16 a[32:47], v[92:95], v[184:187], a[32:47]
ds_read_b64_tr_b16 v[92:93], v15 offset:44032
ds_read_b64_tr_b16 v[94:95], v15 offset:44288
v_accvgpr_read_b32 v24, a80
v_accvgpr_read_b32 v25, a81
v_accvgpr_read_b32 v26, a82
v_accvgpr_read_b32 v27, a83
s_waitcnt lgkmcnt(8)
v_mfma_f32_32x32x16_bf16 a[0:15], v[96:99], v[188:191], a[0:15]
ds_read_b64_tr_b16 v[96:97], v15 offset:45056
ds_read_b64_tr_b16 v[98:99], v15 offset:45312
v_accvgpr_read_b32 v28, a112
v_accvgpr_read_b32 v29, a113
v_accvgpr_read_b32 v30, a114
v_accvgpr_read_b32 v31, a115
v_mfma_f32_32x32x16_bf16 a[32:47], v[100:103], v[188:191], a[32:47]
ds_read_b64_tr_b16 v[100:101], v15 offset:47104
ds_read_b64_tr_b16 v[102:103], v15 offset:47360
v_max_f32 v24, 0, v24
v_max_f32 v25, 0, v25
v_max_f32 v26, 0, v26
s_add_u32 m0, s40, 85888
s_waitcnt lgkmcnt(8)
v_mfma_f32_32x32x16_bf16 a[0:15], v[104:107], v[192:195], a[0:15]
ds_read_b64_tr_b16 v[104:105], v15 offset:46080
ds_read_b64_tr_b16 v[106:107], v15 offset:46336
buffer_load_dwordx4 v2, s[24:27], s87 offen offset:128 lds
v_max_f32 v27, 0, v27
v_mul_f32 v24, v24, v28
v_mul_f32 v25, v25, v29
v_mfma_f32_32x32x16_bf16 a[32:47], v[108:111], v[192:195], a[32:47]
ds_read_b64_tr_b16 v[108:109], v15 offset:48128
ds_read_b64_tr_b16 v[110:111], v15 offset:48384
v_mul_f32 v26, v26, v30
v_mul_f32 v27, v27, v31
v_cvt_pk_bf16_f32 v24, v24, v25
v_cvt_pk_bf16_f32 v26, v26, v27
s_waitcnt lgkmcnt(8)
v_mfma_f32_32x32x16_bf16 a[0:15], v[88:91], v[196:199], a[0:15]
s_waitcnt vmcnt(30)
s_barrier
ds_read_b64_tr_b16 v[88:89], v15 offset:49152
ds_read_b64_tr_b16 v[90:91], v15 offset:49408
v_accvgpr_write_b32 a184, v24
v_accvgpr_write_b32 a185, v26
v_mfma_f32_32x32x16_bf16 a[32:47], v[92:95], v[196:199], a[32:47]
ds_read_b64_tr_b16 v[92:93], v15 offset:51200
ds_read_b64_tr_b16 v[94:95], v15 offset:51456
v_accvgpr_read_b32 v32, a84
v_accvgpr_read_b32 v33, a85
v_accvgpr_read_b32 v34, a86
s_add_u32 m0, s40, 89984
s_waitcnt lgkmcnt(8)
v_mfma_f32_32x32x16_bf16 a[0:15], v[96:99], v[200:203], a[0:15]
ds_read_b64_tr_b16 v[96:97], v15 offset:50176
ds_read_b64_tr_b16 v[98:99], v15 offset:50432
buffer_load_dwordx4 v2, s[24:27], s88 offen offset:128 lds
v_accvgpr_read_b32 v35, a87
v_accvgpr_read_b32 v36, a116
v_accvgpr_read_b32 v37, a117
v_mfma_f32_32x32x16_bf16 a[32:47], v[100:103], v[200:203], a[32:47]
ds_read_b64_tr_b16 v[100:101], v15 offset:52224
ds_read_b64_tr_b16 v[102:103], v15 offset:52480
v_accvgpr_read_b32 v38, a118
v_accvgpr_read_b32 v39, a119
v_max_f32 v32, 0, v32
v_max_f32 v33, 0, v33
s_waitcnt lgkmcnt(8)
v_mfma_f32_32x32x16_bf16 a[0:15], v[104:107], v[204:207], a[0:15]
ds_read_b64_tr_b16 v[104:105], v15 offset:53248
ds_read_b64_tr_b16 v[106:107], v15 offset:53504
v_max_f32 v34, 0, v34
v_max_f32 v35, 0, v35
v_mul_f32 v32, v32, v36
v_mul_f32 v33, v33, v37
v_mfma_f32_32x32x16_bf16 a[32:47], v[108:111], v[204:207], a[32:47]
ds_read_b64_tr_b16 v[108:109], v15 offset:55296
ds_read_b64_tr_b16 v[110:111], v15 offset:55552
v_mul_f32 v34, v34, v38
v_mul_f32 v35, v35, v39
v_cvt_pk_bf16_f32 v32, v32, v33
s_add_u32 m0, s40, 94080
s_waitcnt lgkmcnt(8)
v_mfma_f32_32x32x16_bf16 a[0:15], v[88:91], v[208:211], a[0:15]
ds_read_b64_tr_b16 v[88:89], v15 offset:54272
ds_read_b64_tr_b16 v[90:91], v15 offset:54528
buffer_load_dwordx4 v2, s[24:27], s89 offen offset:128 lds
v_cvt_pk_bf16_f32 v34, v34, v35
v_accvgpr_write_b32 a186, v32
v_accvgpr_write_b32 a187, v34
v_mfma_f32_32x32x16_bf16 a[32:47], v[92:95], v[208:211], a[32:47]
ds_read_b64_tr_b16 v[92:93], v15 offset:56320
ds_read_b64_tr_b16 v[94:95], v15 offset:56576
s_mov_b32 s6, 131072
buffer_store_dwordx4 a[184:187], v21, s[36:39], s6 offen offset:2048 sc1
v_accvgpr_read_b32 v24, a88
v_accvgpr_read_b32 v25, a89
s_waitcnt lgkmcnt(8)
v_mfma_f32_32x32x16_bf16 a[0:15], v[96:99], v[212:215], a[0:15]
s_waitcnt vmcnt(31)
s_barrier
ds_read_b64_tr_b16 v[96:97], v15 offset:57344
ds_read_b64_tr_b16 v[98:99], v15 offset:57600
v_mov_b32 v4, 1
s_waitcnt vmcnt(20)
s_barrier
buffer_store_byte v4, v0, s[36:39], s1 offen sc1
v_mfma_f32_32x32x16_bf16 a[32:47], v[100:103], v[212:215], a[32:47]
ds_read_b64_tr_b16 v[100:101], v15 offset:59392
ds_read_b64_tr_b16 v[102:103], v15 offset:59648
v_accvgpr_read_b32 v26, a90
v_accvgpr_read_b32 v27, a91
v_accvgpr_read_b32 v28, a120
s_add_u32 m0, s40, 98176
s_waitcnt lgkmcnt(8)
v_mfma_f32_32x32x16_bf16 a[0:15], v[104:107], v[216:219], a[0:15]
ds_read_b64_tr_b16 v[104:105], v15 offset:58368
ds_read_b64_tr_b16 v[106:107], v15 offset:58624
buffer_load_dwordx4 v2, s[24:27], s90 offen offset:128 lds
v_accvgpr_read_b32 v29, a121
v_accvgpr_read_b32 v30, a122
v_accvgpr_read_b32 v31, a123
v_mfma_f32_32x32x16_bf16 a[32:47], v[108:111], v[216:219], a[32:47]
ds_read_b64_tr_b16 v[108:109], v15 offset:60416
ds_read_b64_tr_b16 v[110:111], v15 offset:60672
v_max_f32 v24, 0, v24
v_max_f32 v25, 0, v25
v_max_f32 v26, 0, v26
v_max_f32 v27, 0, v27
s_waitcnt lgkmcnt(8)
v_mfma_f32_32x32x16_bf16 a[0:15], v[88:91], v[220:223], a[0:15]
ds_read_b64_tr_b16 v[88:89], v15 offset:61440
ds_read_b64_tr_b16 v[90:91], v15 offset:61696
v_mul_f32 v24, v24, v28
v_mul_f32 v25, v25, v29
v_mul_f32 v26, v26, v30
v_mul_f32 v27, v27, v31
v_mfma_f32_32x32x16_bf16 a[32:47], v[92:95], v[220:223], a[32:47]
ds_read_b64_tr_b16 v[92:93], v15 offset:63488
ds_read_b64_tr_b16 v[94:95], v15 offset:63744
v_cvt_pk_bf16_f32 v24, v24, v25
v_cvt_pk_bf16_f32 v26, v26, v27
v_accvgpr_write_b32 a188, v24
s_add_u32 m0, s40, 102272
s_waitcnt lgkmcnt(8)
v_mfma_f32_32x32x16_bf16 a[0:15], v[96:99], v[224:227], a[0:15]
ds_read_b64_tr_b16 v[96:97], v15 offset:62464
ds_read_b64_tr_b16 v[98:99], v15 offset:62720
buffer_load_dwordx4 v2, s[24:27], s91 offen offset:128 lds
v_accvgpr_write_b32 a189, v26
v_accvgpr_read_b32 v32, a92
v_accvgpr_read_b32 v33, a93
v_mfma_f32_32x32x16_bf16 a[32:47], v[100:103], v[224:227], a[32:47]
ds_read_b64_tr_b16 v[100:101], v15 offset:64512
ds_read_b64_tr_b16 v[102:103], v15 offset:64768
v_accvgpr_read_b32 v34, a94
v_accvgpr_read_b32 v35, a95
v_accvgpr_read_b32 v36, a124
v_accvgpr_read_b32 v37, a125
s_waitcnt lgkmcnt(8)
v_mfma_f32_32x32x16_bf16 a[0:15], v[104:107], v[228:231], a[0:15]
s_barrier
ds_read_b64_tr_b16 v[104:105], v14 offset:0
ds_read_b64_tr_b16 v[106:107], v14 offset:256
v_accvgpr_read_b32 v38, a126
v_accvgpr_read_b32 v39, a127
v_max_f32 v32, 0, v32
v_mfma_f32_32x32x16_bf16 a[32:47], v[108:111], v[228:231], a[32:47]
ds_read_b64_tr_b16 v[108:109], v14 offset:2048
ds_read_b64_tr_b16 v[110:111], v14 offset:2304
v_max_f32 v33, 0, v33
v_max_f32 v34, 0, v34
v_max_f32 v35, 0, v35
s_add_u32 m0, s40, 106496
s_waitcnt lgkmcnt(8)
v_mfma_f32_32x32x16_bf16 a[0:15], v[88:91], v[232:235], a[0:15]
ds_read_b64_tr_b16 v[88:89], v14 offset:1024
ds_read_b64_tr_b16 v[90:91], v14 offset:1280
buffer_load_dwordx4 v6, s[24:27], 0 offen offset:0 lds
v_mul_f32 v32, v32, v36
v_mul_f32 v33, v33, v37
v_mul_f32 v34, v34, v38
v_mfma_f32_32x32x16_bf16 a[32:47], v[92:95], v[232:235], a[32:47]
ds_read_b64_tr_b16 v[92:93], v14 offset:3072
ds_read_b64_tr_b16 v[94:95], v14 offset:3328
v_mul_f32 v35, v35, v39
v_cvt_pk_bf16_f32 v32, v32, v33
v_cvt_pk_bf16_f32 v34, v34, v35
v_accvgpr_write_b32 a190, v32
s_waitcnt lgkmcnt(8)
v_mfma_f32_32x32x16_bf16 a[0:15], v[96:99], v[236:239], a[0:15]
ds_read_b64_tr_b16 v[96:97], v14 offset:4096
ds_read_b64_tr_b16 v[98:99], v14 offset:4352
v_accvgpr_write_b32 a191, v34
s_mov_b32 s6, 131072
buffer_store_dwordx4 a[188:191], v21, s[36:39], s6 offen offset:3072 sc1
v_mfma_f32_32x32x16_bf16 a[32:47], v[100:103], v[236:239], a[32:47]
ds_read_b64_tr_b16 v[100:101], v14 offset:6144
ds_read_b64_tr_b16 v[102:103], v14 offset:6400
s_add_u32 m0, s40, 110592
s_waitcnt lgkmcnt(8)
v_mfma_f32_32x32x16_bf16 a[0:15], v[104:107], v[240:243], a[0:15]
ds_read_b64_tr_b16 v[104:105], v14 offset:5120
ds_read_b64_tr_b16 v[106:107], v14 offset:5376
buffer_load_dwordx4 v7, s[16:19], 0 offen offset:0 lds
v_mfma_f32_32x32x16_bf16 a[32:47], v[108:111], v[240:243], a[32:47]
ds_read_b64_tr_b16 v[108:109], v14 offset:7168
ds_read_b64_tr_b16 v[110:111], v14 offset:7424
s_waitcnt lgkmcnt(8)
v_mfma_f32_32x32x16_bf16 a[0:15], v[88:91], v[244:247], a[0:15]
s_barrier
ds_read_b64_tr_b16 v[88:89], v8 offset:8192
ds_read_b64_tr_b16 v[90:91], v8 offset:8704
v_mfma_f32_32x32x16_bf16 a[32:47], v[92:95], v[244:247], a[32:47]
ds_read_b64_tr_b16 v[92:93], v11 offset:8192
ds_read_b64_tr_b16 v[94:95], v11 offset:8704
s_add_u32 m0, s40, 114688
s_waitcnt lgkmcnt(8)
v_mfma_f32_32x32x16_bf16 a[0:15], v[96:99], v[248:251], a[0:15]
ds_read_b64_tr_b16 v[96:97], v8 offset:10240
ds_read_b64_tr_b16 v[98:99], v8 offset:10752
buffer_load_dwordx4 v3, s[24:27], 0 offen offset:0 lds
v_mfma_f32_32x32x16_bf16 a[32:47], v[100:103], v[248:251], a[32:47]
ds_read_b64_tr_b16 v[100:101], v11 offset:10240
ds_read_b64_tr_b16 v[102:103], v11 offset:10752
s_waitcnt lgkmcnt(8)
v_mfma_f32_32x32x16_bf16 a[0:15], v[104:107], v[252:255], a[0:15]
ds_read_b64_tr_b16 v[104:105], v8 offset:12288
ds_read_b64_tr_b16 v[106:107], v8 offset:12800
v_mfma_f32_32x32x16_bf16 a[32:47], v[108:111], v[252:255], a[32:47]
ds_read_b64_tr_b16 v[108:109], v11 offset:12288
ds_read_b64_tr_b16 v[110:111], v11 offset:12800
s_add_u32 m0, s40, 118784
s_waitcnt lgkmcnt(8)
v_mfma_f32_32x32x16_bf16 v[208:223], v[88:91], a[128:131], 0
ds_read_b64_tr_b16 v[88:89], v8 offset:14336
ds_read_b64_tr_b16 v[90:91], v8 offset:14848
buffer_load_dwordx4 v10, s[16:19], 0 offen offset:0 lds
v_mfma_f32_32x32x16_bf16 v[224:239], v[92:95], a[128:131], 0
ds_read_b64_tr_b16 v[92:93], v11 offset:14336
ds_read_b64_tr_b16 v[94:95], v11 offset:14848
s_waitcnt lgkmcnt(8)
v_mfma_f32_32x32x16_bf16 v[208:223], v[96:99], a[132:135], v[208:223]
s_barrier
ds_read_b64_tr_b16 v[96:97], v8 offset:16384
ds_read_b64_tr_b16 v[98:99], v8 offset:16896
v_accvgpr_read_b32 v24, a0
v_accvgpr_read_b32 v25, a1
v_accvgpr_read_b32 v26, a2
v_mfma_f32_32x32x16_bf16 v[224:239], v[100:103], a[132:135], v[224:239]
ds_read_b64_tr_b16 v[100:101], v11 offset:16384
ds_read_b64_tr_b16 v[102:103], v11 offset:16896
v_accvgpr_read_b32 v27, a3
v_accvgpr_read_b32 v28, a32
v_accvgpr_read_b32 v29, a33
s_add_u32 m0, s40, 122752
s_waitcnt lgkmcnt(8)
v_mfma_f32_32x32x16_bf16 v[208:223], v[104:107], a[136:139], v[208:223]
ds_read_b64_tr_b16 v[104:105], v8 offset:18432
ds_read_b64_tr_b16 v[106:107], v8 offset:18944
buffer_load_dwordx4 v3, s[24:27], 0 offen offset:128 lds
v_accvgpr_read_b32 v30, a34
v_accvgpr_read_b32 v31, a35
v_max_f32 v24, 0, v24
v_mfma_f32_32x32x16_bf16 v[224:239], v[108:111], a[136:139], v[224:239]
ds_read_b64_tr_b16 v[108:109], v11 offset:18432
ds_read_b64_tr_b16 v[110:111], v11 offset:18944
v_max_f32 v25, 0, v25
v_max_f32 v26, 0, v26
v_max_f32 v27, 0, v27
v_mul_f32 v24, v24, v28
s_waitcnt lgkmcnt(8)
v_mfma_f32_32x32x16_bf16 v[208:223], v[88:91], a[140:143], v[208:223]
ds_read_b64_tr_b16 v[88:89], v8 offset:20480
ds_read_b64_tr_b16 v[90:91], v8 offset:20992
v_mul_f32 v25, v25, v29
v_mul_f32 v26, v26, v30
v_mul_f32 v27, v27, v31
v_cvt_pk_bf16_f32 v24, v24, v25
v_mfma_f32_32x32x16_bf16 v[224:239], v[92:95], a[140:143], v[224:239]
ds_read_b64_tr_b16 v[92:93], v11 offset:20480
ds_read_b64_tr_b16 v[94:95], v11 offset:20992
v_cvt_pk_bf16_f32 v26, v26, v27
v_accvgpr_write_b32 a192, v24
v_accvgpr_write_b32 a193, v26
s_add_u32 m0, s40, 126848
s_waitcnt lgkmcnt(8)
v_mfma_f32_32x32x16_bf16 v[208:223], v[96:99], a[144:147], v[208:223]
ds_read_b64_tr_b16 v[96:97], v8 offset:22528
ds_read_b64_tr_b16 v[98:99], v8 offset:23040
buffer_load_dwordx4 v10, s[16:19], 0 offen offset:128 lds
v_accvgpr_read_b32 v32, a4
v_accvgpr_read_b32 v33, a5
v_accvgpr_read_b32 v34, a6
v_mfma_f32_32x32x16_bf16 v[224:239], v[100:103], a[144:147], v[224:239]
ds_read_b64_tr_b16 v[100:101], v11 offset:22528
ds_read_b64_tr_b16 v[102:103], v11 offset:23040
v_accvgpr_read_b32 v35, a7
v_accvgpr_read_b32 v36, a36
v_accvgpr_read_b32 v37, a37
v_accvgpr_read_b32 v38, a38
s_waitcnt lgkmcnt(8)
v_mfma_f32_32x32x16_bf16 v[208:223], v[104:107], a[148:151], v[208:223]
s_barrier
ds_read_b64_tr_b16 v[104:105], v8 offset:24576
ds_read_b64_tr_b16 v[106:107], v8 offset:25088
v_accvgpr_read_b32 v39, a39
v_max_f32 v32, 0, v32
v_max_f32 v33, 0, v33
v_mfma_f32_32x32x16_bf16 v[224:239], v[108:111], a[148:151], v[224:239]
ds_read_b64_tr_b16 v[108:109], v11 offset:24576
ds_read_b64_tr_b16 v[110:111], v11 offset:25088
v_max_f32 v34, 0, v34
v_max_f32 v35, 0, v35
s_mov_b32 m0, s40
s_add_u32 s41, s84, 256
s_waitcnt lgkmcnt(8)
v_mfma_f32_32x32x16_bf16 v[208:223], v[88:91], a[152:155], v[208:223]
ds_read_b64_tr_b16 v[88:89], v8 offset:26624
ds_read_b64_tr_b16 v[90:91], v8 offset:27136
buffer_load_dwordx4 v2, s[24:27], s41 offen lds
v_mul_f32 v32, v32, v36
v_mul_f32 v33, v33, v37
v_mul_f32 v34, v34, v38
v_mfma_f32_32x32x16_bf16 v[224:239], v[92:95], a[152:155], v[224:239]
ds_read_b64_tr_b16 v[92:93], v11 offset:26624
ds_read_b64_tr_b16 v[94:95], v11 offset:27136
v_mul_f32 v35, v35, v39
v_cvt_pk_bf16_f32 v32, v32, v33
v_cvt_pk_bf16_f32 v34, v34, v35
v_accvgpr_write_b32 a194, v32
s_waitcnt lgkmcnt(8)
v_mfma_f32_32x32x16_bf16 v[208:223], v[96:99], a[156:159], v[208:223]
ds_read_b64_tr_b16 v[96:97], v8 offset:28672
ds_read_b64_tr_b16 v[98:99], v8 offset:29184
v_accvgpr_write_b32 a195, v34
s_mov_b32 s6, 147456
buffer_store_dwordx4 a[192:195], v21, s[36:39], s6 offen offset:0 sc1
v_accvgpr_read_b32 v24, a8
v_mfma_f32_32x32x16_bf16 v[224:239], v[100:103], a[156:159], v[224:239]
ds_read_b64_tr_b16 v[100:101], v11 offset:28672
ds_read_b64_tr_b16 v[102:103], v11 offset:29184
v_accvgpr_read_b32 v25, a9
v_accvgpr_read_b32 v26, a10
v_accvgpr_read_b32 v27, a11
s_add_u32 m0, s40, 3840
s_waitcnt lgkmcnt(8)
v_mfma_f32_32x32x16_bf16 v[208:223], v[104:107], a[160:163], v[208:223]
ds_read_b64_tr_b16 v[104:105], v8 offset:30720
ds_read_b64_tr_b16 v[106:107], v8 offset:31232
buffer_load_dwordx4 v2, s[24:27], s85 offen offset:256 lds
v_accvgpr_read_b32 v28, a40
v_accvgpr_read_b32 v29, a41
v_accvgpr_read_b32 v30, a42
v_mfma_f32_32x32x16_bf16 v[224:239], v[108:111], a[160:163], v[224:239]
ds_read_b64_tr_b16 v[108:109], v11 offset:30720
ds_read_b64_tr_b16 v[110:111], v11 offset:31232
v_accvgpr_read_b32 v31, a43
v_max_f32 v24, 0, v24
v_max_f32 v25, 0, v25
v_max_f32 v26, 0, v26
s_waitcnt lgkmcnt(8)
v_mfma_f32_32x32x16_bf16 v[208:223], v[88:91], a[164:167], v[208:223]
s_barrier
ds_read_b64_tr_b16 v[88:89], v8 offset:32768
ds_read_b64_tr_b16 v[90:91], v8 offset:33280
v_max_f32 v27, 0, v27
v_mul_f32 v24, v24, v28
v_mul_f32 v25, v25, v29
v_mfma_f32_32x32x16_bf16 v[224:239], v[92:95], a[164:167], v[224:239]
ds_read_b64_tr_b16 v[92:93], v11 offset:32768
ds_read_b64_tr_b16 v[94:95], v11 offset:33280
v_mul_f32 v26, v26, v30
v_mul_f32 v27, v27, v31
v_cvt_pk_bf16_f32 v24, v24, v25
s_add_u32 m0, s40, 7936
s_waitcnt lgkmcnt(8)
v_mfma_f32_32x32x16_bf16 v[208:223], v[96:99], a[168:171], v[208:223]
ds_read_b64_tr_b16 v[96:97], v8 offset:34816
ds_read_b64_tr_b16 v[98:99], v8 offset:35328
buffer_load_dwordx4 v2, s[24:27], s86 offen offset:256 lds
s_lshl_b32 s7, s5, 4
s_xor_b32 s45, s4, 1
s_add_u32 s7, s7, s45
v_mfma_f32_32x32x16_bf16 v[224:239], v[100:103], a[168:171], v[224:239]
ds_read_b64_tr_b16 v[100:101], v11 offset:34816
ds_read_b64_tr_b16 v[102:103], v11 offset:35328
v_mov_b32 v14, s7
s_sub_u32 s45, s45, s4
s_mul_i32 s45, s45, 180224
v_add_u32 v15, s45, v21
s_waitcnt lgkmcnt(8)
v_mfma_f32_32x32x16_bf16 v[208:223], v[104:107], a[172:175], v[208:223]
ds_read_b64_tr_b16 v[104:105], v8 offset:36864
ds_read_b64_tr_b16 v[106:107], v8 offset:37376
buffer_load_ubyte v4, v14, s[36:39], s1 offen sc1
v_lshrrev_b32 v60, 4, v1
v_bfe_u32 v61, v1, 3, 1
v_and_b32 v62, 7, v1
v_mfma_f32_32x32x16_bf16 v[224:239], v[108:111], a[172:175], v[224:239]
ds_read_b64_tr_b16 v[108:109], v11 offset:36864
ds_read_b64_tr_b16 v[110:111], v11 offset:37376
v_and_b32 v63, 15, v1
v_mul_u32_u24 v40, 180224, v60
v_lshl_add_u32 v40, v61, 10, v40
s_add_u32 m0, s40, 12032
s_waitcnt lgkmcnt(8)
v_mfma_f32_32x32x16_bf16 v[208:223], v[88:91], a[176:179], v[208:223]
ds_read_b64_tr_b16 v[88:89], v8 offset:38912
ds_read_b64_tr_b16 v[90:91], v8 offset:39424
buffer_load_dwordx4 v2, s[24:27], s87 offen offset:256 lds
v_lshl_add_u32 v40, v62, 4, v40
s_mul_i32 s7, s5, 2883584
s_lshr_b32 s45, s4, 2
v_mfma_f32_32x32x16_bf16 v[224:239], v[92:95], a[176:179], v[224:239]
ds_read_b64_tr_b16 v[92:93], v11 offset:38912
ds_read_b64_tr_b16 v[94:95], v11 offset:39424
s_lshl_b32 s45, s45, 12
s_add_u32 s7, s7, s45
s_and_b32 s45, s3, 1
s_lshl_b32 s45, s45, 11
s_waitcnt lgkmcnt(8)
v_mfma_f32_32x32x16_bf16 v[208:223], v[96:99], a[180:183], v[208:223]
s_waitcnt vmcnt(34)
s_barrier
ds_read_b64_tr_b16 v[96:97], v8 offset:40960
ds_read_b64_tr_b16 v[98:99], v8 offset:41472
s_add_u32 s7, s7, s45
s_lshr_b32 s45, s3, 1
v_mfma_f32_32x32x16_bf16 v[224:239], v[100:103], a[180:183], v[224:239]
ds_read_b64_tr_b16 v[100:101], v11 offset:40960
ds_read_b64_tr_b16 v[102:103], v11 offset:41472
s_lshl_b32 s45, s45, 9
s_add_u32 s7, s7, s45
s_and_b32 s45, s4, 3
s_add_u32 m0, s40, 16128
s_waitcnt lgkmcnt(8)
v_mfma_f32_32x32x16_bf16 v[208:223], v[104:107], a[184:187], v[208:223]
ds_read_b64_tr_b16 v[104:105], v8 offset:43008
ds_read_b64_tr_b16 v[106:107], v8 offset:43520
buffer_load_dwordx4 v2, s[24:27], s88 offen offset:256 lds
s_lshl_b32 s45, s45, 7
s_add_u32 s7, s7, s45
s_add_u32 s7, s7, 0
v_mfma_f32_32x32x16_bf16 v[224:239], v[108:111], a[184:187], v[224:239]
ds_read_b64_tr_b16 v[108:109], v11 offset:43008
ds_read_b64_tr_b16 v[110:111], v11 offset:43520
v_add_u32 v40, s7, v40
s_lshl_b32 s7, s5, 4
s_add_u32 s7, s7, s4
s_mul_i32 s7, s7, 9216
s_waitcnt lgkmcnt(8)
v_mfma_f32_32x32x16_bf16 v[208:223], v[88:91], a[188:191], v[208:223]
ds_read_b64_tr_b16 v[88:89], v8 offset:45056
ds_read_b64_tr_b16 v[90:91], v8 offset:45568
s_lshl_b32 s45, s3, 5
s_add_u32 s7, s7, s45
v_mul_u32_u24 v64, 1152, v62
v_lshl_add_u32 v64, v61, 4, v64
v_mfma_f32_32x32x16_bf16 v[224:239], v[92:95], a[188:191], v[224:239]
ds_read_b64_tr_b16 v[92:93], v11 offset:45056
ds_read_b64_tr_b16 v[94:95], v11 offset:45568
v_add_u32 v64, s7, v64
v_mov_b32 v65, 0x7fffff00
v_lshl_add_u32 v41, v60, 9, v64
s_add_u32 m0, s40, 20224
s_waitcnt lgkmcnt(8)
v_mfma_f32_32x32x16_bf16 v[112:127], v[96:99], a[128:131], 0
ds_read_b64_tr_b16 v[96:97], v8 offset:47104
ds_read_b64_tr_b16 v[98:99], v8 offset:47616
buffer_load_dwordx4 v2, s[24:27], s89 offen offset:256 lds
v_cvt_pk_bf16_f32 v26, v26, v27
v_accvgpr_write_b32 a196, v24
v_accvgpr_write_b32 a197, v26
v_mfma_f32_32x32x16_bf16 v[128:143], v[100:103], a[128:131], 0
ds_read_b64_tr_b16 v[100:101], v11 offset:47104
ds_read_b64_tr_b16 v[102:103], v11 offset:47616
v_accvgpr_read_b32 v32, a12
v_accvgpr_read_b32 v33, a13
v_accvgpr_read_b32 v34, a14
v_accvgpr_read_b32 v35, a15
s_waitcnt lgkmcnt(8)
v_mfma_f32_32x32x16_bf16 v[112:127], v[104:107], a[132:135], v[112:127]
s_waitcnt vmcnt(34)
s_barrier
ds_read_b64_tr_b16 v[104:105], v8 offset:49152
ds_read_b64_tr_b16 v[106:107], v8 offset:49664
v_accvgpr_read_b32 v36, a44
v_accvgpr_read_b32 v37, a45
v_mfma_f32_32x32x16_bf16 v[128:143], v[108:111], a[132:135], v[128:143]
ds_read_b64_tr_b16 v[108:109], v11 offset:49152
ds_read_b64_tr_b16 v[110:111], v11 offset:49664
v_accvgpr_read_b32 v38, a46
v_accvgpr_read_b32 v39, a47
v_max_f32 v32, 0, v32
s_add_u32 m0, s40, 24320
s_waitcnt lgkmcnt(8)
v_mfma_f32_32x32x16_bf16 v[112:127], v[88:91], a[136:139], v[112:127]
ds_read_b64_tr_b16 v[88:89], v8 offset:51200
ds_read_b64_tr_b16 v[90:91], v8 offset:51712
buffer_load_dwordx4 v2, s[24:27], s90 offen offset:256 lds
v_max_f32 v33, 0, v33
v_max_f32 v34, 0, v34
v_max_f32 v35, 0, v35
v_mfma_f32_32x32x16_bf16 v[128:143], v[92:95], a[136:139], v[128:143]
ds_read_b64_tr_b16 v[92:93], v11 offset:51200
ds_read_b64_tr_b16 v[94:95], v11 offset:51712
v_mul_f32 v32, v32, v36
v_mul_f32 v33, v33, v37
v_mul_f32 v34, v34, v38
v_mul_f32 v35, v35, v39
s_waitcnt lgkmcnt(8)
v_mfma_f32_32x32x16_bf16 v[112:127], v[96:99], a[140:143], v[112:127]
ds_read_b64_tr_b16 v[96:97], v8 offset:53248
ds_read_b64_tr_b16 v[98:99], v8 offset:53760
v_cvt_pk_bf16_f32 v32, v32, v33
v_cvt_pk_bf16_f32 v34, v34, v35
v_accvgpr_write_b32 a198, v32
v_accvgpr_write_b32 a199, v34
v_mfma_f32_32x32x16_bf16 v[128:143], v[100:103], a[140:143], v[128:143]
ds_read_b64_tr_b16 v[100:101], v11 offset:53248
ds_read_b64_tr_b16 v[102:103], v11 offset:53760
s_mov_b32 s6, 147456
buffer_store_dwordx4 a[196:199], v21, s[36:39], s6 offen offset:1024 sc1
v_cmp_gt_u32 s[92:93], 32, v1
s_add_u32 m0, s40, 28416
s_waitcnt lgkmcnt(8)
v_mfma_f32_32x32x16_bf16 v[112:127], v[104:107], a[144:147], v[112:127]
ds_read_b64_tr_b16 v[104:105], v8 offset:55296
ds_read_b64_tr_b16 v[106:107], v8 offset:55808
buffer_load_dwordx4 v2, s[24:27], s91 offen offset:256 lds
v_cmp_gt_u32 s[94:95], 16, v1
v_lshrrev_b32 v66, 5, v1
v_bfe_u32 v67, v1, 4, 1
v_mfma_f32_32x32x16_bf16 v[128:143], v[108:111], a[144:147], v[128:143]
ds_read_b64_tr_b16 v[108:109], v11 offset:55296
ds_read_b64_tr_b16 v[110:111], v11 offset:55808
v_lshl_add_u32 v43, v66, 9, v64
v_lshl_add_u32 v43, v67, 3, v43
v_cndmask_b32 v41, v65, v41, s[92:93]
v_cndmask_b32 v42, v65, v64, s[94:95]
s_waitcnt lgkmcnt(8)
v_mfma_f32_32x32x16_bf16 v[112:127], v[88:91], a[148:151], v[112:127]
s_waitcnt vmcnt(32)
s_barrier
ds_read_b64_tr_b16 v[88:89], v8 offset:57344
ds_read_b64_tr_b16 v[90:91], v8 offset:57856
v_mfma_f32_32x32x16_bf16 v[128:143], v[92:95], a[148:151], v[128:143]
ds_read_b64_tr_b16 v[92:93], v11 offset:57344
ds_read_b64_tr_b16 v[94:95], v11 offset:57856
s_add_u32 m0, s40, 32512
s_waitcnt lgkmcnt(8)
v_mfma_f32_32x32x16_bf16 v[112:127], v[96:99], a[152:155], v[112:127]
ds_read_b64_tr_b16 v[96:97], v8 offset:59392
ds_read_b64_tr_b16 v[98:99], v8 offset:59904
buffer_load_dwordx4 v3, s[24:27], 0 offen offset:256 lds
v_mfma_f32_32x32x16_bf16 v[128:143], v[100:103], a[152:155], v[128:143]
ds_read_b64_tr_b16 v[100:101], v11 offset:59392
ds_read_b64_tr_b16 v[102:103], v11 offset:59904
s_waitcnt lgkmcnt(8)
v_mfma_f32_32x32x16_bf16 v[112:127], v[104:107], a[156:159], v[112:127]
ds_read_b64_tr_b16 v[104:105], v8 offset:61440
ds_read_b64_tr_b16 v[106:107], v8 offset:61952
v_mfma_f32_32x32x16_bf16 v[128:143], v[108:111], a[156:159], v[128:143]
ds_read_b64_tr_b16 v[108:109], v11 offset:61440
ds_read_b64_tr_b16 v[110:111], v11 offset:61952
s_waitcnt vmcnt(7)
v_cmp_gt_u32 vcc, 1, v4
s_cmp_lg_u64 vcc, 0
s_cbranch_scc1 L_slow1
L_back1:
s_add_u32 m0, s40, 36608
s_waitcnt lgkmcnt(8)
v_mfma_f32_32x32x16_bf16 v[112:127], v[88:91], a[160:163], v[112:127]
ds_read_b64_tr_b16 v[88:89], v8 offset:63488
ds_read_b64_tr_b16 v[90:91], v8 offset:64000
buffer_load_dwordx4 v10, s[16:19], 0 offen offset:256 lds
s_mov_b32 s7, 81920
buffer_load_dwordx4 a[64:67], v15, s[36:39], s7 offen offset:0 sc1
v_mfma_f32_32x32x16_bf16 v[128:143], v[92:95], a[160:163], v[128:143]
ds_read_b64_tr_b16 v[92:93], v11 offset:63488
ds_read_b64_tr_b16 v[94:95], v11 offset:64000
s_mov_b32 s7, 81920
buffer_load_dwordx4 a[68:71], v15, s[36:39], s7 offen offset:1024 sc1
s_waitcnt lgkmcnt(8)
v_mfma_f32_32x32x16_bf16 v[112:127], v[96:99], a[164:167], v[112:127]
s_barrier
ds_read_b64_tr_b16 v[96:97], v9 offset:0
ds_read_b64_tr_b16 v[98:99], v9 offset:512
s_mov_b32 s7, 81920
buffer_load_dwordx4 a[72:75], v15, s[36:39], s7 offen offset:2048 sc1
v_mfma_f32_32x32x16_bf16 v[128:143], v[100:103], a[164:167], v[128:143]
ds_read_b64_tr_b16 v[100:101], v12 offset:0
ds_read_b64_tr_b16 v[102:103], v12 offset:512
s_mov_b32 s7, 81920
buffer_load_dwordx4 a[76:79], v15, s[36:39], s7 offen offset:3072 sc1
s_add_u32 m0, s40, 40960
s_waitcnt lgkmcnt(8)
v_mfma_f32_32x32x16_bf16 v[112:127], v[104:107], a[168:171], v[112:127]
ds_read_b64_tr_b16 v[104:105], v9 offset:2048
ds_read_b64_tr_b16 v[106:107], v9 offset:2560
buffer_load_dwordx4 v13, s[24:27], s84 offen offset:0 lds
s_mov_b32 s7, 98304
buffer_load_dwordx4 a[80:83], v15, s[36:39], s7 offen offset:0 sc1
v_mfma_f32_32x32x16_bf16 v[128:143], v[108:111], a[168:171], v[128:143]
ds_read_b64_tr_b16 v[108:109], v12 offset:2048
ds_read_b64_tr_b16 v[110:111], v12 offset:2560
s_mov_b32 s7, 98304
buffer_load_dwordx4 a[84:87], v15, s[36:39], s7 offen offset:1024 sc1
s_waitcnt lgkmcnt(8)
v_mfma_f32_32x32x16_bf16 v[112:127], v[88:91], a[172:175], v[112:127]
ds_read_b64_tr_b16 v[88:89], v9 offset:4096
ds_read_b64_tr_b16 v[90:91], v9 offset:4608
s_mov_b32 s7, 98304
buffer_load_dwordx4 a[88:91], v15, s[36:39], s7 offen offset:2048 sc1
s_mov_b32 s7, 98304
buffer_load_dwordx4 a[92:95], v15, s[36:39], s7 offen offset:3072 sc1
v_mfma_f32_32x32x16_bf16 v[128:143], v[92:95], a[172:175], v[128:143]
ds_read_b64_tr_b16 v[92:93], v12 offset:4096
ds_read_b64_tr_b16 v[94:95], v12 offset:4608
s_mov_b32 s7, 114688
buffer_load_dwordx4 a[96:99], v15, s[36:39], s7 offen offset:0 sc1
s_add_u32 m0, s40, 45056
s_waitcnt lgkmcnt(8)
v_mfma_f32_32x32x16_bf16 v[112:127], v[96:99], a[176:179], v[112:127]
ds_read_b64_tr_b16 v[96:97], v9 offset:6144
ds_read_b64_tr_b16 v[98:99], v9 offset:6656
buffer_load_dwordx4 v13, s[24:27], s85 offen offset:0 lds
s_mov_b32 s7, 114688
buffer_load_dwordx4 a[100:103], v15, s[36:39], s7 offen offset:1024 sc1
v_mfma_f32_32x32x16_bf16 v[128:143], v[100:103], a[176:179], v[128:143]
ds_read_b64_tr_b16 v[100:101], v12 offset:6144
ds_read_b64_tr_b16 v[102:103], v12 offset:6656
s_mov_b32 s7, 114688
buffer_load_dwordx4 a[104:107], v15, s[36:39], s7 offen offset:2048 sc1
s_waitcnt lgkmcnt(8)
v_mfma_f32_32x32x16_bf16 v[112:127], v[104:107], a[180:183], v[112:127]
s_barrier
ds_read_b64_tr_b16 v[104:105], v9 offset:8192
ds_read_b64_tr_b16 v[106:107], v9 offset:8704
s_mov_b32 s7, 114688
buffer_load_dwordx4 a[108:111], v15, s[36:39], s7 offen offset:3072 sc1
v_mfma_f32_32x32x16_bf16 v[128:143], v[108:111], a[180:183], v[128:143]
ds_read_b64_tr_b16 v[108:109], v12 offset:8192
ds_read_b64_tr_b16 v[110:111], v12 offset:8704
s_add_u32 m0, s40, 49152
s_waitcnt lgkmcnt(8)
v_mfma_f32_32x32x16_bf16 v[112:127], v[88:91], a[184:187], v[112:127]
ds_read_b64_tr_b16 v[88:89], v9 offset:10240
ds_read_b64_tr_b16 v[90:91], v9 offset:10752
buffer_load_dwordx4 v13, s[24:27], s86 offen offset:0 lds
v_mfma_f32_32x32x16_bf16 v[128:143], v[92:95], a[184:187], v[128:143]
ds_read_b64_tr_b16 v[92:93], v12 offset:10240
ds_read_b64_tr_b16 v[94:95], v12 offset:10752
s_waitcnt lgkmcnt(8)
v_mfma_f32_32x32x16_bf16 v[112:127], v[96:99], a[188:191], v[112:127]
ds_read_b64_tr_b16 v[96:97], v9 offset:12288
ds_read_b64_tr_b16 v[98:99], v9 offset:12800
v_mfma_f32_32x32x16_bf16 v[128:143], v[100:103], a[188:191], v[128:143]
ds_read_b64_tr_b16 v[100:101], v12 offset:12288
ds_read_b64_tr_b16 v[102:103], v12 offset:12800
s_add_u32 m0, s40, 53248
s_waitcnt lgkmcnt(8)
v_mfma_f32_32x32x16_bf16 v[144:159], v[104:107], a[128:131], 0
ds_read_b64_tr_b16 v[104:105], v9 offset:14336
ds_read_b64_tr_b16 v[106:107], v9 offset:14848
buffer_load_dwordx4 v13, s[24:27], s87 offen offset:0 lds
v_mfma_f32_32x32x16_bf16 v[160:175], v[108:111], a[128:131], 0
ds_read_b64_tr_b16 v[108:109], v12 offset:14336
ds_read_b64_tr_b16 v[110:111], v12 offset:14848
s_waitcnt lgkmcnt(8)
v_mfma_f32_32x32x16_bf16 v[144:159], v[88:91], a[132:135], v[144:159]
s_barrier
ds_read_b64_tr_b16 v[88:89], v9 offset:16384
ds_read_b64_tr_b16 v[90:91], v9 offset:16896
v_mfma_f32_32x32x16_bf16 v[160:175], v[92:95], a[132:135], v[160:175]
ds_read_b64_tr_b16 v[92:93], v12 offset:16384
ds_read_b64_tr_b16 v[94:95], v12 offset:16896
s_add_u32 m0, s40, 57344
s_waitcnt lgkmcnt(8)
v_mfma_f32_32x32x16_bf16 v[144:159], v[96:99], a[136:139], v[144:159]
ds_read_b64_tr_b16 v[96:97], v9 offset:18432
ds_read_b64_tr_b16 v[98:99], v9 offset:18944
buffer_load_dwordx4 v13, s[24:27], s88 offen offset:0 lds
v_mfma_f32_32x32x16_bf16 v[160:175], v[100:103], a[136:139], v[160:175]
ds_read_b64_tr_b16 v[100:101], v12 offset:18432
ds_read_b64_tr_b16 v[102:103], v12 offset:18944
s_waitcnt lgkmcnt(8)
v_mfma_f32_32x32x16_bf16 v[144:159], v[104:107], a[140:143], v[144:159]
ds_read_b64_tr_b16 v[104:105], v9 offset:20480
ds_read_b64_tr_b16 v[106:107], v9 offset:20992
v_mfma_f32_32x32x16_bf16 v[160:175], v[108:111], a[140:143], v[160:175]
ds_read_b64_tr_b16 v[108:109], v12 offset:20480
ds_read_b64_tr_b16 v[110:111], v12 offset:20992
s_add_u32 m0, s40, 61440
s_waitcnt lgkmcnt(8)
v_mfma_f32_32x32x16_bf16 v[144:159], v[88:91], a[144:147], v[144:159]
ds_read_b64_tr_b16 v[88:89], v9 offset:22528
ds_read_b64_tr_b16 v[90:91], v9 offset:23040
buffer_load_dwordx4 v13, s[24:27], s89 offen offset:0 lds
v_mfma_f32_32x32x16_bf16 v[160:175], v[92:95], a[144:147], v[160:175]
ds_read_b64_tr_b16 v[92:93], v12 offset:22528
ds_read_b64_tr_b16 v[94:95], v12 offset:23040
s_waitcnt lgkmcnt(8)
v_mfma_f32_32x32x16_bf16 v[144:159], v[96:99], a[148:151], v[144:159]
s_barrier
ds_read_b64_tr_b16 v[96:97], v9 offset:24576
ds_read_b64_tr_b16 v[98:99], v9 offset:25088
v_mfma_f32_32x32x16_bf16 v[160:175], v[100:103], a[148:151], v[160:175]
ds_read_b64_tr_b16 v[100:101], v12 offset:24576
ds_read_b64_tr_b16 v[102:103], v12 offset:25088
s_add_u32 m0, s40, 65536
s_waitcnt lgkmcnt(8)
v_mfma_f32_32x32x16_bf16 v[144:159], v[104:107], a[152:155], v[144:159]
ds_read_b64_tr_b16 v[104:105], v9 offset:26624
ds_read_b64_tr_b16 v[106:107], v9 offset:27136
buffer_load_dwordx4 v13, s[24:27], s90 offen offset:0 lds
v_mfma_f32_32x32x16_bf16 v[160:175], v[108:111], a[152:155], v[160:175]
ds_read_b64_tr_b16 v[108:109], v12 offset:26624
ds_read_b64_tr_b16 v[110:111], v12 offset:27136
s_waitcnt lgkmcnt(8)
v_mfma_f32_32x32x16_bf16 v[144:159], v[88:91], a[156:159], v[144:159]
ds_read_b64_tr_b16 v[88:89], v9 offset:28672
ds_read_b64_tr_b16 v[90:91], v9 offset:29184
v_mfma_f32_32x32x16_bf16 v[160:175], v[92:95], a[156:159], v[160:175]
ds_read_b64_tr_b16 v[92:93], v12 offset:28672
ds_read_b64_tr_b16 v[94:95], v12 offset:29184
s_add_u32 m0, s40, 69632
s_waitcnt lgkmcnt(8)
v_mfma_f32_32x32x16_bf16 v[144:159], v[96:99], a[160:163], v[144:159]
ds_read_b64_tr_b16 v[96:97], v9 offset:30720
ds_read_b64_tr_b16 v[98:99], v9 offset:31232
buffer_load_dwordx4 v13, s[24:27], s91 offen offset:0 lds
v_mfma_f32_32x32x16_bf16 v[160:175], v[100:103], a[160:163], v[160:175]
ds_read_b64_tr_b16 v[100:101], v12 offset:30720
ds_read_b64_tr_b16 v[102:103], v12 offset:31232
s_waitcnt lgkmcnt(8)
v_mfma_f32_32x32x16_bf16 v[144:159], v[104:107], a[164:167], v[144:159]
s_barrier
ds_read_b64_tr_b16 v[104:105], v9 offset:32768
ds_read_b64_tr_b16 v[106:107], v9 offset:33280
v_mfma_f32_32x32x16_bf16 v[160:175], v[108:111], a[164:167], v[160:175]
ds_read_b64_tr_b16 v[108:109], v12 offset:32768
ds_read_b64_tr_b16 v[110:111], v12 offset:33280
s_add_u32 m0, s40, 73728
s_waitcnt lgkmcnt(8)
v_mfma_f32_32x32x16_bf16 v[144:159], v[88:91], a[168:171], v[144:159]
ds_read_b64_tr_b16 v[88:89], v9 offset:34816
ds_read_b64_tr_b16 v[90:91], v9 offset:35328
buffer_load_dwordx4 v16, s[24:27], 0 offen offset:0 lds
v_mfma_f32_32x32x16_bf16 v[160:175], v[92:95], a[168:171], v[160:175]
ds_read_b64_tr_b16 v[92:93], v12 offset:34816
ds_read_b64_tr_b16 v[94:95], v12 offset:35328
s_waitcnt lgkmcnt(8)
v_mfma_f32_32x32x16_bf16 v[144:159], v[96:99], a[172:175], v[144:159]
ds_read_b64_tr_b16 v[96:97], v9 offset:36864
ds_read_b64_tr_b16 v[98:99], v9 offset:37376
v_mfma_f32_32x32x16_bf16 v[160:175], v[100:103], a[172:175], v[160:175]
ds_read_b64_tr_b16 v[100:101], v12 offset:36864
ds_read_b64_tr_b16 v[102:103], v12 offset:37376
s_add_u32 m0, s40, 77824
s_waitcnt lgkmcnt(8)
v_mfma_f32_32x32x16_bf16 v[144:159], v[104:107], a[176:179], v[144:159]
ds_read_b64_tr_b16 v[104:105], v9 offset:38912
ds_read_b64_tr_b16 v[106:107], v9 offset:39424
buffer_load_dwordx4 v19, s[16:19], 0 offen offset:0 lds
v_mfma_f32_32x32x16_bf16 v[160:175], v[108:111], a[176:179], v[160:175]
ds_read_b64_tr_b16 v[108:109], v12 offset:38912
ds_read_b64_tr_b16 v[110:111], v12 offset:39424
s_waitcnt lgkmcnt(8)
v_mfma_f32_32x32x16_bf16 v[144:159], v[88:91], a[180:183], v[144:159]
s_barrier
ds_read_b64_tr_b16 v[88:89], v9 offset:40960
ds_read_b64_tr_b16 v[90:91], v9 offset:41472
v_mov_b32 v47, 2
s_waitcnt vmcnt(25)
s_barrier
v_mfma_f32_32x32x16_bf16 v[160:175], v[92:95], a[180:183], v[160:175]
ds_read_b64_tr_b16 v[92:93], v12 offset:40960
ds_read_b64_tr_b16 v[94:95], v12 offset:41472
buffer_store_byte v47, v0, s[36:39], s1 offen sc1
v_cndmask_b32 v44, v65, v43, s[92:93]
s_add_u32 m0, s40, 81792
s_waitcnt lgkmcnt(8)
v_mfma_f32_32x32x16_bf16 v[144:159], v[96:99], a[184:187], v[144:159]
ds_read_b64_tr_b16 v[96:97], v9 offset:43008
ds_read_b64_tr_b16 v[98:99], v9 offset:43520
buffer_load_dwordx4 v13, s[24:27], s84 offen offset:128 lds
s_lshl_b32 s7, s5, 4
v_add_u32 v45, s7, v63
v_mfma_f32_32x32x16_bf16 v[160:175], v[100:103], a[184:187], v[160:175]
ds_read_b64_tr_b16 v[100:101], v12 offset:43008
ds_read_b64_tr_b16 v[102:103], v12 offset:43520
v_mov_b32 v65, 0x3f80
v_mov_b32 v66, 0x3f800000
s_waitcnt lgkmcnt(8)
v_mfma_f32_32x32x16_bf16 v[144:159], v[104:107], a[188:191], v[144:159]
ds_read_b64_tr_b16 v[104:105], v9 offset:45056
ds_read_b64_tr_b16 v[106:107], v9 offset:45568
v_cmp_eq_u32 vcc, 0, v63
s_nop 1
v_cndmask_b32 v67, 0, v65, vcc
v_mfma_f32_32x32x16_bf16 v[160:175], v[108:111], a[188:191], v[160:175]
ds_read_b64_tr_b16 v[108:109], v12 offset:45056
ds_read_b64_tr_b16 v[110:111], v12 offset:45568
v_cmp_eq_u32 vcc, 1, v63
s_nop 1
v_cndmask_b32 v48, v67, v66, vcc
s_add_u32 m0, s40, 85888
s_waitcnt lgkmcnt(8)
v_mfma_f32_32x32x16_bf16 v[208:223], v[88:91], a[192:195], v[208:223]
ds_read_b64_tr_b16 v[88:89], v9 offset:47104
ds_read_b64_tr_b16 v[90:91], v9 offset:47616
buffer_load_dwordx4 v13, s[24:27], s85 offen offset:128 lds
v_cmp_eq_u32 vcc, 2, v63
s_nop 1
v_cndmask_b32 v67, 0, v65, vcc
v_mfma_f32_32x32x16_bf16 v[224:239], v[92:95], a[192:195], v[224:239]
ds_read_b64_tr_b16 v[92:93], v12 offset:47104
ds_read_b64_tr_b16 v[94:95], v12 offset:47616
v_cmp_eq_u32 vcc, 3, v63
s_nop 1
v_cndmask_b32 v49, v67, v66, vcc
s_waitcnt lgkmcnt(8)
v_mfma_f32_32x32x16_bf16 v[208:223], v[96:99], a[196:199], v[208:223]
ds_read_b64_tr_b16 v[96:97], v17 offset:8192
ds_read_b64_tr_b16 v[98:99], v17 offset:8704
v_cmp_eq_u32 vcc, 4, v63
s_nop 1
v_cndmask_b32 v67, 0, v65, vcc
v_mfma_f32_32x32x16_bf16 v[224:239], v[100:103], a[196:199], v[224:239]
ds_read_b64_tr_b16 v[100:101], v18 offset:8192
ds_read_b64_tr_b16 v[102:103], v18 offset:8704
v_cmp_eq_u32 vcc, 5, v63
s_nop 1
v_cndmask_b32 v50, v67, v66, vcc
s_add_u32 m0, s40, 89984
s_waitcnt lgkmcnt(8)
v_mfma_f32_32x32x16_bf16 v[208:223], v[104:107], a[200:203], v[208:223]
s_barrier
ds_read_b64_tr_b16 v[104:105], v9 offset:49152
ds_read_b64_tr_b16 v[106:107], v9 offset:49664
buffer_load_dwordx4 v13, s[24:27], s86 offen offset:128 lds
v_cmp_eq_u32 vcc, 6, v63
s_nop 1
v_cndmask_b32 v67, 0, v65, vcc
v_mfma_f32_32x32x16_bf16 v[224:239], v[108:111], a[200:203], v[224:239]
ds_read_b64_tr_b16 v[108:109], v12 offset:49152
ds_read_b64_tr_b16 v[110:111], v12 offset:49664
v_cmp_eq_u32 vcc, 7, v63
s_nop 1
v_cndmask_b32 v51, v67, v66, vcc
s_waitcnt lgkmcnt(8)
v_mfma_f32_32x32x16_bf16 v[208:223], v[88:91], a[204:207], v[208:223]
ds_read_b64_tr_b16 v[88:89], v9 offset:51200
ds_read_b64_tr_b16 v[90:91], v9 offset:51712
v_cmp_eq_u32 vcc, 8, v63
s_nop 1
v_cndmask_b32 v67, 0, v65, vcc
v_mfma_f32_32x32x16_bf16 v[224:239], v[92:95], a[204:207], v[224:239]
ds_read_b64_tr_b16 v[92:93], v12 offset:51200
ds_read_b64_tr_b16 v[94:95], v12 offset:51712
v_cmp_eq_u32 vcc, 9, v63
s_nop 1
v_cndmask_b32 v52, v67, v66, vcc
s_add_u32 m0, s40, 94080
s_waitcnt lgkmcnt(8)
v_mfma_f32_32x32x16_bf16 v[208:223], v[96:99], a[208:211], v[208:223]
ds_read_b64_tr_b16 v[96:97], v9 offset:53248
ds_read_b64_tr_b16 v[98:99], v9 offset:53760
buffer_load_dwordx4 v13, s[24:27], s87 offen offset:128 lds
v_cmp_eq_u32 vcc, 10, v63
s_nop 1
v_cndmask_b32 v67, 0, v65, vcc
v_mfma_f32_32x32x16_bf16 v[224:239], v[100:103], a[208:211], v[224:239]
ds_read_b64_tr_b16 v[100:101], v12 offset:53248
ds_read_b64_tr_b16 v[102:103], v12 offset:53760
v_cmp_eq_u32 vcc, 11, v63
s_nop 1
v_cndmask_b32 v53, v67, v66, vcc
s_waitcnt lgkmcnt(8)
v_mfma_f32_32x32x16_bf16 v[112:127], v[104:107], a[192:195], v[112:127]
ds_read_b64_tr_b16 v[104:105], v9 offset:55296
ds_read_b64_tr_b16 v[106:107], v9 offset:55808
v_cmp_eq_u32 vcc, 12, v63
s_nop 1
v_cndmask_b32 v67, 0, v65, vcc
v_mfma_f32_32x32x16_bf16 v[128:143], v[108:111], a[192:195], v[128:143]
ds_read_b64_tr_b16 v[108:109], v12 offset:55296
ds_read_b64_tr_b16 v[110:111], v12 offset:55808
v_cmp_eq_u32 vcc, 13, v63
s_nop 1
v_cndmask_b32 v54, v67, v66, vcc
s_waitcnt lgkmcnt(8)
v_mfma_f32_32x32x16_bf16 v[112:127], v[88:91], a[196:199], v[112:127]
ds_read_b64_tr_b16 v[88:89], v17 offset:0
ds_read_b64_tr_b16 v[90:91], v17 offset:512
v_cmp_eq_u32 vcc, 14, v63
s_nop 1
v_cndmask_b32 v67, 0, v65, vcc
v_mfma_f32_32x32x16_bf16 v[128:143], v[92:95], a[196:199], v[128:143]
ds_read_b64_tr_b16 v[92:93], v18 offset:0
ds_read_b64_tr_b16 v[94:95], v18 offset:512
v_cmp_eq_u32 vcc, 15, v63
s_nop 1
v_cndmask_b32 v55, v67, v66, vcc
s_add_u32 m0, s40, 98176
s_waitcnt lgkmcnt(8)
v_mfma_f32_32x32x16_bf16 v[112:127], v[96:99], a[200:203], v[112:127]
s_barrier
ds_read_b64_tr_b16 v[96:97], v9 offset:57344
ds_read_b64_tr_b16 v[98:99], v9 offset:57856
buffer_load_dwordx4 v13, s[24:27], s88 offen offset:128 lds
s_mov_b32 s92, 0xffff0000
v_mfma_f32_32x32x16_bf16 v[128:143], v[100:103], a[200:203], v[128:143]
ds_read_b64_tr_b16 v[100:101], v12 offset:57344
ds_read_b64_tr_b16 v[102:103], v12 offset:57856
s_mov_b32 s93, 0xffff0000
v_cndmask_b32 v56, v48, v52, s[92:93]
v_cndmask_b32 v57, v49, v53, s[92:93]
s_waitcnt lgkmcnt(8)
v_mfma_f32_32x32x16_bf16 v[112:127], v[104:107], a[204:207], v[112:127]
ds_read_b64_tr_b16 v[104:105], v9 offset:59392
ds_read_b64_tr_b16 v[106:107], v9 offset:59904
v_cndmask_b32 v58, v50, v54, s[92:93]
v_cndmask_b32 v59, v51, v55, s[92:93]
buffer_load_dwordx4 a[212:215], v42, s[8:11], 0 offen offset:0
v_mfma_f32_32x32x16_bf16 v[128:143], v[108:111], a[204:207], v[128:143]
ds_read_b64_tr_b16 v[108:109], v12 offset:59392
ds_read_b64_tr_b16 v[110:111], v12 offset:59904
buffer_load_dwordx4 a[216:219], v41, s[8:11], 0 offen offset:128
buffer_load_dwordx4 a[220:223], v41, s[8:11], 0 offen offset:256
s_add_u32 m0, s40, 102272
s_waitcnt lgkmcnt(8)
v_mfma_f32_32x32x16_bf16 v[112:127], v[88:91], a[208:211], v[112:127]
ds_read_b64_tr_b16 v[88:89], v9 offset:61440
ds_read_b64_tr_b16 v[90:91], v9 offset:61952
buffer_load_dwordx4 v13, s[24:27], s89 offen offset:128 lds
buffer_load_dwordx4 a[224:227], v41, s[8:11], 0 offen offset:384
buffer_load_dwordx4 a[228:231], v41, s[8:11], 0 offen offset:512
v_mfma_f32_32x32x16_bf16 v[128:143], v[92:95], a[208:211], v[128:143]
ds_read_b64_tr_b16 v[92:93], v12 offset:61440
ds_read_b64_tr_b16 v[94:95], v12 offset:61952
v_cvt_pk_bf16_f32 v24, v208, v209
v_cvt_pk_bf16_f32 v25, v210, v211
v_cvt_pk_bf16_f32 v26, v212, v213
s_waitcnt lgkmcnt(8)
v_mfma_f32_32x32x16_bf16 v[144:159], v[96:99], a[192:195], v[144:159]
ds_read_b64_tr_b16 v[96:97], v9 offset:63488
ds_read_b64_tr_b16 v[98:99], v9 offset:64000
v_cvt_pk_bf16_f32 v27, v214, v215
s_mov_b32 s6, 0
buffer_store_dwordx4 v[24:27], v21, s[36:39], s6 offen offset:0 sc1
v_mfma_f32_32x32x16_bf16 v[160:175], v[100:103], a[192:195], v[160:175]
ds_read_b64_tr_b16 v[100:101], v12 offset:63488
ds_read_b64_tr_b16 v[102:103], v12 offset:64000
v_cvt_pk_bf16_f32 v28, v216, v217
v_cvt_pk_bf16_f32 v29, v218, v219
v_cvt_pk_bf16_f32 v30, v220, v221
s_waitcnt lgkmcnt(8)
v_mfma_f32_32x32x16_bf16 v[144:159], v[104:107], a[196:199], v[144:159]
ds_read_b64_tr_b16 v[104:105], v17 offset:1024
ds_read_b64_tr_b16 v[106:107], v17 offset:1536
v_cvt_pk_bf16_f32 v31, v222, v223
s_mov_b32 s6, 0
buffer_store_dwordx4 v[28:31], v21, s[36:39], s6 offen offset:1024 sc1
v_mfma_f32_32x32x16_bf16 v[160:175], v[108:111], a[196:199], v[160:175]
ds_read_b64_tr_b16 v[108:109], v18 offset:1024
ds_read_b64_tr_b16 v[110:111], v18 offset:1536
v_cvt_pk_bf16_f32 v32, v224, v225
v_cvt_pk_bf16_f32 v33, v226, v227
s_add_u32 m0, s40, 106368
s_waitcnt lgkmcnt(8)
v_mfma_f32_32x32x16_bf16 v[144:159], v[88:91], a[200:203], v[144:159]
s_barrier
ds_read_b64_tr_b16 v[88:89], v8 offset:0
ds_read_b64_tr_b16 v[90:91], v8 offset:512
buffer_load_dwordx4 v13, s[24:27], s90 offen offset:128 lds
v_cvt_pk_bf16_f32 v34, v228, v229
v_mfma_f32_32x32x16_bf16 v[160:175], v[92:95], a[200:203], v[160:175]
ds_read_b64_tr_b16 v[92:93], v11 offset:0
ds_read_b64_tr_b16 v[94:95], v11 offset:512
v_cvt_pk_bf16_f32 v35, v230, v231
s_mov_b32 s6, 0
buffer_store_dwordx4 v[32:35], v21, s[36:39], s6 offen offset:2048 sc1
s_waitcnt lgkmcnt(8)
v_mfma_f32_32x32x16_bf16 v[144:159], v[96:99], a[204:207], v[144:159]
ds_read_b64_tr_b16 v[96:97], v8 offset:2048
ds_read_b64_tr_b16 v[98:99], v8 offset:2560
v_cvt_pk_bf16_f32 v36, v232, v233
v_cvt_pk_bf16_f32 v37, v234, v235
v_cvt_pk_bf16_f32 v38, v236, v237
v_mfma_f32_32x32x16_bf16 v[160:175], v[100:103], a[204:207], v[160:175]
ds_read_b64_tr_b16 v[100:101], v11 offset:2048
ds_read_b64_tr_b16 v[102:103], v11 offset:2560
buffer_load_ubyte v4, v14, s[36:39], s1 offen sc1
v_cvt_pk_bf16_f32 v39, v238, v239
s_add_u32 m0, s40, 110464
s_waitcnt lgkmcnt(8)
v_mfma_f32_32x32x16_bf16 v[144:159], v[104:107], a[208:211], v[144:159]
ds_read_b64_tr_b16 v[104:105], v8 offset:4096
ds_read_b64_tr_b16 v[106:107], v8 offset:4608
buffer_load_dwordx4 v13, s[24:27], s91 offen offset:128 lds
s_mov_b32 s6, 0
buffer_store_dwordx4 v[36:39], v21, s[36:39], s6 offen offset:3072 sc1
v_mfma_f32_32x32x16_bf16 v[160:175], v[108:111], a[208:211], v[160:175]
ds_read_b64_tr_b16 v[108:109], v11 offset:4096
ds_read_b64_tr_b16 v[110:111], v11 offset:4608
s_waitcnt lgkmcnt(8)
v_mfma_f32_32x32x16_bf16 v[176:191], v[88:91], a[128:131], 0
ds_read_b64_tr_b16 v[88:89], v8 offset:6144
ds_read_b64_tr_b16 v[90:91], v8 offset:6656
v_mfma_f32_32x32x16_bf16 v[192:207], v[92:95], a[128:131], 0
ds_read_b64_tr_b16 v[92:93], v11 offset:6144
ds_read_b64_tr_b16 v[94:95], v11 offset:6656
s_waitcnt lgkmcnt(8)
v_mfma_f32_32x32x16_bf16 v[176:191], v[96:99], a[132:135], v[176:191]
s_barrier
ds_read_b64_tr_b16 v[96:97], v8 offset:8192
ds_read_b64_tr_b16 v[98:99], v8 offset:8704
v_mfma_f32_32x32x16_bf16 v[192:207], v[100:103], a[132:135], v[192:207]
ds_read_b64_tr_b16 v[100:101], v11 offset:8192
ds_read_b64_tr_b16 v[102:103], v11 offset:8704
s_add_u32 m0, s40, 114560
s_waitcnt lgkmcnt(8)
v_mfma_f32_32x32x16_bf16 v[176:191], v[104:107], a[136:139], v[176:191]
ds_read_b64_tr_b16 v[104:105], v8 offset:10240
ds_read_b64_tr_b16 v[106:107], v8 offset:10752
buffer_load_dwordx4 v16, s[24:27], 0 offen offset:128 lds
v_mfma_f32_32x32x16_bf16 v[192:207], v[108:111], a[136:139], v[192:207]
ds_read_b64_tr_b16 v[108:109], v11 offset:10240
ds_read_b64_tr_b16 v[110:111], v11 offset:10752
s_waitcnt lgkmcnt(8)
v_mfma_f32_32x32x16_bf16 v[176:191], v[88:91], a[140:143], v[176:191]
ds_read_b64_tr_b16 v[88:89], v8 offset:12288
ds_read_b64_tr_b16 v[90:91], v8 offset:12800
v_mfma_f32_32x32x16_bf16 v[192:207], v[92:95], a[140:143], v[192:207]
ds_read_b64_tr_b16 v[92:93], v11 offset:12288
ds_read_b64_tr_b16 v[94:95], v11 offset:12800
s_add_u32 m0, s40, 118656
s_waitcnt lgkmcnt(8)
v_mfma_f32_32x32x16_bf16 v[176:191], v[96:99], a[144:147], v[176:191]
ds_read_b64_tr_b16 v[96:97], v8 offset:14336
ds_read_b64_tr_b16 v[98:99], v8 offset:14848
buffer_load_dwordx4 v19, s[16:19], 0 offen offset:128 lds
v_mfma_f32_32x32x16_bf16 v[192:207], v[100:103], a[144:147], v[192:207]
ds_read_b64_tr_b16 v[100:101], v11 offset:14336
ds_read_b64_tr_b16 v[102:103], v11 offset:14848
s_waitcnt lgkmcnt(8)
v_mfma_f32_32x32x16_bf16 v[176:191], v[104:107], a[148:151], v[176:191]
s_barrier
ds_read_b64_tr_b16 v[104:105], v8 offset:16384
ds_read_b64_tr_b16 v[106:107], v8 offset:16896
v_mfma_f32_32x32x16_bf16 v[192:207], v[108:111], a[148:151], v[192:207]
ds_read_b64_tr_b16 v[108:109], v11 offset:16384
ds_read_b64_tr_b16 v[110:111], v11 offset:16896
s_add_u32 m0, s40, 122624
s_waitcnt lgkmcnt(8)
v_mfma_f32_32x32x16_bf16 v[176:191], v[88:91], a[152:155], v[176:191]
ds_read_b64_tr_b16 v[88:89], v8 offset:18432
ds_read_b64_tr_b16 v[90:91], v8 offset:18944
buffer_load_dwordx4 v13, s[24:27], s84 offen offset:256 lds
v_mfma_f32_32x32x16_bf16 v[192:207], v[92:95], a[152:155], v[192:207]
ds_read_b64_tr_b16 v[92:93], v11 offset:18432
ds_read_b64_tr_b16 v[94:95], v11 offset:18944
s_waitcnt lgkmcnt(8)
v_mfma_f32_32x32x16_bf16 v[176:191], v[96:99], a[156:159], v[176:191]
ds_read_b64_tr_b16 v[96:97], v8 offset:20480
ds_read_b64_tr_b16 v[98:99], v8 offset:20992
v_mfma_f32_32x32x16_bf16 v[192:207], v[100:103], a[156:159], v[192:207]
ds_read_b64_tr_b16 v[100:101], v11 offset:20480
ds_read_b64_tr_b16 v[102:103], v11 offset:20992
s_add_u32 m0, s40, 126720
s_waitcnt lgkmcnt(8)
v_mfma_f32_32x32x16_bf16 v[176:191], v[104:107], a[160:163], v[176:191]
ds_read_b64_tr_b16 v[104:105], v8 offset:22528
ds_read_b64_tr_b16 v[106:107], v8 offset:23040
buffer_load_dwordx4 v13, s[24:27], s85 offen offset:256 lds
v_mfma_f32_32x32x16_bf16 v[192:207], v[108:111], a[160:163], v[192:207]
ds_read_b64_tr_b16 v[108:109], v11 offset:22528
ds_read_b64_tr_b16 v[110:111], v11 offset:23040
s_waitcnt lgkmcnt(8)
v_mfma_f32_32x32x16_bf16 v[176:191], v[88:91], a[164:167], v[176:191]
s_waitcnt vmcnt(47)
s_barrier
ds_read_b64_tr_b16 v[88:89], v8 offset:24576
ds_read_b64_tr_b16 v[90:91], v8 offset:25088
v_mfma_f32_32x32x16_bf16 v[192:207], v[92:95], a[164:167], v[192:207]
ds_read_b64_tr_b16 v[92:93], v11 offset:24576
ds_read_b64_tr_b16 v[94:95], v11 offset:25088
s_mov_b32 m0, s40
s_add_u32 s41, s86, 256
s_waitcnt lgkmcnt(8)
v_mfma_f32_32x32x16_bf16 v[176:191], v[96:99], a[168:171], v[176:191]
ds_read_b64_tr_b16 v[96:97], v8 offset:26624
ds_read_b64_tr_b16 v[98:99], v8 offset:27136
buffer_load_dwordx4 v13, s[24:27], s41 offen lds
v_mfma_f32_32x32x16_bf16 v[192:207], v[100:103], a[168:171], v[192:207]
ds_read_b64_tr_b16 v[100:101], v11 offset:26624
ds_read_b64_tr_b16 v[102:103], v11 offset:27136
s_waitcnt lgkmcnt(8)
v_mfma_f32_32x32x16_bf16 v[176:191], v[104:107], a[172:175], v[176:191]
ds_read_b64_tr_b16 v[104:105], v8 offset:28672
ds_read_b64_tr_b16 v[106:107], v8 offset:29184
s_waitcnt vmcnt(7)
v_cmp_gt_u32 vcc, 2, v4
s_cmp_lg_u64 vcc, 0
s_cbranch_scc1 L_slow2
L_back2:
v_mfma_f32_32x32x16_bf16 v[192:207], v[108:111], a[172:175], v[192:207]
ds_read_b64_tr_b16 v[108:109], v11 offset:28672
ds_read_b64_tr_b16 v[110:111], v11 offset:29184
s_mov_b32 s7, 131072
buffer_load_dwordx4 a[112:115], v15, s[36:39], s7 offen offset:0 sc1
s_add_u32 m0, s40, 3840
s_waitcnt lgkmcnt(8)
v_mfma_f32_32x32x16_bf16 v[176:191], v[88:91], a[176:179], v[176:191]
ds_read_b64_tr_b16 v[88:89], v8 offset:30720
ds_read_b64_tr_b16 v[90:91], v8 offset:31232
buffer_load_dwordx4 v13, s[24:27], s87 offen offset:256 lds
s_mov_b32 s7, 131072
buffer_load_dwordx4 a[116:119], v15, s[36:39], s7 offen offset:1024 sc1
v_mfma_f32_32x32x16_bf16 v[192:207], v[92:95], a[176:179], v[192:207]
ds_read_b64_tr_b16 v[92:93], v11 offset:30720
ds_read_b64_tr_b16 v[94:95], v11 offset:31232
s_mov_b32 s7, 131072
buffer_load_dwordx4 a[120:123], v15, s[36:39], s7 offen offset:2048 sc1
s_waitcnt lgkmcnt(8)
v_mfma_f32_32x32x16_bf16 v[176:191], v[96:99], a[180:183], v[176:191]
s_barrier
ds_read_b64_tr_b16 v[96:97], v8 offset:32768
ds_read_b64_tr_b16 v[98:99], v8 offset:33280
s_mov_b32 s7, 131072
buffer_load_dwordx4 a[124:127], v15, s[36:39], s7 offen offset:3072 sc1
v_mfma_f32_32x32x16_bf16 v[192:207], v[100:103], a[180:183], v[192:207]
ds_read_b64_tr_b16 v[100:101], v11 offset:32768
ds_read_b64_tr_b16 v[102:103], v11 offset:33280
s_mov_b32 s7, 147456
buffer_load_dwordx4 a[16:19], v15, s[36:39], s7 offen offset:0 sc1
s_add_u32 m0, s40, 7936
s_waitcnt lgkmcnt(8)
v_mfma_f32_32x32x16_bf16 v[176:191], v[104:107], a[184:187], v[176:191]
ds_read_b64_tr_b16 v[104:105], v8 offset:34816
ds_read_b64_tr_b16 v[106:107], v8 offset:35328
buffer_load_dwordx4 v13, s[24:27], s88 offen offset:256 lds
s_mov_b32 s7, 147456
buffer_load_dwordx4 a[20:23], v15, s[36:39], s7 offen offset:1024 sc1
v_mfma_f32_32x32x16_bf16 v[192:207], v[108:111], a[184:187], v[192:207]
ds_read_b64_tr_b16 v[108:109], v11 offset:34816
ds_read_b64_tr_b16 v[110:111], v11 offset:35328
s_mov_b32 s7, 147456
buffer_load_dwordx4 a[24:27], v15, s[36:39], s7 offen offset:2048 sc1
s_waitcnt lgkmcnt(8)
v_mfma_f32_32x32x16_bf16 v[176:191], v[88:91], a[188:191], v[176:191]
ds_read_b64_tr_b16 v[88:89], v8 offset:36864
ds_read_b64_tr_b16 v[90:91], v8 offset:37376
s_mov_b32 s7, 147456
buffer_load_dwordx4 a[28:31], v15, s[36:39], s7 offen offset:3072 sc1
v_mfma_f32_32x32x16_bf16 v[192:207], v[92:95], a[188:191], v[192:207]
ds_read_b64_tr_b16 v[92:93], v11 offset:36864
ds_read_b64_tr_b16 v[94:95], v11 offset:37376
s_mov_b32 s7, 163840
buffer_load_dwordx4 a[48:51], v15, s[36:39], s7 offen offset:0 sc1
s_add_u32 m0, s40, 12032
s_waitcnt lgkmcnt(8)
v_mfma_f32_32x32x16_bf16 v[176:191], v[96:99], a[192:195], v[176:191]
ds_read_b64_tr_b16 v[96:97], v8 offset:38912
ds_read_b64_tr_b16 v[98:99], v8 offset:39424
buffer_load_dwordx4 v13, s[24:27], s89 offen offset:256 lds
v_mfma_f32_32x32x16_bf16 v[192:207], v[100:103], a[192:195], v[192:207]
ds_read_b64_tr_b16 v[100:101], v11 offset:38912
ds_read_b64_tr_b16 v[102:103], v11 offset:39424
s_waitcnt lgkmcnt(8)
v_mfma_f32_32x32x16_bf16 v[176:191], v[104:107], a[196:199], v[176:191]
ds_read_b64_tr_b16 v[104:105], v17 offset:2048
ds_read_b64_tr_b16 v[106:107], v17 offset:2560
v_mfma_f32_32x32x16_bf16 v[192:207], v[108:111], a[196:199], v[192:207]
ds_read_b64_tr_b16 v[108:109], v18 offset:2048
ds_read_b64_tr_b16 v[110:111], v18 offset:2560
s_add_u32 m0, s40, 16128
s_waitcnt lgkmcnt(8)
v_mfma_f32_32x32x16_bf16 v[176:191], v[88:91], a[200:203], v[176:191]
s_barrier
ds_read_b64_tr_b16 v[88:89], v8 offset:40960
ds_read_b64_tr_b16 v[90:91], v8 offset:41472
buffer_load_dwordx4 v13, s[24:27], s90 offen offset:256 lds
v_mfma_f32_32x32x16_bf16 v[192:207], v[92:95], a[200:203], v[192:207]
ds_read_b64_tr_b16 v[92:93], v11 offset:40960
ds_read_b64_tr_b16 v[94:95], v11 offset:41472
s_waitcnt lgkmcnt(8)
v_mfma_f32_32x32x16_bf16 v[176:191], v[96:99], a[204:207], v[176:191]
ds_read_b64_tr_b16 v[96:97], v8 offset:43008
ds_read_b64_tr_b16 v[98:99], v8 offset:43520
v_mfma_f32_32x32x16_bf16 v[192:207], v[100:103], a[204:207], v[192:207]
ds_read_b64_tr_b16 v[100:101], v11 offset:43008
ds_read_b64_tr_b16 v[102:103], v11 offset:43520
s_add_u32 m0, s40, 20224
s_waitcnt lgkmcnt(8)
v_mfma_f32_32x32x16_bf16 v[176:191], v[104:107], a[208:211], v[176:191]
ds_read_b64_tr_b16 v[104:105], v8 offset:45056
ds_read_b64_tr_b16 v[106:107], v8 offset:45568
buffer_load_dwordx4 v13, s[24:27], s91 offen offset:256 lds
v_mfma_f32_32x32x16_bf16 v[192:207], v[108:111], a[208:211], v[192:207]
ds_read_b64_tr_b16 v[108:109], v11 offset:45056
ds_read_b64_tr_b16 v[110:111], v11 offset:45568
s_waitcnt lgkmcnt(8)
v_mfma_f32_32x32x16_bf16 v[112:127], v[88:91], a[64:67], v[112:127]
ds_read_b64_tr_b16 v[88:89], v8 offset:47104
ds_read_b64_tr_b16 v[90:91], v8 offset:47616
v_mfma_f32_32x32x16_bf16 v[128:143], v[92:95], a[64:67], v[128:143]
ds_read_b64_tr_b16 v[92:93], v11 offset:47104
ds_read_b64_tr_b16 v[94:95], v11 offset:47616
s_waitcnt lgkmcnt(8)
v_mfma_f32_32x32x16_bf16 v[112:127], v[96:99], a[68:71], v[112:127]
s_barrier
ds_read_b64_tr_b16 v[96:97], v8 offset:49152
ds_read_b64_tr_b16 v[98:99], v8 offset:49664
v_mfma_f32_32x32x16_bf16 v[128:143], v[100:103], a[68:71], v[128:143]
ds_read_b64_tr_b16 v[100:101], v11 offset:49152
ds_read_b64_tr_b16 v[102:103], v11 offset:49664
s_add_u32 m0, s40, 24320
s_waitcnt lgkmcnt(8)
v_mfma_f32_32x32x16_bf16 v[112:127], v[104:107], a[72:75], v[112:127]
ds_read_b64_tr_b16 v[104:105], v8 offset:51200
ds_read_b64_tr_b16 v[106:107], v8 offset:51712
buffer_load_dwordx4 v16, s[24:27], 0 offen offset:256 lds
v_mfma_f32_32x32x16_bf16 v[128:143], v[108:111], a[72:75], v[128:143]
ds_read_b64_tr_b16 v[108:109], v11 offset:51200
ds_read_b64_tr_b16 v[110:111], v11 offset:51712
s_waitcnt lgkmcnt(8)
v_mfma_f32_32x32x16_bf16 v[112:127], v[88:91], a[76:79], v[112:127]
ds_read_b64_tr_b16 v[88:89], v8 offset:53248
ds_read_b64_tr_b16 v[90:91], v8 offset:53760
v_mfma_f32_32x32x16_bf16 v[128:143], v[92:95], a[76:79], v[128:143]
ds_read_b64_tr_b16 v[92:93], v11 offset:53248
ds_read_b64_tr_b16 v[94:95], v11 offset:53760
v_mov_b32 v47, 3
s_waitcnt vmcnt(20)
s_barrier
s_add_u32 m0, s40, 28416
s_waitcnt lgkmcnt(8)
v_mfma_f32_32x32x16_bf16 v[112:127], v[96:99], a[80:83], v[112:127]
ds_read_b64_tr_b16 v[96:97], v8 offset:55296
ds_read_b64_tr_b16 v[98:99], v8 offset:55808
buffer_load_dwordx4 v19, s[16:19], 0 offen offset:256 lds
buffer_store_byte v47, v0, s[36:39], s1 offen sc1
v_mfma_f32_32x32x16_bf16 v[128:143], v[100:103], a[80:83], v[128:143]
ds_read_b64_tr_b16 v[100:101], v11 offset:55296
ds_read_b64_tr_b16 v[102:103], v11 offset:55808
s_waitcnt lgkmcnt(8)
v_mfma_f32_32x32x16_bf16 v[112:127], v[104:107], a[84:87], v[112:127]
s_barrier
ds_read_b64_tr_b16 v[104:105], v8 offset:57344
ds_read_b64_tr_b16 v[106:107], v8 offset:57856
v_mfma_f32_32x32x16_bf16 v[128:143], v[108:111], a[84:87], v[128:143]
ds_read_b64_tr_b16 v[108:109], v11 offset:57344
ds_read_b64_tr_b16 v[110:111], v11 offset:57856
s_add_u32 m0, s40, 32384
s_waitcnt lgkmcnt(8)
v_mfma_f32_32x32x16_bf16 v[112:127], v[88:91], a[88:91], v[112:127]
ds_read_b64_tr_b16 v[88:89], v8 offset:59392
ds_read_b64_tr_b16 v[90:91], v8 offset:59904
buffer_load_dwordx4 v2, s[24:27], s84 offen offset:384 lds
v_mfma_f32_32x32x16_bf16 v[128:143], v[92:95], a[88:91], v[128:143]
ds_read_b64_tr_b16 v[92:93], v11 offset:59392
ds_read_b64_tr_b16 v[94:95], v11 offset:59904
s_waitcnt lgkmcnt(8)
v_mfma_f32_32x32x16_bf16 v[112:127], v[96:99], a[92:95], v[112:127]
ds_read_b64_tr_b16 v[96:97], v8 offset:61440
ds_read_b64_tr_b16 v[98:99], v8 offset:61952
v_mfma_f32_32x32x16_bf16 v[128:143], v[100:103], a[92:95], v[128:143]
ds_read_b64_tr_b16 v[100:101], v11 offset:61440
ds_read_b64_tr_b16 v[102:103], v11 offset:61952
s_add_u32 m0, s40, 36480
s_waitcnt lgkmcnt(8)
v_mfma_f32_32x32x16_bf16 v[112:127], v[104:107], a[96:99], v[112:127]
ds_read_b64_tr_b16 v[104:105], v8 offset:63488
ds_read_b64_tr_b16 v[106:107], v8 offset:64000
buffer_load_dwordx4 v2, s[24:27], s85 offen offset:384 lds
v_mfma_f32_32x32x16_bf16 v[128:143], v[108:111], a[96:99], v[128:143]
ds_read_b64_tr_b16 v[108:109], v11 offset:63488
ds_read_b64_tr_b16 v[110:111], v11 offset:64000
s_waitcnt lgkmcnt(8)
v_mfma_f32_32x32x16_bf16 v[112:127], v[88:91], a[100:103], v[112:127]
s_barrier
ds_read_b64_tr_b16 v[88:89], v9 offset:0
ds_read_b64_tr_b16 v[90:91], v9 offset:512
v_mfma_f32_32x32x16_bf16 v[128:143], v[92:95], a[100:103], v[128:143]
ds_read_b64_tr_b16 v[92:93], v12 offset:0
ds_read_b64_tr_b16 v[94:95], v12 offset:512
s_add_u32 m0, s40, 40576
s_waitcnt lgkmcnt(8)
v_mfma_f32_32x32x16_bf16 v[112:127], v[96:99], a[104:107], v[112:127]
ds_read_b64_tr_b16 v[96:97], v9 offset:2048
ds_read_b64_tr_b16 v[98:99], v9 offset:2560
buffer_load_dwordx4 v2, s[24:27], s86 offen offset:384 lds
v_mfma_f32_32x32x16_bf16 v[128:143], v[100:103], a[104:107], v[128:143]
ds_read_b64_tr_b16 v[100:101], v12 offset:2048
ds_read_b64_tr_b16 v[102:103], v12 offset:2560
s_waitcnt lgkmcnt(8)
v_mfma_f32_32x32x16_bf16 v[112:127], v[104:107], a[108:111], v[112:127]
ds_read_b64_tr_b16 v[104:105], v9 offset:4096
ds_read_b64_tr_b16 v[106:107], v9 offset:4608
v_mfma_f32_32x32x16_bf16 v[128:143], v[108:111], a[108:111], v[128:143]
ds_read_b64_tr_b16 v[108:109], v12 offset:4096
ds_read_b64_tr_b16 v[110:111], v12 offset:4608
s_add_u32 m0, s40, 44672
s_waitcnt lgkmcnt(8)
s_waitcnt vmcnt(9)
v_mfma_f32_32x32x16_bf16 v[112:127], v[88:91], a[112:115], v[112:127]
ds_read_b64_tr_b16 v[88:89], v9 offset:6144
ds_read_b64_tr_b16 v[90:91], v9 offset:6656
buffer_load_dwordx4 v2, s[24:27], s87 offen offset:384 lds
v_mfma_f32_32x32x16_bf16 v[128:143], v[92:95], a[112:115], v[128:143]
ds_read_b64_tr_b16 v[92:93], v12 offset:6144
ds_read_b64_tr_b16 v[94:95], v12 offset:6656
s_waitcnt lgkmcnt(8)
v_mfma_f32_32x32x16_bf16 v[112:127], v[96:99], a[116:119], v[112:127]
s_barrier
ds_read_b64_tr_b16 v[96:97], v9 offset:8192
ds_read_b64_tr_b16 v[98:99], v9 offset:8704
v_mfma_f32_32x32x16_bf16 v[128:143], v[100:103], a[116:119], v[128:143]
ds_read_b64_tr_b16 v[100:101], v12 offset:8192
ds_read_b64_tr_b16 v[102:103], v12 offset:8704
s_add_u32 m0, s40, 48768
s_waitcnt lgkmcnt(8)
v_mfma_f32_32x32x16_bf16 v[112:127], v[104:107], a[120:123], v[112:127]
ds_read_b64_tr_b16 v[104:105], v9 offset:10240
ds_read_b64_tr_b16 v[106:107], v9 offset:10752
buffer_load_dwordx4 v2, s[24:27], s88 offen offset:384 lds
v_mfma_f32_32x32x16_bf16 v[128:143], v[108:111], a[120:123], v[128:143]
ds_read_b64_tr_b16 v[108:109], v12 offset:10240
ds_read_b64_tr_b16 v[110:111], v12 offset:10752
s_waitcnt lgkmcnt(8)
v_mfma_f32_32x32x16_bf16 v[112:127], v[88:91], a[124:127], v[112:127]
ds_read_b64_tr_b16 v[88:89], v9 offset:12288
ds_read_b64_tr_b16 v[90:91], v9 offset:12800
v_mfma_f32_32x32x16_bf16 v[128:143], v[92:95], a[124:127], v[128:143]
ds_read_b64_tr_b16 v[92:93], v12 offset:12288
ds_read_b64_tr_b16 v[94:95], v12 offset:12800
s_add_u32 m0, s40, 52864
s_waitcnt lgkmcnt(8)
v_mfma_f32_32x32x16_bf16 v[112:127], v[96:99], a[16:19], v[112:127]
ds_read_b64_tr_b16 v[96:97], v9 offset:14336
ds_read_b64_tr_b16 v[98:99], v9 offset:14848
buffer_load_dwordx4 v2, s[24:27], s89 offen offset:384 lds
v_mfma_f32_32x32x16_bf16 v[128:143], v[100:103], a[16:19], v[128:143]
ds_read_b64_tr_b16 v[100:101], v12 offset:14336
ds_read_b64_tr_b16 v[102:103], v12 offset:14848
s_waitcnt lgkmcnt(8)
v_mfma_f32_32x32x16_bf16 v[112:127], v[104:107], a[20:23], v[112:127]
ds_read_b64_tr_b16 v[104:105], v17 offset:4096
ds_read_b64_tr_b16 v[106:107], v17 offset:4608
v_mfma_f32_32x32x16_bf16 v[128:143], v[108:111], a[20:23], v[128:143]
ds_read_b64_tr_b16 v[108:109], v18 offset:4096
ds_read_b64_tr_b16 v[110:111], v18 offset:4608
s_add_u32 m0, s40, 56960
s_waitcnt lgkmcnt(8)
v_mfma_f32_32x32x16_bf16 v[112:127], v[88:91], a[24:27], v[112:127]
s_barrier
ds_read_b64_tr_b16 v[88:89], v9 offset:16384
ds_read_b64_tr_b16 v[90:91], v9 offset:16896
buffer_load_dwordx4 v2, s[24:27], s90 offen offset:384 lds
v_mfma_f32_32x32x16_bf16 v[128:143], v[92:95], a[24:27], v[128:143]
ds_read_b64_tr_b16 v[92:93], v12 offset:16384
ds_read_b64_tr_b16 v[94:95], v12 offset:16896
s_waitcnt lgkmcnt(8)
v_mfma_f32_32x32x16_bf16 v[112:127], v[96:99], a[28:31], v[112:127]
ds_read_b64_tr_b16 v[96:97], v9 offset:18432
ds_read_b64_tr_b16 v[98:99], v9 offset:18944
v_mfma_f32_32x32x16_bf16 v[128:143], v[100:103], a[28:31], v[128:143]
ds_read_b64_tr_b16 v[100:101], v12 offset:18432
ds_read_b64_tr_b16 v[102:103], v12 offset:18944
s_add_u32 m0, s40, 61056
s_waitcnt lgkmcnt(8)
v_mfma_f32_32x32x16_bf16 v[112:127], v[104:107], a[48:51], v[112:127]
ds_read_b64_tr_b16 v[104:105], v9 offset:20480
ds_read_b64_tr_b16 v[106:107], v9 offset:20992
buffer_load_dwordx4 v2, s[24:27], s91 offen offset:384 lds
v_mfma_f32_32x32x16_bf16 v[128:143], v[108:111], a[48:51], v[128:143]
ds_read_b64_tr_b16 v[108:109], v12 offset:20480
ds_read_b64_tr_b16 v[110:111], v12 offset:20992
s_waitcnt lgkmcnt(8)
v_mfma_f32_32x32x16_bf16 v[144:159], v[88:91], a[64:67], v[144:159]
ds_read_b64_tr_b16 v[88:89], v9 offset:22528
ds_read_b64_tr_b16 v[90:91], v9 offset:23040
v_mfma_f32_32x32x16_bf16 v[160:175], v[92:95], a[64:67], v[160:175]
ds_read_b64_tr_b16 v[92:93], v12 offset:22528
ds_read_b64_tr_b16 v[94:95], v12 offset:23040
s_waitcnt lgkmcnt(8)
v_mfma_f32_32x32x16_bf16 v[144:159], v[96:99], a[68:71], v[144:159]
s_barrier
ds_read_b64_tr_b16 v[96:97], v9 offset:24576
ds_read_b64_tr_b16 v[98:99], v9 offset:25088
v_mfma_f32_32x32x16_bf16 v[160:175], v[100:103], a[68:71], v[160:175]
ds_read_b64_tr_b16 v[100:101], v12 offset:24576
ds_read_b64_tr_b16 v[102:103], v12 offset:25088
v_cvt_pk_bf16_f32 v24, v112, v113
v_cvt_pk_bf16_f32 v25, v114, v115
s_add_u32 m0, s40, 65152
s_waitcnt lgkmcnt(8)
v_mfma_f32_32x32x16_bf16 v[144:159], v[104:107], a[72:75], v[144:159]
ds_read_b64_tr_b16 v[104:105], v9 offset:26624
ds_read_b64_tr_b16 v[106:107], v9 offset:27136
buffer_load_dwordx4 v3, s[24:27], 0 offen offset:384 lds
v_cvt_pk_bf16_f32 v26, v116, v117
v_cvt_pk_bf16_f32 v27, v118, v119
v_mfma_f32_32x32x16_bf16 v[160:175], v[108:111], a[72:75], v[160:175]
ds_read_b64_tr_b16 v[108:109], v12 offset:26624
ds_read_b64_tr_b16 v[110:111], v12 offset:27136
s_mov_b32 s6, 16384
buffer_store_dwordx4 v[24:27], v21, s[36:39], s6 offen offset:0 sc1
v_cvt_pk_bf16_f32 v28, v120, v121
s_waitcnt lgkmcnt(8)
v_mfma_f32_32x32x16_bf16 v[144:159], v[88:91], a[76:79], v[144:159]
ds_read_b64_tr_b16 v[88:89], v9 offset:28672
ds_read_b64_tr_b16 v[90:91], v9 offset:29184
v_cvt_pk_bf16_f32 v29, v122, v123
v_cvt_pk_bf16_f32 v30, v124, v125
v_cvt_pk_bf16_f32 v31, v126, v127
v_mfma_f32_32x32x16_bf16 v[160:175], v[92:95], a[76:79], v[160:175]
ds_read_b64_tr_b16 v[92:93], v12 offset:28672
ds_read_b64_tr_b16 v[94:95], v12 offset:29184
s_mov_b32 s6, 16384
buffer_store_dwordx4 v[28:31], v21, s[36:39], s6 offen offset:1024 sc1
s_add_u32 m0, s40, 69248
s_waitcnt lgkmcnt(8)
v_mfma_f32_32x32x16_bf16 v[144:159], v[96:99], a[80:83], v[144:159]
ds_read_b64_tr_b16 v[96:97], v9 offset:30720
ds_read_b64_tr_b16 v[98:99], v9 offset:31232
buffer_load_dwordx4 v10, s[16:19], 0 offen offset:384 lds
v_cvt_pk_bf16_f32 v32, v128, v129
v_cvt_pk_bf16_f32 v33, v130, v131
v_mfma_f32_32x32x16_bf16 v[160:175], v[100:103], a[80:83], v[160:175]
ds_read_b64_tr_b16 v[100:101], v12 offset:30720
ds_read_b64_tr_b16 v[102:103], v12 offset:31232
v_cvt_pk_bf16_f32 v34, v132, v133
v_cvt_pk_bf16_f32 v35, v134, v135
s_waitcnt lgkmcnt(8)
v_mfma_f32_32x32x16_bf16 v[144:159], v[104:107], a[84:87], v[144:159]
s_barrier
ds_read_b64_tr_b16 v[104:105], v9 offset:32768
ds_read_b64_tr_b16 v[106:107], v9 offset:33280
s_mov_b32 s6, 16384
buffer_store_dwordx4 v[32:35], v21, s[36:39], s6 offen offset:2048 sc1
v_mfma_f32_32x32x16_bf16 v[160:175], v[108:111], a[84:87], v[160:175]
ds_read_b64_tr_b16 v[108:109], v12 offset:32768
ds_read_b64_tr_b16 v[110:111], v12 offset:33280
v_cvt_pk_bf16_f32 v36, v136, v137
v_cvt_pk_bf16_f32 v37, v138, v139
s_add_u32 m0, s40, 73344
s_waitcnt lgkmcnt(8)
v_mfma_f32_32x32x16_bf16 v[144:159], v[88:91], a[88:91], v[144:159]
ds_read_b64_tr_b16 v[88:89], v9 offset:34816
ds_read_b64_tr_b16 v[90:91], v9 offset:35328
buffer_load_dwordx4 v13, s[24:27], s84 offen offset:384 lds
v_cvt_pk_bf16_f32 v38, v140, v141
v_cvt_pk_bf16_f32 v39, v142, v143
v_mfma_f32_32x32x16_bf16 v[160:175], v[92:95], a[88:91], v[160:175]
ds_read_b64_tr_b16 v[92:93], v12 offset:34816
ds_read_b64_tr_b16 v[94:95], v12 offset:35328
s_mov_b32 s6, 16384
buffer_store_dwordx4 v[36:39], v21, s[36:39], s6 offen offset:3072 sc1
s_waitcnt lgkmcnt(8)
v_mfma_f32_32x32x16_bf16 v[144:159], v[96:99], a[92:95], v[144:159]
ds_read_b64_tr_b16 v[96:97], v9 offset:36864
ds_read_b64_tr_b16 v[98:99], v9 offset:37376
v_mfma_f32_32x32x16_bf16 v[160:175], v[100:103], a[92:95], v[160:175]
ds_read_b64_tr_b16 v[100:101], v12 offset:36864
ds_read_b64_tr_b16 v[102:103], v12 offset:37376
s_add_u32 m0, s40, 77440
s_waitcnt lgkmcnt(8)
v_mfma_f32_32x32x16_bf16 v[144:159], v[104:107], a[96:99], v[144:159]
ds_read_b64_tr_b16 v[104:105], v9 offset:38912
ds_read_b64_tr_b16 v[106:107], v9 offset:39424
buffer_load_dwordx4 v13, s[24:27], s85 offen offset:384 lds
v_mfma_f32_32x32x16_bf16 v[160:175], v[108:111], a[96:99], v[160:175]
ds_read_b64_tr_b16 v[108:109], v12 offset:38912
ds_read_b64_tr_b16 v[110:111], v12 offset:39424
s_waitcnt lgkmcnt(8)
v_mfma_f32_32x32x16_bf16 v[144:159], v[88:91], a[100:103], v[144:159]
s_barrier
ds_read_b64_tr_b16 v[88:89], v9 offset:40960
ds_read_b64_tr_b16 v[90:91], v9 offset:41472
v_mfma_f32_32x32x16_bf16 v[160:175], v[92:95], a[100:103], v[160:175]
ds_read_b64_tr_b16 v[92:93], v12 offset:40960
ds_read_b64_tr_b16 v[94:95], v12 offset:41472
s_add_u32 m0, s40, 81536
s_waitcnt lgkmcnt(8)
v_mfma_f32_32x32x16_bf16 v[144:159], v[96:99], a[104:107], v[144:159]
ds_read_b64_tr_b16 v[96:97], v9 offset:43008
ds_read_b64_tr_b16 v[98:99], v9 offset:43520
buffer_load_dwordx4 v13, s[24:27], s86 offen offset:384 lds
v_mfma_f32_32x32x16_bf16 v[160:175], v[100:103], a[104:107], v[160:175]
ds_read_b64_tr_b16 v[100:101], v12 offset:43008
ds_read_b64_tr_b16 v[102:103], v12 offset:43520
s_waitcnt lgkmcnt(8)
v_mfma_f32_32x32x16_bf16 v[144:159], v[104:107], a[108:111], v[144:159]
ds_read_b64_tr_b16 v[104:105], v9 offset:45056
ds_read_b64_tr_b16 v[106:107], v9 offset:45568
v_mfma_f32_32x32x16_bf16 v[160:175], v[108:111], a[108:111], v[160:175]
ds_read_b64_tr_b16 v[108:109], v12 offset:45056
ds_read_b64_tr_b16 v[110:111], v12 offset:45568
s_add_u32 m0, s40, 85632
s_waitcnt lgkmcnt(8)
v_mfma_f32_32x32x16_bf16 v[144:159], v[88:91], a[112:115], v[144:159]
ds_read_b64_tr_b16 v[88:89], v9 offset:47104
ds_read_b64_tr_b16 v[90:91], v9 offset:47616
buffer_load_dwordx4 v13, s[24:27], s87 offen offset:384 lds
v_mfma_f32_32x32x16_bf16 v[160:175], v[92:95], a[112:115], v[160:175]
ds_read_b64_tr_b16 v[92:93], v12 offset:47104
ds_read_b64_tr_b16 v[94:95], v12 offset:47616
s_waitcnt lgkmcnt(8)
v_mfma_f32_32x32x16_bf16 v[144:159], v[96:99], a[116:119], v[144:159]
s_barrier
ds_read_b64_tr_b16 v[96:97], v9 offset:49152
ds_read_b64_tr_b16 v[98:99], v9 offset:49664
v_mfma_f32_32x32x16_bf16 v[160:175], v[100:103], a[116:119], v[160:175]
ds_read_b64_tr_b16 v[100:101], v12 offset:49152
ds_read_b64_tr_b16 v[102:103], v12 offset:49664
s_add_u32 m0, s40, 89728
s_waitcnt lgkmcnt(8)
v_mfma_f32_32x32x16_bf16 v[144:159], v[104:107], a[120:123], v[144:159]
ds_read_b64_tr_b16 v[104:105], v9 offset:51200
ds_read_b64_tr_b16 v[106:107], v9 offset:51712
buffer_load_dwordx4 v13, s[24:27], s88 offen offset:384 lds
v_mfma_f32_32x32x16_bf16 v[160:175], v[108:111], a[120:123], v[160:175]
ds_read_b64_tr_b16 v[108:109], v12 offset:51200
ds_read_b64_tr_b16 v[110:111], v12 offset:51712
s_waitcnt lgkmcnt(8)
v_mfma_f32_32x32x16_bf16 v[144:159], v[88:91], a[124:127], v[144:159]
ds_read_b64_tr_b16 v[88:89], v9 offset:53248
ds_read_b64_tr_b16 v[90:91], v9 offset:53760
v_mfma_f32_32x32x16_bf16 v[160:175], v[92:95], a[124:127], v[160:175]
ds_read_b64_tr_b16 v[92:93], v12 offset:53248
ds_read_b64_tr_b16 v[94:95], v12 offset:53760
s_add_u32 m0, s40, 93824
s_waitcnt lgkmcnt(8)
v_mfma_f32_32x32x16_bf16 v[144:159], v[96:99], a[16:19], v[144:159]
ds_read_b64_tr_b16 v[96:97], v9 offset:55296
ds_read_b64_tr_b16 v[98:99], v9 offset:55808
buffer_load_dwordx4 v13, s[24:27], s89 offen offset:384 lds
v_mfma_f32_32x32x16_bf16 v[160:175], v[100:103], a[16:19], v[160:175]
ds_read_b64_tr_b16 v[100:101], v12 offset:55296
ds_read_b64_tr_b16 v[102:103], v12 offset:55808
s_waitcnt lgkmcnt(8)
v_mfma_f32_32x32x16_bf16 v[144:159], v[104:107], a[20:23], v[144:159]
ds_read_b64_tr_b16 v[104:105], v17 offset:5120
ds_read_b64_tr_b16 v[106:107], v17 offset:5632
v_mfma_f32_32x32x16_bf16 v[160:175], v[108:111], a[20:23], v[160:175]
ds_read_b64_tr_b16 v[108:109], v18 offset:5120
ds_read_b64_tr_b16 v[110:111], v18 offset:5632
s_add_u32 m0, s40, 97920
s_waitcnt lgkmcnt(8)
v_mfma_f32_32x32x16_bf16 v[144:159], v[88:91], a[24:27], v[144:159]
s_barrier
ds_read_b64_tr_b16 v[88:89], v9 offset:57344
ds_read_b64_tr_b16 v[90:91], v9 offset:57856
buffer_load_dwordx4 v13, s[24:27], s90 offen offset:384 lds
v_mfma_f32_32x32x16_bf16 v[160:175], v[92:95], a[24:27], v[160:175]
ds_read_b64_tr_b16 v[92:93], v12 offset:57344
ds_read_b64_tr_b16 v[94:95], v12 offset:57856
s_waitcnt lgkmcnt(8)
v_mfma_f32_32x32x16_bf16 v[144:159], v[96:99], a[28:31], v[144:159]
ds_read_b64_tr_b16 v[96:97], v9 offset:59392
ds_read_b64_tr_b16 v[98:99], v9 offset:59904
v_mfma_f32_32x32x16_bf16 v[160:175], v[100:103], a[28:31], v[160:175]
ds_read_b64_tr_b16 v[100:101], v12 offset:59392
ds_read_b64_tr_b16 v[102:103], v12 offset:59904
buffer_load_ubyte v46, v45, s[36:39], s1 offen sc1
s_add_u32 m0, s40, 102016
s_waitcnt lgkmcnt(8)
v_mfma_f32_32x32x16_bf16 v[144:159], v[104:107], a[48:51], v[144:159]
ds_read_b64_tr_b16 v[104:105], v9 offset:61440
ds_read_b64_tr_b16 v[106:107], v9 offset:61952
buffer_load_dwordx4 v13, s[24:27], s91 offen offset:384 lds
v_mfma_f32_32x32x16_bf16 v[160:175], v[108:111], a[48:51], v[160:175]
ds_read_b64_tr_b16 v[108:109], v12 offset:61440
ds_read_b64_tr_b16 v[110:111], v12 offset:61952
s_waitcnt lgkmcnt(8)
v_mfma_f32_32x32x16_bf16 v[176:191], v[88:91], a[64:67], v[176:191]
ds_read_b64_tr_b16 v[88:89], v9 offset:63488
ds_read_b64_tr_b16 v[90:91], v9 offset:64000
v_mfma_f32_32x32x16_bf16 v[192:207], v[92:95], a[64:67], v[192:207]
ds_read_b64_tr_b16 v[92:93], v12 offset:63488
ds_read_b64_tr_b16 v[94:95], v12 offset:64000
s_waitcnt lgkmcnt(8)
v_mfma_f32_32x32x16_bf16 v[176:191], v[96:99], a[68:71], v[176:191]
s_barrier
ds_read_b64_tr_b16 v[96:97], v8 offset:0
ds_read_b64_tr_b16 v[98:99], v8 offset:512
v_mfma_f32_32x32x16_bf16 v[192:207], v[100:103], a[68:71], v[192:207]
ds_read_b64_tr_b16 v[100:101], v11 offset:0
ds_read_b64_tr_b16 v[102:103], v11 offset:512
v_cvt_pk_bf16_f32 v24, v144, v145
v_cvt_pk_bf16_f32 v25, v146, v147
s_add_u32 m0, s40, 106112
s_waitcnt lgkmcnt(8)
v_mfma_f32_32x32x16_bf16 v[176:191], v[104:107], a[72:75], v[176:191]
ds_read_b64_tr_b16 v[104:105], v8 offset:2048
ds_read_b64_tr_b16 v[106:107], v8 offset:2560
buffer_load_dwordx4 v16, s[24:27], 0 offen offset:384 lds
v_cvt_pk_bf16_f32 v26, v148, v149
v_cvt_pk_bf16_f32 v27, v150, v151
v_mfma_f32_32x32x16_bf16 v[192:207], v[108:111], a[72:75], v[192:207]
ds_read_b64_tr_b16 v[108:109], v11 offset:2048
ds_read_b64_tr_b16 v[110:111], v11 offset:2560
s_mov_b32 s6, 32768
buffer_store_dwordx4 v[24:27], v21, s[36:39], s6 offen offset:0 sc1
v_cvt_pk_bf16_f32 v28, v152, v153
s_waitcnt lgkmcnt(8)
v_mfma_f32_32x32x16_bf16 v[176:191], v[88:91], a[76:79], v[176:191]
ds_read_b64_tr_b16 v[88:89], v8 offset:4096
ds_read_b64_tr_b16 v[90:91], v8 offset:4608
v_cvt_pk_bf16_f32 v29, v154, v155
v_cvt_pk_bf16_f32 v30, v156, v157
v_cvt_pk_bf16_f32 v31, v158, v159
v_mfma_f32_32x32x16_bf16 v[192:207], v[92:95], a[76:79], v[192:207]
ds_read_b64_tr_b16 v[92:93], v11 offset:4096
ds_read_b64_tr_b16 v[94:95], v11 offset:4608
s_mov_b32 s6, 32768
buffer_store_dwordx4 v[28:31], v21, s[36:39], s6 offen offset:1024 sc1
s_add_u32 m0, s40, 110208
s_waitcnt lgkmcnt(8)
v_mfma_f32_32x32x16_bf16 v[176:191], v[96:99], a[80:83], v[176:191]
ds_read_b64_tr_b16 v[96:97], v8 offset:6144
ds_read_b64_tr_b16 v[98:99], v8 offset:6656
buffer_load_dwordx4 v19, s[16:19], 0 offen offset:384 lds
v_cvt_pk_bf16_f32 v32, v160, v161
v_cvt_pk_bf16_f32 v33, v162, v163
v_mfma_f32_32x32x16_bf16 v[192:207], v[100:103], a[80:83], v[192:207]
ds_read_b64_tr_b16 v[100:101], v11 offset:6144
ds_read_b64_tr_b16 v[102:103], v11 offset:6656
v_cvt_pk_bf16_f32 v34, v164, v165
v_cvt_pk_bf16_f32 v35, v166, v167
s_waitcnt lgkmcnt(8)
v_mfma_f32_32x32x16_bf16 v[176:191], v[104:107], a[84:87], v[176:191]
s_waitcnt vmcnt(32)
s_barrier
ds_read_b64_tr_b16 v[104:105], v8 offset:8192
ds_read_b64_tr_b16 v[106:107], v8 offset:8704
s_mov_b32 s6, 32768
buffer_store_dwordx4 v[32:35], v21, s[36:39], s6 offen offset:2048 sc1
v_mfma_f32_32x32x16_bf16 v[192:207], v[108:111], a[84:87], v[192:207]
ds_read_b64_tr_b16 v[108:109], v11 offset:8192
ds_read_b64_tr_b16 v[110:111], v11 offset:8704
v_cvt_pk_bf16_f32 v36, v168, v169
v_cvt_pk_bf16_f32 v37, v170, v171
v_cvt_pk_bf16_f32 v38, v172, v173
s_waitcnt lgkmcnt(8)
v_mfma_f32_32x32x16_bf16 v[176:191], v[88:91], a[88:91], v[176:191]
ds_read_b64_tr_b16 v[88:89], v8 offset:10240
ds_read_b64_tr_b16 v[90:91], v8 offset:10752
v_cvt_pk_bf16_f32 v39, v174, v175
s_mov_b32 s6, 32768
buffer_store_dwordx4 v[36:39], v21, s[36:39], s6 offen offset:3072 sc1
v_mfma_f32_32x32x16_bf16 v[192:207], v[92:95], a[88:91], v[192:207]
ds_read_b64_tr_b16 v[92:93], v11 offset:10240
ds_read_b64_tr_b16 v[94:95], v11 offset:10752
s_waitcnt lgkmcnt(8)
v_mfma_f32_32x32x16_bf16 v[176:191], v[96:99], a[92:95], v[176:191]
ds_read_b64_tr_b16 v[96:97], v8 offset:12288
ds_read_b64_tr_b16 v[98:99], v8 offset:12800
v_mfma_f32_32x32x16_bf16 v[192:207], v[100:103], a[92:95], v[192:207]
ds_read_b64_tr_b16 v[100:101], v11 offset:12288
ds_read_b64_tr_b16 v[102:103], v11 offset:12800
s_waitcnt lgkmcnt(8)
v_mfma_f32_32x32x16_bf16 v[176:191], v[104:107], a[96:99], v[176:191]
ds_read_b64_tr_b16 v[104:105], v8 offset:14336
ds_read_b64_tr_b16 v[106:107], v8 offset:14848
v_mfma_f32_32x32x16_bf16 v[192:207], v[108:111], a[96:99], v[192:207]
ds_read_b64_tr_b16 v[108:109], v11 offset:14336
ds_read_b64_tr_b16 v[110:111], v11 offset:14848
s_waitcnt lgkmcnt(8)
v_mfma_f32_32x32x16_bf16 v[176:191], v[88:91], a[100:103], v[176:191]
s_waitcnt vmcnt(32)
s_barrier
ds_read_b64_tr_b16 v[88:89], v8 offset:16384
ds_read_b64_tr_b16 v[90:91], v8 offset:16896
v_mfma_f32_32x32x16_bf16 v[192:207], v[92:95], a[100:103], v[192:207]
ds_read_b64_tr_b16 v[92:93], v11 offset:16384
ds_read_b64_tr_b16 v[94:95], v11 offset:16896
s_waitcnt lgkmcnt(8)
v_mfma_f32_32x32x16_bf16 v[176:191], v[96:99], a[104:107], v[176:191]
ds_read_b64_tr_b16 v[96:97], v8 offset:18432
ds_read_b64_tr_b16 v[98:99], v8 offset:18944
v_mfma_f32_32x32x16_bf16 v[192:207], v[100:103], a[104:107], v[192:207]
ds_read_b64_tr_b16 v[100:101], v11 offset:18432
ds_read_b64_tr_b16 v[102:103], v11 offset:18944
s_waitcnt lgkmcnt(8)
v_mfma_f32_32x32x16_bf16 v[176:191], v[104:107], a[108:111], v[176:191]
ds_read_b64_tr_b16 v[104:105], v8 offset:20480
ds_read_b64_tr_b16 v[106:107], v8 offset:20992
v_mfma_f32_32x32x16_bf16 v[192:207], v[108:111], a[108:111], v[192:207]
ds_read_b64_tr_b16 v[108:109], v11 offset:20480
ds_read_b64_tr_b16 v[110:111], v11 offset:20992
s_waitcnt lgkmcnt(8)
v_mfma_f32_32x32x16_bf16 v[176:191], v[88:91], a[112:115], v[176:191]
ds_read_b64_tr_b16 v[88:89], v8 offset:22528
ds_read_b64_tr_b16 v[90:91], v8 offset:23040
v_mfma_f32_32x32x16_bf16 v[192:207], v[92:95], a[112:115], v[192:207]
ds_read_b64_tr_b16 v[92:93], v11 offset:22528
ds_read_b64_tr_b16 v[94:95], v11 offset:23040
s_waitcnt lgkmcnt(8)
v_mfma_f32_32x32x16_bf16 v[176:191], v[96:99], a[116:119], v[176:191]
s_waitcnt vmcnt(30)
s_barrier
ds_read_b64_tr_b16 v[96:97], v8 offset:24576
ds_read_b64_tr_b16 v[98:99], v8 offset:25088
v_mfma_f32_32x32x16_bf16 v[192:207], v[100:103], a[116:119], v[192:207]
ds_read_b64_tr_b16 v[100:101], v11 offset:24576
ds_read_b64_tr_b16 v[102:103], v11 offset:25088
v_mov_b32 v47, 4
s_waitcnt vmcnt(14)
s_barrier
s_waitcnt lgkmcnt(8)
v_mfma_f32_32x32x16_bf16 v[176:191], v[104:107], a[120:123], v[176:191]
ds_read_b64_tr_b16 v[104:105], v8 offset:26624
ds_read_b64_tr_b16 v[106:107], v8 offset:27136
buffer_store_byte v47, v0, s[36:39], s1 offen sc1
s_waitcnt vmcnt(8)
v_mfma_f32_32x32x16_bf16 v[192:207], v[108:111], a[120:123], v[192:207]
ds_read_b64_tr_b16 v[108:109], v11 offset:26624
ds_read_b64_tr_b16 v[110:111], v11 offset:27136
v_cmp_gt_u32 vcc, 3, v46
s_cmp_lg_u64 vcc, 0
s_cbranch_scc1 L_slow3
L_back3:
s_waitcnt lgkmcnt(8)
v_mfma_f32_32x32x16_bf16 v[176:191], v[88:91], a[124:127], v[176:191]
ds_read_b64_tr_b16 v[88:89], v8 offset:28672
ds_read_b64_tr_b16 v[90:91], v8 offset:29184
s_mov_b32 s7, 0
buffer_load_dwordx4 a[232:235], v40, s[36:39], s7 offen sc1
v_mfma_f32_32x32x16_bf16 v[192:207], v[92:95], a[124:127], v[192:207]
ds_read_b64_tr_b16 v[92:93], v11 offset:28672
ds_read_b64_tr_b16 v[94:95], v11 offset:29184
s_mov_b32 s7, 720896
buffer_load_dwordx4 a[236:239], v40, s[36:39], s7 offen sc1
s_waitcnt lgkmcnt(8)
v_mfma_f32_32x32x16_bf16 v[176:191], v[96:99], a[16:19], v[176:191]
ds_read_b64_tr_b16 v[96:97], v8 offset:30720
ds_read_b64_tr_b16 v[98:99], v8 offset:31232
s_mov_b32 s7, 1441792
buffer_load_dwordx4 a[240:243], v40, s[36:39], s7 offen sc1
v_mfma_f32_32x32x16_bf16 v[192:207], v[100:103], a[16:19], v[192:207]
ds_read_b64_tr_b16 v[100:101], v11 offset:30720
ds_read_b64_tr_b16 v[102:103], v11 offset:31232
s_mov_b32 s7, 2162688
buffer_load_dwordx4 a[244:247], v40, s[36:39], s7 offen sc1
s_waitcnt lgkmcnt(8)
v_mfma_f32_32x32x16_bf16 v[176:191], v[104:107], a[20:23], v[176:191]
ds_read_b64_tr_b16 v[104:105], v17 offset:6144
ds_read_b64_tr_b16 v[106:107], v17 offset:6656
v_mfma_f32_32x32x16_bf16 v[192:207], v[108:111], a[20:23], v[192:207]
ds_read_b64_tr_b16 v[108:109], v18 offset:6144
ds_read_b64_tr_b16 v[110:111], v18 offset:6656
s_waitcnt lgkmcnt(8)
v_mfma_f32_32x32x16_bf16 v[176:191], v[88:91], a[24:27], v[176:191]
s_barrier
ds_read_b64_tr_b16 v[88:89], v8 offset:32768
ds_read_b64_tr_b16 v[90:91], v8 offset:33280
v_mfma_f32_32x32x16_bf16 v[192:207], v[92:95], a[24:27], v[192:207]
ds_read_b64_tr_b16 v[92:93], v11 offset:32768
ds_read_b64_tr_b16 v[94:95], v11 offset:33280
s_waitcnt lgkmcnt(8)
v_mfma_f32_32x32x16_bf16 v[176:191], v[96:99], a[28:31], v[176:191]
ds_read_b64_tr_b16 v[96:97], v8 offset:34816
ds_read_b64_tr_b16 v[98:99], v8 offset:35328
v_mfma_f32_32x32x16_bf16 v[192:207], v[100:103], a[28:31], v[192:207]
ds_read_b64_tr_b16 v[100:101], v11 offset:34816
ds_read_b64_tr_b16 v[102:103], v11 offset:35328
s_waitcnt lgkmcnt(8)
v_mfma_f32_32x32x16_bf16 v[176:191], v[104:107], a[48:51], v[176:191]
ds_read_b64_tr_b16 v[104:105], v8 offset:36864
ds_read_b64_tr_b16 v[106:107], v8 offset:37376
v_mfma_f32_32x32x16_bf16 v[192:207], v[108:111], a[48:51], v[192:207]
ds_read_b64_tr_b16 v[108:109], v11 offset:36864
ds_read_b64_tr_b16 v[110:111], v11 offset:37376
s_waitcnt lgkmcnt(8)
v_mfma_f32_32x32x16_bf16 v[208:223], v[88:91], a[128:131], 0
ds_read_b64_tr_b16 v[88:89], v8 offset:38912
ds_read_b64_tr_b16 v[90:91], v8 offset:39424
v_mfma_f32_32x32x16_bf16 v[224:239], v[92:95], a[128:131], 0
ds_read_b64_tr_b16 v[92:93], v11 offset:38912
ds_read_b64_tr_b16 v[94:95], v11 offset:39424
s_waitcnt lgkmcnt(8)
v_mfma_f32_32x32x16_bf16 v[208:223], v[96:99], a[132:135], v[208:223]
s_barrier
ds_read_b64_tr_b16 v[96:97], v8 offset:40960
ds_read_b64_tr_b16 v[98:99], v8 offset:41472
v_mfma_f32_32x32x16_bf16 v[224:239], v[100:103], a[132:135], v[224:239]
ds_read_b64_tr_b16 v[100:101], v11 offset:40960
ds_read_b64_tr_b16 v[102:103], v11 offset:41472
v_cvt_pk_bf16_f32 v24, v176, v177
v_cvt_pk_bf16_f32 v25, v178, v179
v_cvt_pk_bf16_f32 v26, v180, v181
s_waitcnt lgkmcnt(8)
v_mfma_f32_32x32x16_bf16 v[208:223], v[104:107], a[136:139], v[208:223]
ds_read_b64_tr_b16 v[104:105], v8 offset:43008
ds_read_b64_tr_b16 v[106:107], v8 offset:43520
v_cvt_pk_bf16_f32 v27, v182, v183
s_mov_b32 s6, 49152
buffer_store_dwordx4 v[24:27], v21, s[36:39], s6 offen offset:0 sc1
v_mfma_f32_32x32x16_bf16 v[224:239], v[108:111], a[136:139], v[224:239]
ds_read_b64_tr_b16 v[108:109], v11 offset:43008
ds_read_b64_tr_b16 v[110:111], v11 offset:43520
v_cvt_pk_bf16_f32 v28, v184, v185
v_cvt_pk_bf16_f32 v29, v186, v187
v_cvt_pk_bf16_f32 v30, v188, v189
s_waitcnt lgkmcnt(8)
v_mfma_f32_32x32x16_bf16 v[208:223], v[88:91], a[140:143], v[208:223]
ds_read_b64_tr_b16 v[88:89], v8 offset:45056
ds_read_b64_tr_b16 v[90:91], v8 offset:45568
v_cvt_pk_bf16_f32 v31, v190, v191
s_mov_b32 s6, 49152
buffer_store_dwordx4 v[28:31], v21, s[36:39], s6 offen offset:1024 sc1
v_mfma_f32_32x32x16_bf16 v[224:239], v[92:95], a[140:143], v[224:239]
ds_read_b64_tr_b16 v[92:93], v11 offset:45056
ds_read_b64_tr_b16 v[94:95], v11 offset:45568
v_cvt_pk_bf16_f32 v32, v192, v193
v_cvt_pk_bf16_f32 v33, v194, v195
v_cvt_pk_bf16_f32 v34, v196, v197
s_waitcnt lgkmcnt(8)
v_mfma_f32_32x32x16_bf16 v[208:223], v[96:99], a[144:147], v[208:223]
ds_read_b64_tr_b16 v[96:97], v8 offset:47104
ds_read_b64_tr_b16 v[98:99], v8 offset:47616
v_cvt_pk_bf16_f32 v35, v198, v199
s_mov_b32 s6, 49152
buffer_store_dwordx4 v[32:35], v21, s[36:39], s6 offen offset:2048 sc1
v_mfma_f32_32x32x16_bf16 v[224:239], v[100:103], a[144:147], v[224:239]
ds_read_b64_tr_b16 v[100:101], v11 offset:47104
ds_read_b64_tr_b16 v[102:103], v11 offset:47616
v_cvt_pk_bf16_f32 v36, v200, v201
v_cvt_pk_bf16_f32 v37, v202, v203
v_cvt_pk_bf16_f32 v38, v204, v205
s_waitcnt lgkmcnt(8)
v_mfma_f32_32x32x16_bf16 v[208:223], v[104:107], a[148:151], v[208:223]
s_barrier
ds_read_b64_tr_b16 v[104:105], v8 offset:49152
ds_read_b64_tr_b16 v[106:107], v8 offset:49664
v_cvt_pk_bf16_f32 v39, v206, v207
v_mfma_f32_32x32x16_bf16 v[224:239], v[108:111], a[148:151], v[224:239]
ds_read_b64_tr_b16 v[108:109], v11 offset:49152
ds_read_b64_tr_b16 v[110:111], v11 offset:49664
s_mov_b32 s6, 49152
buffer_store_dwordx4 v[36:39], v21, s[36:39], s6 offen offset:3072 sc1
s_waitcnt lgkmcnt(8)
v_mfma_f32_32x32x16_bf16 v[208:223], v[88:91], a[152:155], v[208:223]
ds_read_b64_tr_b16 v[88:89], v8 offset:51200
ds_read_b64_tr_b16 v[90:91], v8 offset:51712
v_mfma_f32_32x32x16_bf16 v[224:239], v[92:95], a[152:155], v[224:239]
ds_read_b64_tr_b16 v[92:93], v11 offset:51200
ds_read_b64_tr_b16 v[94:95], v11 offset:51712
s_waitcnt lgkmcnt(8)
v_mfma_f32_32x32x16_bf16 v[208:223], v[96:99], a[156:159], v[208:223]
ds_read_b64_tr_b16 v[96:97], v8 offset:53248
ds_read_b64_tr_b16 v[98:99], v8 offset:53760
v_mfma_f32_32x32x16_bf16 v[224:239], v[100:103], a[156:159], v[224:239]
ds_read_b64_tr_b16 v[100:101], v11 offset:53248
ds_read_b64_tr_b16 v[102:103], v11 offset:53760
s_waitcnt lgkmcnt(8)
v_mfma_f32_32x32x16_bf16 v[208:223], v[104:107], a[160:163], v[208:223]
ds_read_b64_tr_b16 v[104:105], v8 offset:55296
ds_read_b64_tr_b16 v[106:107], v8 offset:55808
v_mfma_f32_32x32x16_bf16 v[224:239], v[108:111], a[160:163], v[224:239]
ds_read_b64_tr_b16 v[108:109], v11 offset:55296
ds_read_b64_tr_b16 v[110:111], v11 offset:55808
s_waitcnt lgkmcnt(8)
v_mfma_f32_32x32x16_bf16 v[208:223], v[88:91], a[164:167], v[208:223]
s_barrier
ds_read_b64_tr_b16 v[88:89], v8 offset:57344
ds_read_b64_tr_b16 v[90:91], v8 offset:57856
v_mfma_f32_32x32x16_bf16 v[224:239], v[92:95], a[164:167], v[224:239]
ds_read_b64_tr_b16 v[92:93], v11 offset:57344
ds_read_b64_tr_b16 v[94:95], v11 offset:57856
s_waitcnt lgkmcnt(8)
v_mfma_f32_32x32x16_bf16 v[208:223], v[96:99], a[168:171], v[208:223]
ds_read_b64_tr_b16 v[96:97], v8 offset:59392
ds_read_b64_tr_b16 v[98:99], v8 offset:59904
v_mfma_f32_32x32x16_bf16 v[224:239], v[100:103], a[168:171], v[224:239]
ds_read_b64_tr_b16 v[100:101], v11 offset:59392
ds_read_b64_tr_b16 v[102:103], v11 offset:59904
s_waitcnt lgkmcnt(8)
v_mfma_f32_32x32x16_bf16 v[208:223], v[104:107], a[172:175], v[208:223]
ds_read_b64_tr_b16 v[104:105], v8 offset:61440
ds_read_b64_tr_b16 v[106:107], v8 offset:61952
v_mfma_f32_32x32x16_bf16 v[224:239], v[108:111], a[172:175], v[224:239]
ds_read_b64_tr_b16 v[108:109], v11 offset:61440
ds_read_b64_tr_b16 v[110:111], v11 offset:61952
s_waitcnt lgkmcnt(8)
v_mfma_f32_32x32x16_bf16 v[208:223], v[88:91], a[176:179], v[208:223]
ds_read_b64_tr_b16 v[88:89], v8 offset:63488
ds_read_b64_tr_b16 v[90:91], v8 offset:64000
v_mfma_f32_32x32x16_bf16 v[224:239], v[92:95], a[176:179], v[224:239]
ds_read_b64_tr_b16 v[92:93], v11 offset:63488
ds_read_b64_tr_b16 v[94:95], v11 offset:64000
s_waitcnt lgkmcnt(8)
v_mfma_f32_32x32x16_bf16 v[208:223], v[96:99], a[180:183], v[208:223]
s_barrier
ds_read_b64_tr_b16 v[96:97], v9 offset:0
ds_read_b64_tr_b16 v[98:99], v9 offset:512
v_mfma_f32_32x32x16_bf16 v[224:239], v[100:103], a[180:183], v[224:239]
ds_read_b64_tr_b16 v[100:101], v12 offset:0
ds_read_b64_tr_b16 v[102:103], v12 offset:512
s_waitcnt lgkmcnt(8)
v_mfma_f32_32x32x16_bf16 v[208:223], v[104:107], a[184:187], v[208:223]
ds_read_b64_tr_b16 v[104:105], v9 offset:2048
ds_read_b64_tr_b16 v[106:107], v9 offset:2560
v_mfma_f32_32x32x16_bf16 v[224:239], v[108:111], a[184:187], v[224:239]
ds_read_b64_tr_b16 v[108:109], v12 offset:2048
ds_read_b64_tr_b16 v[110:111], v12 offset:2560
s_waitcnt lgkmcnt(8)
v_mfma_f32_32x32x16_bf16 v[208:223], v[88:91], a[188:191], v[208:223]
ds_read_b64_tr_b16 v[88:89], v9 offset:4096
ds_read_b64_tr_b16 v[90:91], v9 offset:4608
v_mfma_f32_32x32x16_bf16 v[224:239], v[92:95], a[188:191], v[224:239]
ds_read_b64_tr_b16 v[92:93], v12 offset:4096
ds_read_b64_tr_b16 v[94:95], v12 offset:4608
s_waitcnt lgkmcnt(8)
v_mfma_f32_32x32x16_bf16 v[208:223], v[96:99], a[192:195], v[208:223]
ds_read_b64_tr_b16 v[96:97], v9 offset:6144
ds_read_b64_tr_b16 v[98:99], v9 offset:6656
v_mfma_f32_32x32x16_bf16 v[224:239], v[100:103], a[192:195], v[224:239]
ds_read_b64_tr_b16 v[100:101], v12 offset:6144
ds_read_b64_tr_b16 v[102:103], v12 offset:6656
s_waitcnt lgkmcnt(8)
v_mfma_f32_32x32x16_bf16 v[208:223], v[104:107], a[196:199], v[208:223]
ds_read_b64_tr_b16 v[104:105], v17 offset:3072
ds_read_b64_tr_b16 v[106:107], v17 offset:3584
v_mfma_f32_32x32x16_bf16 v[224:239], v[108:111], a[196:199], v[224:239]
ds_read_b64_tr_b16 v[108:109], v18 offset:3072
ds_read_b64_tr_b16 v[110:111], v18 offset:3584
s_waitcnt lgkmcnt(8)
v_mfma_f32_32x32x16_bf16 v[208:223], v[88:91], a[200:203], v[208:223]
s_barrier
ds_read_b64_tr_b16 v[88:89], v9 offset:8192
ds_read_b64_tr_b16 v[90:91], v9 offset:8704
v_mfma_f32_32x32x16_bf16 v[224:239], v[92:95], a[200:203], v[224:239]
ds_read_b64_tr_b16 v[92:93], v12 offset:8192
ds_read_b64_tr_b16 v[94:95], v12 offset:8704
s_waitcnt lgkmcnt(8)
v_mfma_f32_32x32x16_bf16 v[208:223], v[96:99], a[204:207], v[208:223]
ds_read_b64_tr_b16 v[96:97], v9 offset:10240
ds_read_b64_tr_b16 v[98:99], v9 offset:10752
v_mfma_f32_32x32x16_bf16 v[224:239], v[100:103], a[204:207], v[224:239]
ds_read_b64_tr_b16 v[100:101], v12 offset:10240
ds_read_b64_tr_b16 v[102:103], v12 offset:10752
buffer_load_ubyte v46, v45, s[36:39], s1 offen sc1
s_waitcnt vmcnt(5)
v_mfma_f32_16x16x32_bf16 v[60:63], v[48:51], a[212:215], 0
s_waitcnt lgkmcnt(8)
v_mfma_f32_32x32x16_bf16 v[208:223], v[104:107], a[208:211], v[208:223]
ds_read_b64_tr_b16 v[104:105], v9 offset:12288
ds_read_b64_tr_b16 v[106:107], v9 offset:12800
v_mfma_f32_16x16x32_bf16 v[60:63], v[48:51], a[232:235], v[60:63]
v_mfma_f32_32x32x16_bf16 v[224:239], v[108:111], a[208:211], v[224:239]
ds_read_b64_tr_b16 v[108:109], v12 offset:12288
ds_read_b64_tr_b16 v[110:111], v12 offset:12800
v_mfma_f32_16x16x32_bf16 v[60:63], v[48:51], a[236:239], v[60:63]
s_waitcnt lgkmcnt(8)
v_mfma_f32_32x32x16_bf16 v[208:223], v[88:91], a[64:67], v[208:223]
ds_read_b64_tr_b16 v[88:89], v9 offset:14336
ds_read_b64_tr_b16 v[90:91], v9 offset:14848
v_mfma_f32_16x16x32_bf16 v[60:63], v[48:51], a[240:243], v[60:63]
v_mfma_f32_32x32x16_bf16 v[224:239], v[92:95], a[64:67], v[224:239]
ds_read_b64_tr_b16 v[92:93], v12 offset:14336
ds_read_b64_tr_b16 v[94:95], v12 offset:14848
v_mfma_f32_16x16x32_bf16 v[60:63], v[48:51], a[244:247], v[60:63]
s_waitcnt lgkmcnt(8)
v_mfma_f32_32x32x16_bf16 v[208:223], v[96:99], a[68:71], v[208:223]
s_barrier
ds_read_b64_tr_b16 v[96:97], v9 offset:16384
ds_read_b64_tr_b16 v[98:99], v9 offset:16896
v_mfma_f32_32x32x16_bf16 v[224:239], v[100:103], a[68:71], v[224:239]
ds_read_b64_tr_b16 v[100:101], v12 offset:16384
ds_read_b64_tr_b16 v[102:103], v12 offset:16896
s_nop 3
v_cvt_pk_bf16_f32 v60, v60, v61
v_cvt_pk_bf16_f32 v61, v62, v63
buffer_store_dwordx2 v[60:61], v44, s[28:31], 0 offen offset:0
s_waitcnt lgkmcnt(8)
v_mfma_f32_32x32x16_bf16 v[208:223], v[104:107], a[72:75], v[208:223]
ds_read_b64_tr_b16 v[104:105], v9 offset:18432
ds_read_b64_tr_b16 v[106:107], v9 offset:18944
v_mfma_f32_32x32x16_bf16 v[224:239], v[108:111], a[72:75], v[224:239]
ds_read_b64_tr_b16 v[108:109], v12 offset:18432
ds_read_b64_tr_b16 v[110:111], v12 offset:18944
s_waitcnt lgkmcnt(8)
v_mfma_f32_32x32x16_bf16 v[208:223], v[88:91], a[76:79], v[208:223]
ds_read_b64_tr_b16 v[88:89], v9 offset:20480
ds_read_b64_tr_b16 v[90:91], v9 offset:20992
v_mfma_f32_32x32x16_bf16 v[224:239], v[92:95], a[76:79], v[224:239]
ds_read_b64_tr_b16 v[92:93], v12 offset:20480
ds_read_b64_tr_b16 v[94:95], v12 offset:20992
s_waitcnt lgkmcnt(8)
v_mfma_f32_32x32x16_bf16 v[208:223], v[96:99], a[80:83], v[208:223]
ds_read_b64_tr_b16 v[96:97], v9 offset:22528
ds_read_b64_tr_b16 v[98:99], v9 offset:23040
v_mfma_f32_32x32x16_bf16 v[224:239], v[100:103], a[80:83], v[224:239]
ds_read_b64_tr_b16 v[100:101], v12 offset:22528
ds_read_b64_tr_b16 v[102:103], v12 offset:23040
s_waitcnt lgkmcnt(8)
v_mfma_f32_32x32x16_bf16 v[208:223], v[104:107], a[84:87], v[208:223]
s_barrier
ds_read_b64_tr_b16 v[104:105], v9 offset:24576
ds_read_b64_tr_b16 v[106:107], v9 offset:25088
v_mfma_f32_32x32x16_bf16 v[224:239], v[108:111], a[84:87], v[224:239]
ds_read_b64_tr_b16 v[108:109], v12 offset:24576
ds_read_b64_tr_b16 v[110:111], v12 offset:25088
s_waitcnt lgkmcnt(8)
v_mfma_f32_32x32x16_bf16 v[208:223], v[88:91], a[88:91], v[208:223]
ds_read_b64_tr_b16 v[88:89], v9 offset:26624
ds_read_b64_tr_b16 v[90:91], v9 offset:27136
v_mfma_f32_32x32x16_bf16 v[224:239], v[92:95], a[88:91], v[224:239]
ds_read_b64_tr_b16 v[92:93], v12 offset:26624
ds_read_b64_tr_b16 v[94:95], v12 offset:27136
s_waitcnt lgkmcnt(8)
v_mfma_f32_32x32x16_bf16 v[208:223], v[96:99], a[92:95], v[208:223]
ds_read_b64_tr_b16 v[96:97], v9 offset:28672
ds_read_b64_tr_b16 v[98:99], v9 offset:29184
v_mfma_f32_32x32x16_bf16 v[224:239], v[100:103], a[92:95], v[224:239]
ds_read_b64_tr_b16 v[100:101], v12 offset:28672
ds_read_b64_tr_b16 v[102:103], v12 offset:29184
s_waitcnt lgkmcnt(8)
v_mfma_f32_32x32x16_bf16 v[208:223], v[104:107], a[96:99], v[208:223]
ds_read_b64_tr_b16 v[104:105], v9 offset:30720
ds_read_b64_tr_b16 v[106:107], v9 offset:31232
v_mfma_f32_32x32x16_bf16 v[224:239], v[108:111], a[96:99], v[224:239]
ds_read_b64_tr_b16 v[108:109], v12 offset:30720
ds_read_b64_tr_b16 v[110:111], v12 offset:31232
s_waitcnt lgkmcnt(8)
v_mfma_f32_32x32x16_bf16 v[208:223], v[88:91], a[100:103], v[208:223]
s_barrier
ds_read_b64_tr_b16 v[88:89], v9 offset:32768
ds_read_b64_tr_b16 v[90:91], v9 offset:33280
v_mfma_f32_32x32x16_bf16 v[224:239], v[92:95], a[100:103], v[224:239]
ds_read_b64_tr_b16 v[92:93], v12 offset:32768
ds_read_b64_tr_b16 v[94:95], v12 offset:33280
s_waitcnt lgkmcnt(8)
v_mfma_f32_32x32x16_bf16 v[208:223], v[96:99], a[104:107], v[208:223]
ds_read_b64_tr_b16 v[96:97], v9 offset:34816
ds_read_b64_tr_b16 v[98:99], v9 offset:35328
v_mfma_f32_32x32x16_bf16 v[224:239], v[100:103], a[104:107], v[224:239]
ds_read_b64_tr_b16 v[100:101], v12 offset:34816
ds_read_b64_tr_b16 v[102:103], v12 offset:35328
s_waitcnt lgkmcnt(8)
v_mfma_f32_32x32x16_bf16 v[208:223], v[104:107], a[108:111], v[208:223]
ds_read_b64_tr_b16 v[104:105], v9 offset:36864
ds_read_b64_tr_b16 v[106:107], v9 offset:37376
v_mfma_f32_32x32x16_bf16 v[224:239], v[108:111], a[108:111], v[224:239]
ds_read_b64_tr_b16 v[108:109], v12 offset:36864
ds_read_b64_tr_b16 v[110:111], v12 offset:37376
s_waitcnt lgkmcnt(8)
v_mfma_f32_32x32x16_bf16 v[208:223], v[88:91], a[112:115], v[208:223]
ds_read_b64_tr_b16 v[88:89], v9 offset:38912
ds_read_b64_tr_b16 v[90:91], v9 offset:39424
v_mfma_f32_32x32x16_bf16 v[224:239], v[92:95], a[112:115], v[224:239]
ds_read_b64_tr_b16 v[92:93], v12 offset:38912
ds_read_b64_tr_b16 v[94:95], v12 offset:39424
s_waitcnt lgkmcnt(8)
v_mfma_f32_32x32x16_bf16 v[208:223], v[96:99], a[116:119], v[208:223]
s_barrier
ds_read_b64_tr_b16 v[96:97], v9 offset:40960
ds_read_b64_tr_b16 v[98:99], v9 offset:41472
v_mfma_f32_32x32x16_bf16 v[224:239], v[100:103], a[116:119], v[224:239]
ds_read_b64_tr_b16 v[100:101], v12 offset:40960
ds_read_b64_tr_b16 v[102:103], v12 offset:41472
v_mov_b32 v47, 5
s_waitcnt vmcnt(2)
s_barrier
s_waitcnt lgkmcnt(8)
v_mfma_f32_32x32x16_bf16 v[208:223], v[104:107], a[120:123], v[208:223]
ds_read_b64_tr_b16 v[104:105], v9 offset:43008
ds_read_b64_tr_b16 v[106:107], v9 offset:43520
buffer_store_byte v47, v0, s[36:39], s1 offen sc1
s_waitcnt vmcnt(2)
v_mfma_f32_32x32x16_bf16 v[224:239], v[108:111], a[120:123], v[224:239]
ds_read_b64_tr_b16 v[108:109], v12 offset:43008
ds_read_b64_tr_b16 v[110:111], v12 offset:43520
v_cmp_gt_u32 vcc, 4, v46
s_cmp_lg_u64 vcc, 0
s_cbranch_scc1 L_slow4
L_back4:
s_waitcnt lgkmcnt(8)
v_mfma_f32_32x32x16_bf16 v[208:223], v[88:91], a[124:127], v[208:223]
ds_read_b64_tr_b16 v[88:89], v9 offset:45056
ds_read_b64_tr_b16 v[90:91], v9 offset:45568
s_mov_b32 s7, 16384
buffer_load_dwordx4 a[248:251], v40, s[36:39], s7 offen sc1
v_mfma_f32_32x32x16_bf16 v[224:239], v[92:95], a[124:127], v[224:239]
ds_read_b64_tr_b16 v[92:93], v12 offset:45056
ds_read_b64_tr_b16 v[94:95], v12 offset:45568
s_mov_b32 s7, 737280
buffer_load_dwordx4 a[252:255], v40, s[36:39], s7 offen sc1
s_waitcnt lgkmcnt(8)
v_mfma_f32_32x32x16_bf16 v[208:223], v[96:99], a[16:19], v[208:223]
ds_read_b64_tr_b16 v[96:97], v9 offset:47104
ds_read_b64_tr_b16 v[98:99], v9 offset:47616
s_mov_b32 s7, 1458176
buffer_load_dwordx4 v[72:75], v40, s[36:39], s7 offen sc1
v_mfma_f32_32x32x16_bf16 v[224:239], v[100:103], a[16:19], v[224:239]
ds_read_b64_tr_b16 v[100:101], v12 offset:47104
ds_read_b64_tr_b16 v[102:103], v12 offset:47616
s_mov_b32 s7, 2179072
buffer_load_dwordx4 v[76:79], v40, s[36:39], s7 offen sc1
s_waitcnt lgkmcnt(8)
v_mfma_f32_32x32x16_bf16 v[208:223], v[104:107], a[20:23], v[208:223]
ds_read_b64_tr_b16 v[104:105], v17 offset:7168
ds_read_b64_tr_b16 v[106:107], v17 offset:7680
v_mfma_f32_32x32x16_bf16 v[224:239], v[108:111], a[20:23], v[224:239]
ds_read_b64_tr_b16 v[108:109], v18 offset:7168
ds_read_b64_tr_b16 v[110:111], v18 offset:7680
s_waitcnt lgkmcnt(8)
v_mfma_f32_32x32x16_bf16 v[208:223], v[88:91], a[24:27], v[208:223]
v_mfma_f32_32x32x16_bf16 v[224:239], v[92:95], a[24:27], v[224:239]
s_waitcnt lgkmcnt(4)
v_mfma_f32_32x32x16_bf16 v[208:223], v[96:99], a[28:31], v[208:223]
v_mfma_f32_32x32x16_bf16 v[224:239], v[100:103], a[28:31], v[224:239]
s_waitcnt lgkmcnt(0)
v_mfma_f32_32x32x16_bf16 v[208:223], v[104:107], a[48:51], v[208:223]
v_mfma_f32_32x32x16_bf16 v[224:239], v[108:111], a[48:51], v[224:239]
s_nop 10
v_cvt_pk_bf16_f32 v24, v208, v209
v_cvt_pk_bf16_f32 v25, v210, v211
v_cvt_pk_bf16_f32 v26, v212, v213
v_cvt_pk_bf16_f32 v27, v214, v215
s_mov_b32 s6, 65536
buffer_store_dwordx4 v[24:27], v21, s[36:39], s6 offen offset:0 sc1
v_cvt_pk_bf16_f32 v28, v216, v217
v_cvt_pk_bf16_f32 v29, v218, v219
v_cvt_pk_bf16_f32 v30, v220, v221
v_cvt_pk_bf16_f32 v31, v222, v223
s_mov_b32 s6, 65536
buffer_store_dwordx4 v[28:31], v21, s[36:39], s6 offen offset:1024 sc1
v_cvt_pk_bf16_f32 v32, v224, v225
v_cvt_pk_bf16_f32 v33, v226, v227
v_cvt_pk_bf16_f32 v34, v228, v229
v_cvt_pk_bf16_f32 v35, v230, v231
s_mov_b32 s6, 65536
buffer_store_dwordx4 v[32:35], v21, s[36:39], s6 offen offset:2048 sc1
v_cvt_pk_bf16_f32 v36, v232, v233
v_cvt_pk_bf16_f32 v37, v234, v235
v_cvt_pk_bf16_f32 v38, v236, v237
v_cvt_pk_bf16_f32 v39, v238, v239
s_mov_b32 s6, 65536
buffer_store_dwordx4 v[36:39], v21, s[36:39], s6 offen offset:3072 sc1
buffer_load_ubyte v68, v45, s[36:39], s1 offen sc1
s_waitcnt vmcnt(0)
v_cmp_gt_u32 vcc, 5, v68
s_cmp_lg_u64 vcc, 0
s_cbranch_scc1 L_slow5
L_back5:
s_mov_b32 s7, 32768
buffer_load_dwordx4 v[80:83], v40, s[36:39], s7 offen sc1
s_mov_b32 s7, 753664
buffer_load_dwordx4 v[84:87], v40, s[36:39], s7 offen sc1
s_mov_b32 s7, 1474560
buffer_load_dwordx4 a[52:55], v40, s[36:39], s7 offen sc1
s_mov_b32 s7, 2195456
buffer_load_dwordx4 a[56:59], v40, s[36:39], s7 offen sc1
s_mov_b32 s7, 49152
buffer_load_dwordx4 a[60:63], v40, s[36:39], s7 offen sc1
s_mov_b32 s7, 770048
buffer_load_dwordx4 a[0:3], v40, s[36:39], s7 offen sc1
s_mov_b32 s7, 1490944
buffer_load_dwordx4 a[4:7], v40, s[36:39], s7 offen sc1
s_mov_b32 s7, 2211840
buffer_load_dwordx4 a[8:11], v40, s[36:39], s7 offen sc1
s_mov_b32 s7, 65536
buffer_load_dwordx4 v[144:147], v40, s[36:39], s7 offen sc1
s_mov_b32 s7, 786432
buffer_load_dwordx4 v[148:151], v40, s[36:39], s7 offen sc1
s_mov_b32 s7, 1507328
buffer_load_dwordx4 v[152:155], v40, s[36:39], s7 offen sc1
s_mov_b32 s7, 2228224
buffer_load_dwordx4 v[156:159], v40, s[36:39], s7 offen sc1
v_mfma_f32_16x16x32_bf16 v[64:67], v[56:59], a[216:219], 0
v_mfma_f32_16x16x32_bf16 v[64:67], v[56:59], a[248:251], v[64:67]
v_mfma_f32_16x16x32_bf16 v[64:67], v[56:59], a[252:255], v[64:67]
v_mfma_f32_16x16x32_bf16 v[64:67], v[56:59], v[72:75], v[64:67]
v_mfma_f32_16x16x32_bf16 v[64:67], v[56:59], v[76:79], v[64:67]
s_nop 11
v_cvt_pk_bf16_f32 v64, v64, v65
v_cvt_pk_bf16_f32 v65, v66, v67
buffer_store_dwordx2 v[64:65], v43, s[28:31], 0 offen offset:128
s_waitcnt vmcnt(9)
v_mfma_f32_16x16x32_bf16 v[60:63], v[56:59], a[220:223], 0
v_mfma_f32_16x16x32_bf16 v[60:63], v[56:59], v[80:83], v[60:63]
v_mfma_f32_16x16x32_bf16 v[60:63], v[56:59], v[84:87], v[60:63]
v_mfma_f32_16x16x32_bf16 v[60:63], v[56:59], a[52:55], v[60:63]
v_mfma_f32_16x16x32_bf16 v[60:63], v[56:59], a[56:59], v[60:63]
s_nop 11
v_cvt_pk_bf16_f32 v60, v60, v61
v_cvt_pk_bf16_f32 v61, v62, v63
buffer_store_dwordx2 v[60:61], v43, s[28:31], 0 offen offset:256
s_waitcnt vmcnt(6)
v_mfma_f32_16x16x32_bf16 v[64:67], v[56:59], a[224:227], 0
v_mfma_f32_16x16x32_bf16 v[64:67], v[56:59], a[60:63], v[64:67]
v_mfma_f32_16x16x32_bf16 v[64:67], v[56:59], a[0:3], v[64:67]
v_mfma_f32_16x16x32_bf16 v[64:67], v[56:59], a[4:7], v[64:67]
v_mfma_f32_16x16x32_bf16 v[64:67], v[56:59], a[8:11], v[64:67]
s_nop 11
v_cvt_pk_bf16_f32 v64, v64, v65
v_cvt_pk_bf16_f32 v65, v66, v67
buffer_store_dwordx2 v[64:65], v43, s[28:31], 0 offen offset:384
s_waitcnt vmcnt(3)
s_mov_b32 s44, 0x20000
L_ck4:
s_mov_b32 s45, 0
v_max3_u32 v46, v144, v145, v146
v_max_u32 v46, v46, v147
v_cmp_eq_u32 vcc, -1, v46
s_cmp_lg_u64 vcc, 0
s_cbranch_scc0 L_cs144
s_mov_b32 s7, 65536
buffer_load_dwordx4 v[144:147], v40, s[36:39], s7 offen sc1
s_mov_b32 s45, 1
L_cs144:
v_max3_u32 v46, v148, v149, v150
v_max_u32 v46, v46, v151
v_cmp_eq_u32 vcc, -1, v46
s_cmp_lg_u64 vcc, 0
s_cbranch_scc0 L_cs148
s_mov_b32 s7, 786432
buffer_load_dwordx4 v[148:151], v40, s[36:39], s7 offen sc1
s_mov_b32 s45, 1
L_cs148:
v_max3_u32 v46, v152, v153, v154
v_max_u32 v46, v46, v155
v_cmp_eq_u32 vcc, -1, v46
s_cmp_lg_u64 vcc, 0
s_cbranch_scc0 L_cs152
s_mov_b32 s7, 1507328
buffer_load_dwordx4 v[152:155], v40, s[36:39], s7 offen sc1
s_mov_b32 s45, 1
L_cs152:
v_max3_u32 v46, v156, v157, v158
v_max_u32 v46, v46, v159
v_cmp_eq_u32 vcc, -1, v46
s_cmp_lg_u64 vcc, 0
s_cbranch_scc0 L_cs156
s_mov_b32 s7, 2228224
buffer_load_dwordx4 v[156:159], v40, s[36:39], s7 offen sc1
s_mov_b32 s45, 1
L_cs156:
s_cmp_eq_u32 s45, 0
s_cbranch_scc1 L_ck4d
s_waitcnt vmcnt(0)
s_sub_u32 s44, s44, 1
s_cmp_lg_u32 s44, 0
s_cbranch_scc1 L_ck4
L_ck4d:
v_mfma_f32_16x16x32_bf16 v[60:63], v[56:59], a[228:231], 0
v_mfma_f32_16x16x32_bf16 v[60:63], v[56:59], v[144:147], v[60:63]
v_mfma_f32_16x16x32_bf16 v[60:63], v[56:59], v[148:151], v[60:63]
v_mfma_f32_16x16x32_bf16 v[60:63], v[56:59], v[152:155], v[60:63]
v_mfma_f32_16x16x32_bf16 v[60:63], v[56:59], v[156:159], v[60:63]
s_nop 11
v_cvt_pk_bf16_f32 v60, v60, v61
v_cvt_pk_bf16_f32 v61, v62, v63
buffer_store_dwordx2 v[60:61], v43, s[28:31], 0 offen offset:512
L_done:
s_endpgm
L_slow0:
s_mov_b32 s44, 0x20000
L_spin0:
buffer_load_dword v19, v2, s[32:35], 0 offen sc1
s_waitcnt vmcnt(0)
v_cmp_ne_u32 vcc, s100, v19
s_cmp_eq_u64 vcc, 0
s_cbranch_scc1 L_back0
s_sub_u32 s44, s44, 1
s_cmp_lg_u32 s44, 0
s_cbranch_scc1 L_spin0
s_branch L_back0
L_slow1:
s_mov_b32 s44, 0x20000
L_spin1:
buffer_load_ubyte v4, v14, s[36:39], s1 offen sc1
s_waitcnt vmcnt(0)
v_cmp_gt_u32 vcc, 1, v4
s_cmp_eq_u64 vcc, 0
s_cbranch_scc1 L_back1
s_sub_u32 s44, s44, 1
s_cmp_lg_u32 s44, 0
s_cbranch_scc1 L_spin1
s_branch L_back1
L_slow2:
s_mov_b32 s44, 0x20000
L_spin2:
buffer_load_ubyte v4, v14, s[36:39], s1 offen sc1
s_waitcnt vmcnt(0)
v_cmp_gt_u32 vcc, 2, v4
s_cmp_eq_u64 vcc, 0
s_cbranch_scc1 L_back2
s_sub_u32 s44, s44, 1
s_cmp_lg_u32 s44, 0
s_cbranch_scc1 L_spin2
s_branch L_back2
L_slow3:
s_mov_b32 s44, 0x20000
L_spin3:
buffer_load_ubyte v46, v45, s[36:39], s1 offen sc1
s_waitcnt vmcnt(0)
v_cmp_gt_u32 vcc, 3, v46
s_cmp_eq_u64 vcc, 0
s_cbranch_scc1 L_back3
s_sub_u32 s44, s44, 1
s_cmp_lg_u32 s44, 0
s_cbranch_scc1 L_spin3
s_branch L_back3
L_slow4:
s_mov_b32 s44, 0x20000
L_spin4:
buffer_load_ubyte v46, v45, s[36:39], s1 offen sc1
s_waitcnt vmcnt(0)
v_cmp_gt_u32 vcc, 4, v46
s_cmp_eq_u64 vcc, 0
s_cbranch_scc1 L_back4
s_sub_u32 s44, s44, 1
s_cmp_lg_u32 s44, 0
s_cbranch_scc1 L_spin4
s_branch L_back4
L_slow5:
s_mov_b32 s44, 0x20000
L_spin5:
buffer_load_ubyte v68, v45, s[36:39], s1 offen sc1
s_waitcnt vmcnt(0)
v_cmp_gt_u32 vcc, 5, v68
s_cmp_eq_u64 vcc, 0
s_cbranch_scc1 L_back5
s_sub_u32 s44, s44, 1
s_cmp_lg_u32 s44, 0
s_cbranch_scc1 L_spin5
s_branch L_back5
L_end:
.section .rodata,"a"
.p2align 6
.amdhsa_kernel parallel_sum__linear_attn_block__glu_gated_reglu__prompt_kernel
  .amdhsa_next_free_vgpr 512
  .amdhsa_next_free_sgpr 102
  .amdhsa_accum_offset 256
  .amdhsa_group_segment_fixed_size 0
  .amdhsa_kernarg_size 80
  .amdhsa_user_sgpr_count 2
  .amdhsa_user_sgpr_kernarg_segment_ptr 1
  .amdhsa_system_sgpr_workgroup_id_x 1
.end_amdhsa_kernel
```
